```python
import torch

def _softmax(x, axis=-1):
    return torch.softmax(x, dim=axis)
def _gelu(x):
    return torch.nn.functional.gelu(x, approximate="tanh")
def _silu(x):
    return torch.nn.functional.silu(x)
def _sigmoid(x):
    return torch.sigmoid(x)
def _layernorm(x, axis=-1, eps=1e-5):
    m = x.mean(dim=axis, keepdim=True)
    v = x.var(dim=axis, keepdim=True, unbiased=False)
    return (x - m) / torch.sqrt(v + eps)
def _scatter_add(tgt, idx, src, axis=0):
    return tgt.clone().index_add_(axis, idx, src)
def _segment_sum(src, seg, n):
    out = torch.zeros((n,) + src.shape[1:], dtype=src.dtype)
    return out.index_add_(0, seg, src)
def _pad(x, pw):
    flat = tuple(v for pair in reversed(pw) for v in pair)
    return torch.nn.functional.pad(x, flat)

kernel_name = 'parallel_sum__ssm_conv_h3__glu_gated_glu__prompt'

def setup_inputs():

    _w = (lambda a: (lambda t: t.to(torch.bfloat16) if t.is_floating_point() else t)(torch.as_tensor(a)))
    def _A_setup():
        B, S, D = 1, 2048, 1024
        ks = 4
        return {
            "q": _w((lambda *s: torch.randn(*s, dtype=torch.bfloat16) * 0.05)(B, S, D)),
            "k": _w((lambda *s: torch.randn(*s, dtype=torch.bfloat16) * 0.8)(B, S, D)),
            "v": _w((lambda *s: torch.randn(*s, dtype=torch.bfloat16) * 0.8)(B, S, D)),
            "shift_k": _w((lambda *s: torch.randn(*s, dtype=torch.bfloat16) * 0.8)(D, ks) * 0.5),
            "ssm_k": _w((lambda *s: torch.randn(*s, dtype=torch.bfloat16) * 0.8)(D, S) * (1.0 / S ** 0.5)),
            "ssm_D": _w((lambda *s: torch.randn(*s, dtype=torch.bfloat16) * 0.8)(D)),
        }
    _A_in = _A_setup()

    def _B_setup():
        B, S, D, F = 1, 2048, 1024, 3584
        return {
            "x": _w((lambda *s: torch.randn(*s, dtype=torch.bfloat16) * 0.05)(B, S, D)),
            "w_gate": _w((lambda *s: torch.randn(*s, dtype=torch.bfloat16) * 0.05)(D, F)),
            "w_up": _w((lambda *s: torch.randn(*s, dtype=torch.bfloat16) * 0.05)(D, F)),
            "w_down": _w((lambda *s: torch.randn(*s, dtype=torch.bfloat16) * 0.05)(F, D)),
        }
    _B_in = _B_setup()

    return {
        "A_q": _A_in["q"],
        "A_k": _A_in["k"],
        "A_v": _A_in["v"],
        "A_shift_k": _A_in["shift_k"],
        "A_ssm_k": _A_in["ssm_k"],
        "A_ssm_D": _A_in["ssm_D"],
        "B_x": _B_in["x"],
        "B_w_gate": _B_in["w_gate"],
        "B_w_up": _B_in["w_up"],
        "B_w_down": _B_in["w_down"],
    }

def reference(A_q, A_k, A_v, A_shift_k, A_ssm_k, A_ssm_D, B_x, B_w_gate, B_w_up, B_w_down):
    def _A_ref(q, k, v, shift_k, ssm_k, ssm_D):
        B, S, D = q.shape
        ks = shift_k.shape[-1]
        k_pad = _pad(k, ((0, 0), (ks - 1, 0), (0, 0)))
        k_shift = torch.zeros_like(k)
        for t in range(ks):
            k_shift = k_shift + k_pad[:, t:t + S, :] * shift_k[:, ks - 1 - t][None, None, :]
        kv = k_shift * v
        L = 2 * S
        kv_pad = _pad(kv, ((0, 0), (0, S), (0, 0)))
        kf_pad = _pad(ssm_k, ((0, 0), (0, S)))
        kv_f = (lambda x, axes=(-2,-1): torch.fft.rfft2(x.float(), dim=axes))(kv_pad[:, None, :, :], axes=(1, 2))
        kf_f = (lambda x, axes=(-2,-1): torch.fft.rfft2(x.float(), dim=axes))(kf_pad[:, None, :], axes=(1, 2))
        kf_f = (lambda x, *d: x.permute(*d))(kf_f, 1, 2, 0)
        y_f = kv_f * kf_f[None, :, :, :]
        y = (lambda x, s, axes=(-2,-1): torch.fft.irfft2(x, s=s, dim=axes).to(torch.bfloat16))(y_f, (1, L), axes=(1, 2))[:, 0, :S, :]
        y = y + kv * ssm_D[None, None, :]
        return q * y

    def _B_ref(x, w_gate, w_up, w_down):
        g = torch.einsum("bsd,df->bsf", x, w_gate)
        u = torch.einsum("bsd,df->bsf", x, w_up)
        h = _sigmoid(g) * u
        return torch.einsum("bsf,fd->bsd", h, w_down)

    x = A_q
    xn = _layernorm(x, axis=-1)
    return x + _A_ref(xn, A_k, A_v, A_shift_k, A_ssm_k, A_ssm_D) + _B_ref(xn, B_w_gate, B_w_up, B_w_down)
```

```asm
; @launch grid=(256,1,1) block=(256,1,1) lds=163840
.amdgcn_target "amdgcn-amd-amdhsa--gfx950"
.text
.globl parallel_sum__ssm_conv_h3__glu_gated_glu__prompt_kernel
.p2align 8
.type parallel_sum__ssm_conv_h3__glu_gated_glu__prompt_kernel,@function
parallel_sum__ssm_conv_h3__glu_gated_glu__prompt_kernel:
    s_cmp_ge_u32 s2, 256
    s_cbranch_scc1 La_end
    s_load_dwordx8 s[4:11], s[0:1], 0
    s_load_dwordx4 s[12:15], s[0:1], 56
    s_load_dwordx4 s[16:19], s[0:1], 88
    s_load_dwordx2 s[20:21], s[0:1], 32
    s_load_dwordx2 s[22:23], s[0:1], 72
    s_getpc_b64 s[24:25]
Lpc_La_ct_La_end:
    s_add_u32 s24, s24, La_ct-Lpc_La_ct_La_end
    s_addc_u32 s25, s25, 0
    s_mov_b32 s26, La_end-La_ct
    s_mov_b32 s27, 0x00020000
    v_lshlrev_b32 v26, 7, v0
    buffer_load_dword v27, v26, s[24:27], 0 offen
    v_add_u32 v26, 32768, v26
    buffer_load_dword v27, v26, s[24:27], 0 offen
La_ct:
    v_and_b32 v1, 63, v0
    v_lshrrev_b32 v2, 6, v0
    s_and_b32 s27, s2, 1
    v_readfirstlane_b32 s24, v2
    s_lshr_b32 s3, s2, 3
    s_and_b32 s28, s3, 3
    s_lshl_b32 s25, s27, 2
    s_add_u32 s25, s25, s28
    s_bfe_u32 s26, s2, 0x20001
    s_lshl_b32 s26, s26, 3
    s_and_b32 s3, s3, 28
    s_lshr_b32 s3, 0x74306521, s3
    s_and_b32 s3, s3, 7
    s_add_u32 s26, s26, s3
    s_and_b32 s31, s26, 1
    s_lshr_b32 s29, s24, 1
    s_and_b32 s30, s24, 1
    v_lshlrev_b32 v2, 4, v1
    s_lshl_b32 s62, s2, 2
    s_add_u32 s62, s62, s24
    v_bfrev_b32 v31, 1
    v_or_b32 v3, s2, v0
    v_lshlrev_b32 v3, 20, v3
    v_lshlrev_b32 v30, 20, v0
    s_movk_i32 s91, 4682
    v_mul_u32_u24 v48, s91, v1
    v_lshrrev_b32 v48, 16, v48
    v_mul_u32_u24 v49, 14, v48
    v_sub_u32 v49, v1, v49
    s_lshr_b32 s3, s2, 3
    v_lshl_add_u32 v48, v48, 5, s3
    v_mul_u32_u24 v48, 7168, v48
    v_lshl_add_u32 v48, v49, 7, v48
    s_lshr_b32 s3, s2, 5
    s_lshl_b32 s3, s3, 5
    v_add_u32 v49, s3, v1
    v_lshlrev_b32 v49, 11, v49
    s_cmp_eq_u32 s29, 0
    s_cselect_b64 vcc, -1, 0
    s_cselect_b32 s3, 55, 31
    v_cmp_lt_u32 s[82:83], s3, v1
    v_cndmask_b32 v26, v49, v48, vcc
    s_lshr_b32 s3, s26, 3
    s_mul_i32 s3, s3, 1792
    s_mul_i32 s89, s27, 3670016
    v_cndmask_b32 v26, v26, v31, s[82:83]
    s_add_u32 s3, s3, s89
    s_lshl_b32 s90, s25, 19
    s_lshl_b32 s88, s27, 10
    s_add_u32 s88, s88, s90
    s_lshl_b32 s81, s30, 7
    s_add_u32 s81, s81, s88
    s_cmp_eq_u32 s29, 0
    s_cselect_b32 s76, s3, s81
    s_mov_b32 s77, 256
    s_cselect_b32 s77, 917504, s77
    s_mov_b32 s74, 4194304
    s_cselect_b32 s74, 7340032, s74
    s_mov_b32 s75, 0x00020000
    s_waitcnt lgkmcnt(0)
    s_cmp_eq_u32 s30, 1
    s_cselect_b64 s[32:33], s[14:15], s[12:13]
    s_cmp_eq_u32 s29, 0
    s_cselect_b64 s[72:73], s[32:33], s[4:5]
    s_cmp_eq_u32 s24, 2
    s_cselect_b32 s3, 63, 27
    s_cmp_eq_u32 s24, 3
    s_cselect_b32 s3, -1, s3
    v_cmp_lt_i32 vcc, s3, v1
    s_nop 1
    v_cndmask_b32 v58, v26, v31, vcc
    v_cndmask_b32 v59, v31, v26, vcc
    buffer_load_dword a254, v58, s[72:75], s76 offen
    s_mov_b32 s56, s18
    s_mov_b32 s57, s19
    s_mov_b32 s58, 1048576
    s_mov_b32 s59, 0x00020000
    s_mov_b32 s63, 532480
    buffer_load_dword v29, v3, s[56:59], s63 offen sc1
    s_mov_b32 s34, 7340032
    s_mov_b32 s35, 0x00020000
    s_mov_b32 s44, s4
    s_mov_b32 s45, s5
    s_mov_b32 s46, 4194304
    s_mov_b32 s47, 0x00020000
    s_lshr_b32 s3, s26, 1
    s_mul_i32 s3, s3, 448
    s_mul_i32 s38, s29, 229376
    s_add_u32 s38, s38, s3
    s_add_u32 s39, s38, 7340032
    s_add_u32 s36, s89, s38
    s_mov_b32 s37, 458752
    s_lshl_b32 s41, s29, 14
    s_lshl_b32 s3, s30, 13
    s_add_u32 s41, s41, s3
    s_add_u32 s41, s41, 98304
    s_add_u32 s42, s41, 65536
    s_mov_b32 s40, s41
    s_lshl_b32 s50, s24, 17
    s_add_u32 s50, s50, s90
    s_add_u32 s51, s50, 2048
    s_lshl_b32 s48, s27, 10
    s_add_u32 s48, s48, s50
    s_movk_i32 s49, 128
    s_lshl_b32 s53, s24, 13
    s_add_u32 s54, s53, 98304
    s_mov_b32 s52, s53
    s_mov_b32 s82, 0x98643210
    s_mov_b32 s83, 0xec75ba
    s_lshl_b32 s3, s31, 4
    v_mov_b32 v56, s31
    v_mov_b32 v57, s3
    v_add_u32 v48, 0, v1
    v_mul_u32_u24 v49, s91, v48
    v_lshrrev_b32 v49, 16, v49
    v_mul_u32_u24 v50, 14, v49
    v_sub_u32 v50, v48, v50
    v_cmp_lt_u32 vcc, 11, v50
    v_lshlrev_b32 v52, 2, v50
    v_lshrrev_b64 v[52:53], v52, s[82:83]
    v_cndmask_b32 v53, v57, v56, vcc
    v_and_b32 v52, 15, v52
    v_add_u32 v50, v52, v53
    v_and_b32 v51, 0x13, v49
    v_bfe_u32 v52, v49, 2, 1
    v_lshl_or_b32 v51, v52, 3, v51
    v_bfe_u32 v52, v49, 3, 1
    v_lshl_or_b32 v51, v52, 2, v51
    v_mul_u32_u24 v51, 7168, v51
    v_lshl_add_u32 v32, v50, 4, v51
    v_add_u32 v48, 64, v1
    v_mul_u32_u24 v49, s91, v48
    v_lshrrev_b32 v49, 16, v49
    v_mul_u32_u24 v50, 14, v49
    v_sub_u32 v50, v48, v50
    v_cmp_lt_u32 vcc, 11, v50
    v_lshlrev_b32 v52, 2, v50
    v_lshrrev_b64 v[52:53], v52, s[82:83]
    v_cndmask_b32 v53, v57, v56, vcc
    v_and_b32 v52, 15, v52
    v_add_u32 v50, v52, v53
    v_and_b32 v51, 0x13, v49
    v_bfe_u32 v52, v49, 2, 1
    v_lshl_or_b32 v51, v52, 3, v51
    v_bfe_u32 v52, v49, 3, 1
    v_lshl_or_b32 v51, v52, 2, v51
    v_mul_u32_u24 v51, 7168, v51
    v_lshl_add_u32 v33, v50, 4, v51
    v_subrev_u32 v33, 1024, v33
    v_add_u32 v48, 128, v1
    v_mul_u32_u24 v49, s91, v48
    v_lshrrev_b32 v49, 16, v49
    v_mul_u32_u24 v50, 14, v49
    v_sub_u32 v50, v48, v50
    v_cmp_lt_u32 vcc, 11, v50
    v_lshlrev_b32 v52, 2, v50
    v_lshrrev_b64 v[52:53], v52, s[82:83]
    v_cndmask_b32 v53, v57, v56, vcc
    v_and_b32 v52, 15, v52
    v_add_u32 v50, v52, v53
    v_and_b32 v51, 0x13, v49
    v_bfe_u32 v52, v49, 2, 1
    v_lshl_or_b32 v51, v52, 3, v51
    v_bfe_u32 v52, v49, 3, 1
    v_lshl_or_b32 v51, v52, 2, v51
    v_mul_u32_u24 v51, 7168, v51
    v_lshl_add_u32 v34, v50, 4, v51
    v_subrev_u32 v34, 2048, v34
    v_add_u32 v48, 192, v1
    v_mul_u32_u24 v49, s91, v48
    v_lshrrev_b32 v49, 16, v49
    v_mul_u32_u24 v50, 14, v49
    v_sub_u32 v50, v48, v50
    v_cmp_lt_u32 vcc, 11, v50
    v_lshlrev_b32 v52, 2, v50
    v_lshrrev_b64 v[52:53], v52, s[82:83]
    v_cndmask_b32 v53, v57, v56, vcc
    v_and_b32 v52, 15, v52
    v_add_u32 v50, v52, v53
    v_and_b32 v51, 0x13, v49
    v_bfe_u32 v52, v49, 2, 1
    v_lshl_or_b32 v51, v52, 3, v51
    v_bfe_u32 v52, v49, 3, 1
    v_lshl_or_b32 v51, v52, 2, v51
    v_mul_u32_u24 v51, 7168, v51
    v_lshl_add_u32 v35, v50, 4, v51
    v_subrev_u32 v35, 3072, v35
    v_add_u32 v48, 256, v1
    v_mul_u32_u24 v49, s91, v48
    v_lshrrev_b32 v49, 16, v49
    v_mul_u32_u24 v50, 14, v49
    v_sub_u32 v50, v48, v50
    v_cmp_lt_u32 vcc, 11, v50
    v_lshlrev_b32 v52, 2, v50
    v_lshrrev_b64 v[52:53], v52, s[82:83]
    v_cndmask_b32 v53, v57, v56, vcc
    v_and_b32 v52, 15, v52
    v_add_u32 v50, v52, v53
    v_and_b32 v51, 0x13, v49
    v_bfe_u32 v52, v49, 2, 1
    v_lshl_or_b32 v51, v52, 3, v51
    v_bfe_u32 v52, v49, 3, 1
    v_lshl_or_b32 v51, v52, 2, v51
    v_mul_u32_u24 v51, 7168, v51
    v_lshl_add_u32 v36, v50, 4, v51
    v_add_u32 v48, 320, v1
    v_mul_u32_u24 v49, s91, v48
    v_lshrrev_b32 v49, 16, v49
    v_mul_u32_u24 v50, 14, v49
    v_sub_u32 v50, v48, v50
    v_cmp_lt_u32 vcc, 11, v50
    v_lshlrev_b32 v52, 2, v50
    v_lshrrev_b64 v[52:53], v52, s[82:83]
    v_cndmask_b32 v53, v57, v56, vcc
    v_and_b32 v52, 15, v52
    v_add_u32 v50, v52, v53
    v_and_b32 v51, 0x13, v49
    v_bfe_u32 v52, v49, 2, 1
    v_lshl_or_b32 v51, v52, 3, v51
    v_bfe_u32 v52, v49, 3, 1
    v_lshl_or_b32 v51, v52, 2, v51
    v_mul_u32_u24 v51, 7168, v51
    v_lshl_add_u32 v37, v50, 4, v51
    v_subrev_u32 v37, 1024, v37
    v_add_u32 v48, 384, v1
    v_mul_u32_u24 v49, s91, v48
    v_lshrrev_b32 v49, 16, v49
    v_mul_u32_u24 v50, 14, v49
    v_sub_u32 v50, v48, v50
    v_cmp_lt_u32 vcc, 11, v50
    v_lshlrev_b32 v52, 2, v50
    v_lshrrev_b64 v[52:53], v52, s[82:83]
    v_cndmask_b32 v53, v57, v56, vcc
    v_and_b32 v52, 15, v52
    v_add_u32 v50, v52, v53
    v_and_b32 v51, 0x13, v49
    v_bfe_u32 v52, v49, 2, 1
    v_lshl_or_b32 v51, v52, 3, v51
    v_bfe_u32 v52, v49, 3, 1
    v_lshl_or_b32 v51, v52, 2, v51
    v_mul_u32_u24 v51, 7168, v51
    v_lshl_add_u32 v38, v50, 4, v51
    v_subrev_u32 v38, 2048, v38
    v_lshrrev_b32 v48, 3, v1
    v_lshlrev_b32 v48, 11, v48
    v_lshrrev_b32 v49, 4, v1
    v_and_b32 v50, 7, v1
    v_xor_b32 v49, v49, v50
    v_lshl_add_u32 v40, v49, 4, v48
    v_xor_b32 v41, 64, v40
    v_add_u32 v47, 111616, v41
    v_add_u32 v46, 96256, v40
    v_add_u32 v45, 80896, v41
    v_add_u32 v44, 65536, v40
    v_add_u32 v43, 46080, v41
    v_add_u32 v42, 30720, v40
    v_add_u32 v41, 15360, v41
    s_cmp_eq_u32 s29, 0
    s_cselect_b64 vcc, -1, 0
    s_cbranch_scc1 La_noswap
    s_mov_b32 s3, s32
    s_mov_b32 s32, s44
    s_mov_b32 s44, s3
    s_mov_b32 s3, s33
    s_mov_b32 s33, s45
    s_mov_b32 s45, s3
    s_mov_b32 s3, s34
    s_mov_b32 s34, s46
    s_mov_b32 s46, s3
    s_mov_b32 s3, s36
    s_mov_b32 s36, s48
    s_mov_b32 s48, s3
    s_mov_b32 s3, s37
    s_mov_b32 s37, s49
    s_mov_b32 s49, s3
    s_mov_b32 s3, s38
    s_mov_b32 s38, s50
    s_mov_b32 s50, s3
    s_mov_b32 s3, s39
    s_mov_b32 s39, s51
    s_mov_b32 s51, s3
    s_mov_b32 s3, s40
    s_mov_b32 s40, s52
    s_mov_b32 s52, s3
    s_mov_b32 s3, s41
    s_mov_b32 s41, s53
    s_mov_b32 s53, s3
    s_mov_b32 s3, s42
    s_mov_b32 s42, s54
    s_mov_b32 s54, s3
La_noswap:
    v_cndmask_b32 v4, v40, v32, vcc
    v_cndmask_b32 v12, v32, v40, vcc
    v_cndmask_b32 v5, v41, v33, vcc
    v_cndmask_b32 v13, v33, v41, vcc
    v_cndmask_b32 v6, v42, v34, vcc
    v_cndmask_b32 v14, v34, v42, vcc
    v_cndmask_b32 v7, v43, v35, vcc
    v_cndmask_b32 v15, v35, v43, vcc
    v_cndmask_b32 v8, v44, v36, vcc
    v_cndmask_b32 v16, v36, v44, vcc
    v_cndmask_b32 v9, v45, v37, vcc
    v_cndmask_b32 v17, v37, v45, vcc
    v_cndmask_b32 v10, v46, v38, vcc
    v_cndmask_b32 v18, v38, v46, vcc
    v_cndmask_b32 v11, v47, v31, vcc
    v_cndmask_b32 v19, v31, v47, vcc
    buffer_load_dword a254, v59, s[72:75], s76 offen
    s_add_u32 s76, s76, s77
    s_cmp_eq_u32 s29, 1
    s_cbranch_scc1 La_skipO
    s_mov_b32 m0, s52
    s_nop 0
    buffer_load_dwordx4 v12, s[44:47], s48 offen lds
    buffer_load_dwordx4 v13, s[44:47], s48 offen offset:1024 lds
    buffer_load_dwordx4 v14, s[44:47], s48 offen offset:2048 lds
    buffer_load_dwordx4 v15, s[44:47], s48 offen offset:3072 lds
    s_add_u32 m0, s52, 4096
    s_add_u32 s52, s52, 32768
    buffer_load_dwordx4 v16, s[44:47], s48 offen lds
    s_cmp_eq_u32 s52, s54
    s_cselect_b32 s52, s53, s52
    buffer_load_dwordx4 v17, s[44:47], s48 offen offset:1024 lds
    buffer_load_dwordx4 v18, s[44:47], s48 offen offset:2048 lds
    buffer_load_dwordx4 v19, s[44:47], s48 offen offset:3072 lds
    s_add_u32 s48, s48, s49
    s_cmp_eq_u32 s48, s51
    s_cselect_b32 s48, s50, s48
La_skipO:
    s_mov_b32 m0, s40
    s_nop 0
    buffer_load_dwordx4 v4, s[32:35], s36 offen lds
    buffer_load_dwordx4 v5, s[32:35], s36 offen offset:1024 lds
    buffer_load_dwordx4 v6, s[32:35], s36 offen offset:2048 lds
    buffer_load_dwordx4 v7, s[32:35], s36 offen offset:3072 lds
    s_add_u32 m0, s40, 4096
    s_add_u32 s40, s40, 32768
    buffer_load_dwordx4 v8, s[32:35], s36 offen lds
    s_cmp_eq_u32 s40, s42
    s_cselect_b32 s40, s41, s40
    buffer_load_dwordx4 v9, s[32:35], s36 offen offset:1024 lds
    buffer_load_dwordx4 v10, s[32:35], s36 offen offset:2048 lds
    buffer_load_dwordx4 v11, s[32:35], s36 offen offset:3072 lds
    s_add_u32 s36, s36, s37
    s_cmp_eq_u32 s36, s39
    s_cselect_b32 s36, s38, s36
    s_mov_b32 m0, s52
    s_nop 0
    buffer_load_dwordx4 v12, s[44:47], s48 offen lds
    buffer_load_dwordx4 v13, s[44:47], s48 offen offset:1024 lds
    buffer_load_dwordx4 v14, s[44:47], s48 offen offset:2048 lds
    buffer_load_dwordx4 v15, s[44:47], s48 offen offset:3072 lds
    s_add_u32 m0, s52, 4096
    s_add_u32 s52, s52, 32768
    buffer_load_dwordx4 v16, s[44:47], s48 offen lds
    s_cmp_eq_u32 s52, s54
    s_cselect_b32 s52, s53, s52
    buffer_load_dwordx4 v17, s[44:47], s48 offen offset:1024 lds
    buffer_load_dwordx4 v18, s[44:47], s48 offen offset:2048 lds
    buffer_load_dwordx4 v19, s[44:47], s48 offen offset:3072 lds
    s_add_u32 s48, s48, s49
    s_cmp_eq_u32 s48, s51
    s_cselect_b32 s48, s50, s48
    v_lshrrev_b32 v48, 5, v1
    v_lshlrev_b32 v48, 4, v48
    v_bfe_u32 v49, v1, 4, 1
    v_lshl_add_u32 v48, v49, 2, v48
    v_bfe_u32 v49, v1, 2, 2
    v_add_u32 v48, v48, v49
    v_mul_u32_u24 v48, 224, v48
    v_add_u32 v48, 98304, v48
    v_and_b32 v49, 3, v1
    v_lshl_add_u32 v20, v49, 3, v48
    s_mul_i32 s3, s29, 96
    v_add_u32 v20, s3, v20
    s_lshl_b32 s3, s29, 3
    s_add_u32 s3, s3, 192
    v_add_u32 v21, s3, v48
    v_and_b32 v50, 1, v49
    v_lshl_add_u32 v21, v50, 4, v21
    v_lshrrev_b32 v49, 1, v49
    v_lshlrev_b32 v49, 13, v49
    v_add_u32 v21, v49, v21
    v_and_b32 v48, 15, v1
    v_lshrrev_b32 v49, 1, v48
    v_lshrrev_b32 v50, 4, v1
    v_xor_b32 v49, v49, v50
    v_lshlrev_b32 v49, 4, v49
    v_lshl_add_u32 v24, v48, 7, v49
    s_lshl_b32 s3, s30, 14
    v_add_u32 v24, s3, v24
    v_xor_b32 v25, 64, v24
    v_mov_b32 v22, v24
    v_mov_b32 v23, v25
    s_mov_b32 s60, 0
    v_lshlrev_b32 v28, 2, v50
    v_and_b32 v49, 3, v48
    v_add_lshl_u32 v28, v28, v49, 4
    v_lshrrev_b32 v49, 3, v48
    v_lshl_add_u32 v28, v49, 10, v28
    v_bfe_u32 v49, v48, 2, 1
    v_lshl_add_u32 v28, v49, 3, v28
    s_lshl_b32 s3, s30, 24
    v_add_u32 v28, s3, v28
    v_mov_b32 v49, 0x3f803f80
    v_accvgpr_write_b32 a188, v49
    v_accvgpr_write_b32 a189, v49
    v_accvgpr_write_b32 a190, v49
    v_accvgpr_write_b32 a191, v49
    s_mov_b32 s64, s4
    s_mov_b32 s65, s5
    s_mov_b32 s66, 4194304
    s_mov_b32 s67, 0x00020000
    s_mov_b32 s68, s16
    s_mov_b32 s69, s17
    s_mov_b32 s70, 256
    s_mov_b32 s71, 0x00020000
    s_mov_b32 s12, s8
    s_mov_b32 s13, s9
    s_mov_b32 s14, 0
    s_mov_b32 s15, 0x00020000
La_pc2:
    s_lshl_b32 s3, s26, 1
    s_add_u32 s3, s3, s29
    s_lshl_b32 s3, s3, 12
    s_add_u32 s78, s3, 65536
    s_lshr_b32 s3, s25, 1
    s_lshl_b32 s3, s3, 8
    s_add_u32 s79, s78, s3
    s_and_b32 s3, s25, 1
    s_lshl_b32 s3, s3, 2
    s_add_u32 s79, s79, s3
    s_lshl_b32 s80, s62, 12
    s_add_u32 s28, s28, 1
    s_mov_b32 s61, 0
    v_lshlrev_b32 v255, 7, v1
    v_cmp_lt_u32 vcc, 31, v1
    v_add_u32 v255, s80, v255
    s_nop 0
    v_cndmask_b32 v255, v255, v31, vcc
    buffer_load_dword a254, v26, s[72:75], s76 offen
    s_add_u32 s76, s76, s77
    s_waitcnt vmcnt(9)
    s_barrier
    ds_read_b128 a[28:31], v22 offset:0
    ds_read_b128 a[32:35], v22 offset:2048
    ds_read_b128 a[36:39], v22 offset:4096
    ds_read_b128 a[40:43], v22 offset:6144
    ds_read_b128 a[44:47], v22 offset:8192
    ds_read_b128 a[48:51], v22 offset:10240
    ds_read_b128 a[52:55], v22 offset:12288
    ds_read_b128 a[56:59], v22 offset:14336
    ds_read_b64_tr_b16 a[0:1], v20 offset:0
    ds_read_b64_tr_b16 a[2:3], v20 offset:1792
    ds_read_b64_tr_b16 a[4:5], v20 offset:32
    ds_read_b64_tr_b16 a[6:7], v20 offset:1824
    ds_read_b64_tr_b16 a[8:9], v20 offset:64
    ds_read_b64_tr_b16 a[10:11], v20 offset:1856
    ds_read_b64_tr_b16 a[12:13], v20 offset:8192
    ds_read_b64_tr_b16 a[14:15], v20 offset:9984
    ds_read_b64_tr_b16 a[16:17], v20 offset:8224
    ds_read_b64_tr_b16 a[18:19], v20 offset:10016
    ds_read_b64_tr_b16 a[20:21], v20 offset:8256
    ds_read_b64_tr_b16 a[22:23], v20 offset:10048
    ds_read_b64_tr_b16 a[24:25], v21 offset:0
    ds_read_b64_tr_b16 a[26:27], v21 offset:1792
    v_add_u32 v29, 1, v29
    v_or_b32 v29, 0x80000000, v29
    buffer_store_dword v29, v3, s[56:59], s63 offen sc1
    buffer_store_dword v29, v3, s[68:71], 0 offen sc1
    s_waitcnt vmcnt(3)
    s_waitcnt lgkmcnt(0)
    s_barrier
    v_mfma_f32_16x16x32_bf16 v[32:35], a[0:3], a[28:31], 0
    ds_read_b128 a[88:91], v23 offset:0
    v_mfma_f32_16x16x32_bf16 v[36:39], a[0:3], a[32:35], 0
    ds_read_b128 a[92:95], v23 offset:2048
    v_mfma_f32_16x16x32_bf16 v[40:43], a[0:3], a[36:39], 0
    s_mov_b32 m0, s40
    s_nop 0
    buffer_load_dwordx4 v4, s[32:35], s36 offen lds
    v_mfma_f32_16x16x32_bf16 v[44:47], a[0:3], a[40:43], 0
    ds_read_b128 a[96:99], v23 offset:4096
    v_mfma_f32_16x16x32_bf16 v[48:51], a[0:3], a[44:47], 0
    ds_read_b128 a[100:103], v23 offset:6144
    v_mfma_f32_16x16x32_bf16 v[52:55], a[0:3], a[48:51], 0
    buffer_load_dwordx4 v5, s[32:35], s36 offen offset:1024 lds
    v_mfma_f32_16x16x32_bf16 v[56:59], a[0:3], a[52:55], 0
    ds_read_b128 a[104:107], v23 offset:8192
    v_mfma_f32_16x16x32_bf16 v[60:63], a[0:3], a[56:59], 0
    ds_read_b128 a[108:111], v23 offset:10240
    v_mfma_f32_16x16x32_bf16 v[64:67], a[4:7], a[28:31], 0
    buffer_load_dwordx4 v6, s[32:35], s36 offen offset:2048 lds
    v_mfma_f32_16x16x32_bf16 v[68:71], a[4:7], a[32:35], 0
    ds_read_b128 a[112:115], v23 offset:12288
    v_mfma_f32_16x16x32_bf16 v[72:75], a[4:7], a[36:39], 0
    ds_read_b128 a[116:119], v23 offset:14336
    v_mfma_f32_16x16x32_bf16 v[76:79], a[4:7], a[40:43], 0
    buffer_load_dwordx4 v7, s[32:35], s36 offen offset:3072 lds
    v_mfma_f32_16x16x32_bf16 v[80:83], a[4:7], a[44:47], 0
    ds_read_b64_tr_b16 a[60:61], v20 offset:16384
    v_mfma_f32_16x16x32_bf16 v[84:87], a[4:7], a[48:51], 0
    ds_read_b64_tr_b16 a[62:63], v20 offset:18176
    v_mfma_f32_16x16x32_bf16 v[88:91], a[4:7], a[52:55], 0
    s_add_u32 m0, s40, 4096
    s_add_u32 s40, s40, 32768
    buffer_load_dwordx4 v8, s[32:35], s36 offen lds
    v_mfma_f32_16x16x32_bf16 v[92:95], a[4:7], a[56:59], 0
    ds_read_b64_tr_b16 a[64:65], v20 offset:16416
    v_mfma_f32_16x16x32_bf16 v[96:99], a[8:11], a[28:31], 0
    ds_read_b64_tr_b16 a[66:67], v20 offset:18208
    v_mfma_f32_16x16x32_bf16 v[100:103], a[8:11], a[32:35], 0
    s_cmp_eq_u32 s40, s42
    s_cselect_b32 s40, s41, s40
    buffer_load_dwordx4 v9, s[32:35], s36 offen offset:1024 lds
    v_mfma_f32_16x16x32_bf16 v[104:107], a[8:11], a[36:39], 0
    ds_read_b64_tr_b16 a[68:69], v20 offset:16448
    v_mfma_f32_16x16x32_bf16 v[108:111], a[8:11], a[40:43], 0
    ds_read_b64_tr_b16 a[70:71], v20 offset:18240
    v_mfma_f32_16x16x32_bf16 v[112:115], a[8:11], a[44:47], 0
    buffer_load_dwordx4 v10, s[32:35], s36 offen offset:2048 lds
    v_mfma_f32_16x16x32_bf16 v[116:119], a[8:11], a[48:51], 0
    v_mfma_f32_16x16x32_bf16 v[120:123], a[8:11], a[52:55], 0
    ds_read_b64_tr_b16 a[72:73], v20 offset:24576
    v_mfma_f32_16x16x32_bf16 v[124:127], a[8:11], a[56:59], 0
    ds_read_b64_tr_b16 a[74:75], v20 offset:26368
    v_mfma_f32_16x16x32_bf16 v[128:131], a[12:15], a[28:31], 0
    buffer_load_dwordx4 v11, s[32:35], s36 offen offset:3072 lds
    s_add_u32 s36, s36, s37
    s_cmp_eq_u32 s36, s39
    s_cselect_b32 s36, s38, s36
    v_mfma_f32_16x16x32_bf16 v[132:135], a[12:15], a[32:35], 0
    ds_read_b64_tr_b16 a[76:77], v20 offset:24608
    v_mfma_f32_16x16x32_bf16 v[136:139], a[12:15], a[36:39], 0
    ds_read_b64_tr_b16 a[78:79], v20 offset:26400
    v_mfma_f32_16x16x32_bf16 v[140:143], a[12:15], a[40:43], 0
    s_mov_b32 m0, s52
    s_nop 0
    buffer_load_dwordx4 v12, s[44:47], s48 offen lds
    v_mfma_f32_16x16x32_bf16 v[144:147], a[12:15], a[44:47], 0
    ds_read_b64_tr_b16 a[80:81], v20 offset:24640
    v_mfma_f32_16x16x32_bf16 v[148:151], a[12:15], a[48:51], 0
    ds_read_b64_tr_b16 a[82:83], v20 offset:26432
    v_mfma_f32_16x16x32_bf16 v[152:155], a[12:15], a[52:55], 0
    buffer_load_dwordx4 v13, s[44:47], s48 offen offset:1024 lds
    v_mfma_f32_16x16x32_bf16 v[156:159], a[12:15], a[56:59], 0
    ds_read_b64_tr_b16 a[84:85], v21 offset:16384
    v_mfma_f32_16x16x32_bf16 v[160:163], a[16:19], a[28:31], 0
    ds_read_b64_tr_b16 a[86:87], v21 offset:18176
    v_mfma_f32_16x16x32_bf16 v[164:167], a[16:19], a[32:35], 0
    buffer_load_dwordx4 v14, s[44:47], s48 offen offset:2048 lds
    v_mfma_f32_16x16x32_bf16 v[168:171], a[16:19], a[36:39], 0
    buffer_load_dwordx4 v15, s[44:47], s48 offen offset:3072 lds
    v_mfma_f32_16x16x32_bf16 v[172:175], a[16:19], a[40:43], 0
    s_add_u32 m0, s52, 4096
    s_add_u32 s52, s52, 32768
    buffer_load_dwordx4 v16, s[44:47], s48 offen lds
    v_mfma_f32_16x16x32_bf16 v[176:179], a[16:19], a[44:47], 0
    s_cmp_eq_u32 s52, s54
    s_cselect_b32 s52, s53, s52
    buffer_load_dwordx4 v17, s[44:47], s48 offen offset:1024 lds
    v_mfma_f32_16x16x32_bf16 v[180:183], a[16:19], a[48:51], 0
    buffer_load_dwordx4 v18, s[44:47], s48 offen offset:2048 lds
    v_mfma_f32_16x16x32_bf16 v[184:187], a[16:19], a[52:55], 0
    buffer_load_dwordx4 v19, s[44:47], s48 offen offset:3072 lds
    s_add_u32 s48, s48, s49
    s_cmp_eq_u32 s48, s51
    s_cselect_b32 s48, s50, s48
    v_mfma_f32_16x16x32_bf16 v[188:191], a[16:19], a[56:59], 0
    buffer_load_dwordx4 a[192:195], v2, s[64:67], s80 offen offset:0
    v_mfma_f32_16x16x32_bf16 v[192:195], a[20:23], a[28:31], 0
    buffer_load_dwordx4 a[196:199], v2, s[64:67], s80 offen offset:1024
    v_mfma_f32_16x16x32_bf16 v[196:199], a[20:23], a[32:35], 0
    buffer_load_dwordx4 a[200:203], v2, s[64:67], s80 offen offset:2048
    v_mfma_f32_16x16x32_bf16 v[200:203], a[20:23], a[36:39], 0
    buffer_load_dwordx4 a[204:207], v2, s[64:67], s80 offen offset:3072
    v_mfma_f32_16x16x32_bf16 v[204:207], a[20:23], a[40:43], 0
    v_mfma_f32_16x16x32_bf16 v[208:211], a[20:23], a[44:47], 0
    v_mfma_f32_16x16x32_bf16 v[212:215], a[20:23], a[48:51], 0
    v_mfma_f32_16x16x32_bf16 v[216:219], a[20:23], a[52:55], 0
    v_mfma_f32_16x16x32_bf16 v[220:223], a[20:23], a[56:59], 0
    v_mfma_f32_16x16x32_bf16 a[128:131], a[24:27], a[28:31], 0
    v_mfma_f32_16x16x32_bf16 a[132:135], a[24:27], a[32:35], 0
    v_mfma_f32_16x16x32_bf16 a[136:139], a[24:27], a[36:39], 0
    v_mfma_f32_16x16x32_bf16 a[140:143], a[24:27], a[40:43], 0
    v_mfma_f32_16x16x32_bf16 a[144:147], a[24:27], a[44:47], 0
    v_mfma_f32_16x16x32_bf16 a[148:151], a[24:27], a[48:51], 0
    s_waitcnt vmcnt(12)
    v_mfma_f32_16x16x32_bf16 a[152:155], a[24:27], a[52:55], 0
    v_mfma_f32_16x16x32_bf16 a[156:159], a[24:27], a[56:59], 0
    s_waitcnt lgkmcnt(0)
    s_barrier
    v_mfma_f32_16x16x32_bf16 v[32:35], a[60:63], a[88:91], v[32:35]
    s_add_u32 s60, s60, 32768
    s_cmp_eq_u32 s60, 98304
    s_cselect_b32 s60, 0, s60
    v_mfma_f32_16x16x32_bf16 v[36:39], a[60:63], a[92:95], v[36:39]
    v_add_u32 v22, s60, v24
    v_add_u32 v23, s60, v25
    v_mfma_f32_16x16x32_bf16 v[40:43], a[60:63], a[96:99], v[40:43]
    ds_read_b128 a[28:31], v22 offset:0
    v_mfma_f32_16x16x32_bf16 v[44:47], a[60:63], a[100:103], v[44:47]
    ds_read_b128 a[32:35], v22 offset:2048
    v_mfma_f32_16x16x32_bf16 v[48:51], a[60:63], a[104:107], v[48:51]
    v_mfma_f32_16x16x32_bf16 v[52:55], a[60:63], a[108:111], v[52:55]
    s_mov_b32 m0, s40
    s_nop 0
    buffer_load_dwordx4 v4, s[32:35], s36 offen lds
    v_mfma_f32_16x16x32_bf16 v[56:59], a[60:63], a[112:115], v[56:59]
    ds_read_b128 a[36:39], v22 offset:4096
    v_mfma_f32_16x16x32_bf16 v[60:63], a[60:63], a[116:119], v[60:63]
    ds_read_b128 a[40:43], v22 offset:6144
    v_mfma_f32_16x16x32_bf16 v[64:67], a[64:67], a[88:91], v[64:67]
    buffer_load_dwordx4 v5, s[32:35], s36 offen offset:1024 lds
    v_mfma_f32_16x16x32_bf16 v[68:71], a[64:67], a[92:95], v[68:71]
    v_mfma_f32_16x16x32_bf16 v[72:75], a[64:67], a[96:99], v[72:75]
    ds_read_b128 a[44:47], v22 offset:8192
    v_mfma_f32_16x16x32_bf16 v[76:79], a[64:67], a[100:103], v[76:79]
    ds_read_b128 a[48:51], v22 offset:10240
    v_mfma_f32_16x16x32_bf16 v[80:83], a[64:67], a[104:107], v[80:83]
    buffer_load_dwordx4 v6, s[32:35], s36 offen offset:2048 lds
    v_mfma_f32_16x16x32_bf16 v[84:87], a[64:67], a[108:111], v[84:87]
    ds_read_b128 a[52:55], v22 offset:12288
    v_mfma_f32_16x16x32_bf16 v[88:91], a[64:67], a[112:115], v[88:91]
    v_mfma_f32_16x16x32_bf16 v[92:95], a[64:67], a[116:119], v[92:95]
    ds_read_b128 a[56:59], v22 offset:14336
    v_mfma_f32_16x16x32_bf16 v[96:99], a[68:71], a[88:91], v[96:99]
    buffer_load_dwordx4 v7, s[32:35], s36 offen offset:3072 lds
    v_mfma_f32_16x16x32_bf16 v[100:103], a[68:71], a[92:95], v[100:103]
    ds_read_b64_tr_b16 a[0:1], v20 offset:32768
    v_mfma_f32_16x16x32_bf16 v[104:107], a[68:71], a[96:99], v[104:107]
    ds_read_b64_tr_b16 a[2:3], v20 offset:34560
    v_mfma_f32_16x16x32_bf16 v[108:111], a[68:71], a[100:103], v[108:111]
    v_mfma_f32_16x16x32_bf16 v[112:115], a[68:71], a[104:107], v[112:115]
    s_add_u32 m0, s40, 4096
    s_add_u32 s40, s40, 32768
    buffer_load_dwordx4 v8, s[32:35], s36 offen lds
    v_mfma_f32_16x16x32_bf16 v[116:119], a[68:71], a[108:111], v[116:119]
    ds_read_b64_tr_b16 a[4:5], v20 offset:32800
    v_mfma_f32_16x16x32_bf16 v[120:123], a[68:71], a[112:115], v[120:123]
    ds_read_b64_tr_b16 a[6:7], v20 offset:34592
    v_mfma_f32_16x16x32_bf16 v[124:127], a[68:71], a[116:119], v[124:127]
    s_cmp_eq_u32 s40, s42
    s_cselect_b32 s40, s41, s40
    buffer_load_dwordx4 v9, s[32:35], s36 offen offset:1024 lds
    v_mfma_f32_16x16x32_bf16 v[128:131], a[72:75], a[88:91], v[128:131]
    v_mfma_f32_16x16x32_bf16 v[132:135], a[72:75], a[92:95], v[132:135]
    ds_read_b64_tr_b16 a[8:9], v20 offset:32832
    v_mfma_f32_16x16x32_bf16 v[136:139], a[72:75], a[96:99], v[136:139]
    ds_read_b64_tr_b16 a[10:11], v20 offset:34624
    v_mfma_f32_16x16x32_bf16 v[140:143], a[72:75], a[100:103], v[140:143]
    buffer_load_dwordx4 v10, s[32:35], s36 offen offset:2048 lds
    v_mfma_f32_16x16x32_bf16 v[144:147], a[72:75], a[104:107], v[144:147]
    ds_read_b64_tr_b16 a[12:13], v20 offset:40960
    v_mfma_f32_16x16x32_bf16 v[148:151], a[72:75], a[108:111], v[148:151]
    v_mfma_f32_16x16x32_bf16 v[152:155], a[72:75], a[112:115], v[152:155]
    ds_read_b64_tr_b16 a[14:15], v20 offset:42752
    v_mfma_f32_16x16x32_bf16 v[156:159], a[72:75], a[116:119], v[156:159]
    buffer_load_dwordx4 v11, s[32:35], s36 offen offset:3072 lds
    s_add_u32 s36, s36, s37
    s_cmp_eq_u32 s36, s39
    s_cselect_b32 s36, s38, s36
    v_mfma_f32_16x16x32_bf16 v[160:163], a[76:79], a[88:91], v[160:163]
    ds_read_b64_tr_b16 a[16:17], v20 offset:40992
    v_mfma_f32_16x16x32_bf16 v[164:167], a[76:79], a[92:95], v[164:167]
    ds_read_b64_tr_b16 a[18:19], v20 offset:42784
    v_mfma_f32_16x16x32_bf16 v[168:171], a[76:79], a[96:99], v[168:171]
    v_mfma_f32_16x16x32_bf16 v[172:175], a[76:79], a[100:103], v[172:175]
    s_mov_b32 m0, s52
    s_nop 0
    buffer_load_dwordx4 v12, s[44:47], s48 offen lds
    v_mfma_f32_16x16x32_bf16 v[176:179], a[76:79], a[104:107], v[176:179]
    ds_read_b64_tr_b16 a[20:21], v20 offset:41024
    v_mfma_f32_16x16x32_bf16 v[180:183], a[76:79], a[108:111], v[180:183]
    ds_read_b64_tr_b16 a[22:23], v20 offset:42816
    v_mfma_f32_16x16x32_bf16 v[184:187], a[76:79], a[112:115], v[184:187]
    buffer_load_dwordx4 v13, s[44:47], s48 offen offset:1024 lds
    v_mfma_f32_16x16x32_bf16 v[188:191], a[76:79], a[116:119], v[188:191]
    v_mfma_f32_16x16x32_bf16 v[192:195], a[80:83], a[88:91], v[192:195]
    ds_read_b64_tr_b16 a[24:25], v21 offset:32768
    v_mfma_f32_16x16x32_bf16 v[196:199], a[80:83], a[92:95], v[196:199]
    ds_read_b64_tr_b16 a[26:27], v21 offset:34560
    v_mfma_f32_16x16x32_bf16 v[200:203], a[80:83], a[96:99], v[200:203]
    buffer_load_dwordx4 v14, s[44:47], s48 offen offset:2048 lds
    v_mfma_f32_16x16x32_bf16 v[204:207], a[80:83], a[100:103], v[204:207]
    v_mfma_f32_16x16x32_bf16 v[208:211], a[80:83], a[104:107], v[208:211]
    v_mfma_f32_16x16x32_bf16 v[212:215], a[80:83], a[108:111], v[212:215]
    v_mfma_f32_16x16x32_bf16 v[216:219], a[80:83], a[112:115], v[216:219]
    v_mfma_f32_16x16x32_bf16 v[220:223], a[80:83], a[116:119], v[220:223]
    v_mfma_f32_16x16x32_bf16 a[128:131], a[84:87], a[88:91], a[128:131]
    v_mfma_f32_16x16x32_bf16 a[132:135], a[84:87], a[92:95], a[132:135]
    v_mfma_f32_16x16x32_bf16 a[136:139], a[84:87], a[96:99], a[136:139]
    v_mfma_f32_16x16x32_bf16 a[140:143], a[84:87], a[100:103], a[140:143]
    v_mfma_f32_16x16x32_bf16 a[144:147], a[84:87], a[104:107], a[144:147]
    v_mfma_f32_16x16x32_bf16 a[148:151], a[84:87], a[108:111], a[148:151]
    s_waitcnt vmcnt(15)
    v_mfma_f32_16x16x32_bf16 a[152:155], a[84:87], a[112:115], a[152:155]
    v_mfma_f32_16x16x32_bf16 a[156:159], a[84:87], a[116:119], a[156:159]
    s_waitcnt lgkmcnt(0)
    s_barrier
    v_mfma_f32_16x16x32_bf16 v[32:35], a[0:3], a[28:31], v[32:35]
    ds_read_b128 a[88:91], v23 offset:0
    v_mfma_f32_16x16x32_bf16 v[36:39], a[0:3], a[32:35], v[36:39]
    ds_read_b128 a[92:95], v23 offset:2048
    v_mfma_f32_16x16x32_bf16 v[40:43], a[0:3], a[36:39], v[40:43]
    buffer_load_dwordx4 v15, s[44:47], s48 offen offset:3072 lds
    v_mfma_f32_16x16x32_bf16 v[44:47], a[0:3], a[40:43], v[44:47]
    v_mfma_f32_16x16x32_bf16 v[48:51], a[0:3], a[44:47], v[48:51]
    ds_read_b128 a[96:99], v23 offset:4096
    v_mfma_f32_16x16x32_bf16 v[52:55], a[0:3], a[48:51], v[52:55]
    ds_read_b128 a[100:103], v23 offset:6144
    v_mfma_f32_16x16x32_bf16 v[56:59], a[0:3], a[52:55], v[56:59]
    s_add_u32 m0, s52, 4096
    s_add_u32 s52, s52, 32768
    buffer_load_dwordx4 v16, s[44:47], s48 offen lds
    v_mfma_f32_16x16x32_bf16 v[60:63], a[0:3], a[56:59], v[60:63]
    v_mfma_f32_16x16x32_bf16 v[64:67], a[4:7], a[28:31], v[64:67]
    ds_read_b128 a[104:107], v23 offset:8192
    v_mfma_f32_16x16x32_bf16 v[68:71], a[4:7], a[32:35], v[68:71]
    ds_read_b128 a[108:111], v23 offset:10240
    v_mfma_f32_16x16x32_bf16 v[72:75], a[4:7], a[36:39], v[72:75]
    v_mfma_f32_16x16x32_bf16 v[76:79], a[4:7], a[40:43], v[76:79]
    s_cmp_eq_u32 s52, s54
    s_cselect_b32 s52, s53, s52
    buffer_load_dwordx4 v17, s[44:47], s48 offen offset:1024 lds
    v_mfma_f32_16x16x32_bf16 v[80:83], a[4:7], a[44:47], v[80:83]
    ds_read_b128 a[112:115], v23 offset:12288
    v_mfma_f32_16x16x32_bf16 v[84:87], a[4:7], a[48:51], v[84:87]
    ds_read_b128 a[116:119], v23 offset:14336
    v_mfma_f32_16x16x32_bf16 v[88:91], a[4:7], a[52:55], v[88:91]
    v_mfma_f32_16x16x32_bf16 v[92:95], a[4:7], a[56:59], v[92:95]
    buffer_load_dwordx4 v18, s[44:47], s48 offen offset:2048 lds
    v_mfma_f32_16x16x32_bf16 v[96:99], a[8:11], a[28:31], v[96:99]
    ds_read_b64_tr_b16 a[60:61], v20 offset:49152
    v_mfma_f32_16x16x32_bf16 v[100:103], a[8:11], a[32:35], v[100:103]
    ds_read_b64_tr_b16 a[62:63], v20 offset:50944
    v_mfma_f32_16x16x32_bf16 v[104:107], a[8:11], a[36:39], v[104:107]
    v_mfma_f32_16x16x32_bf16 v[108:111], a[8:11], a[40:43], v[108:111]
    buffer_load_dwordx4 v19, s[44:47], s48 offen offset:3072 lds
    s_add_u32 s48, s48, s49
    s_cmp_eq_u32 s48, s51
    s_cselect_b32 s48, s50, s48
    v_mfma_f32_16x16x32_bf16 v[112:115], a[8:11], a[44:47], v[112:115]
    ds_read_b64_tr_b16 a[64:65], v20 offset:49184
    v_mfma_f32_16x16x32_bf16 v[116:119], a[8:11], a[48:51], v[116:119]
    v_mfma_f32_16x16x32_bf16 v[120:123], a[8:11], a[52:55], v[120:123]
    ds_read_b64_tr_b16 a[66:67], v20 offset:50976
    v_mfma_f32_16x16x32_bf16 v[124:127], a[8:11], a[56:59], v[124:127]
    s_mov_b32 m0, s40
    s_nop 0
    buffer_load_dwordx4 v4, s[32:35], s36 offen lds
    v_mfma_f32_16x16x32_bf16 v[128:131], a[12:15], a[28:31], v[128:131]
    ds_read_b64_tr_b16 a[68:69], v20 offset:49216
    v_mfma_f32_16x16x32_bf16 v[132:135], a[12:15], a[32:35], v[132:135]
    v_mfma_f32_16x16x32_bf16 v[136:139], a[12:15], a[36:39], v[136:139]
    ds_read_b64_tr_b16 a[70:71], v20 offset:51008
    v_mfma_f32_16x16x32_bf16 v[140:143], a[12:15], a[40:43], v[140:143]
    buffer_load_dwordx4 v5, s[32:35], s36 offen offset:1024 lds
    v_mfma_f32_16x16x32_bf16 v[144:147], a[12:15], a[44:47], v[144:147]
    ds_read_b64_tr_b16 a[72:73], v20 offset:57344
    v_mfma_f32_16x16x32_bf16 v[148:151], a[12:15], a[48:51], v[148:151]
    v_mfma_f32_16x16x32_bf16 v[152:155], a[12:15], a[52:55], v[152:155]
    ds_read_b64_tr_b16 a[74:75], v20 offset:59136
    v_mfma_f32_16x16x32_bf16 v[156:159], a[12:15], a[56:59], v[156:159]
    buffer_load_dwordx4 v6, s[32:35], s36 offen offset:2048 lds
    v_mfma_f32_16x16x32_bf16 v[160:163], a[16:19], a[28:31], v[160:163]
    v_mfma_f32_16x16x32_bf16 v[164:167], a[16:19], a[32:35], v[164:167]
    ds_read_b64_tr_b16 a[76:77], v20 offset:57376
    v_mfma_f32_16x16x32_bf16 v[168:171], a[16:19], a[36:39], v[168:171]
    ds_read_b64_tr_b16 a[78:79], v20 offset:59168
    v_mfma_f32_16x16x32_bf16 v[172:175], a[16:19], a[40:43], v[172:175]
    buffer_load_dwordx4 v7, s[32:35], s36 offen offset:3072 lds
    v_mfma_f32_16x16x32_bf16 v[176:179], a[16:19], a[44:47], v[176:179]
    v_mfma_f32_16x16x32_bf16 v[180:183], a[16:19], a[48:51], v[180:183]
    ds_read_b64_tr_b16 a[80:81], v20 offset:57408
    v_mfma_f32_16x16x32_bf16 v[184:187], a[16:19], a[52:55], v[184:187]
    ds_read_b64_tr_b16 a[82:83], v20 offset:59200
    v_mfma_f32_16x16x32_bf16 v[188:191], a[16:19], a[56:59], v[188:191]
    s_add_u32 m0, s40, 4096
    s_add_u32 s40, s40, 32768
    buffer_load_dwordx4 v8, s[32:35], s36 offen lds
    v_mfma_f32_16x16x32_bf16 v[192:195], a[20:23], a[28:31], v[192:195]
    v_mfma_f32_16x16x32_bf16 v[196:199], a[20:23], a[32:35], v[196:199]
    ds_read_b64_tr_b16 a[84:85], v21 offset:49152
    v_mfma_f32_16x16x32_bf16 v[200:203], a[20:23], a[36:39], v[200:203]
    ds_read_b64_tr_b16 a[86:87], v21 offset:50944
    v_mfma_f32_16x16x32_bf16 v[204:207], a[20:23], a[40:43], v[204:207]
    v_mfma_f32_16x16x32_bf16 v[208:211], a[20:23], a[44:47], v[208:211]
    v_mfma_f32_16x16x32_bf16 v[212:215], a[20:23], a[48:51], v[212:215]
    v_mfma_f32_16x16x32_bf16 v[216:219], a[20:23], a[52:55], v[216:219]
    v_mfma_f32_16x16x32_bf16 v[220:223], a[20:23], a[56:59], v[220:223]
    v_mfma_f32_16x16x32_bf16 a[128:131], a[24:27], a[28:31], a[128:131]
    v_mfma_f32_16x16x32_bf16 a[132:135], a[24:27], a[32:35], a[132:135]
    v_mfma_f32_16x16x32_bf16 a[136:139], a[24:27], a[36:39], a[136:139]
    v_mfma_f32_16x16x32_bf16 a[140:143], a[24:27], a[40:43], a[140:143]
    v_mfma_f32_16x16x32_bf16 a[144:147], a[24:27], a[44:47], a[144:147]
    v_mfma_f32_16x16x32_bf16 a[148:151], a[24:27], a[48:51], a[148:151]
    s_waitcnt vmcnt(13)
    v_mfma_f32_16x16x32_bf16 a[152:155], a[24:27], a[52:55], a[152:155]
    v_mfma_f32_16x16x32_bf16 a[156:159], a[24:27], a[56:59], a[156:159]
    s_waitcnt lgkmcnt(0)
    s_barrier
    v_mfma_f32_16x16x32_bf16 v[32:35], a[60:63], a[88:91], v[32:35]
    s_add_u32 s60, s60, 32768
    s_cmp_eq_u32 s60, 98304
    s_cselect_b32 s60, 0, s60
    v_mfma_f32_16x16x32_bf16 v[36:39], a[60:63], a[92:95], v[36:39]
    v_add_u32 v22, s60, v24
    v_add_u32 v23, s60, v25
    v_mfma_f32_16x16x32_bf16 v[40:43], a[60:63], a[96:99], v[40:43]
    ds_read_b128 a[28:31], v22 offset:0
    v_mfma_f32_16x16x32_bf16 v[44:47], a[60:63], a[100:103], v[44:47]
    ds_read_b128 a[32:35], v22 offset:2048
    v_mfma_f32_16x16x32_bf16 v[48:51], a[60:63], a[104:107], v[48:51]
    v_mfma_f32_16x16x32_bf16 v[52:55], a[60:63], a[108:111], v[52:55]
    s_cmp_eq_u32 s40, s42
    s_cselect_b32 s40, s41, s40
    buffer_load_dwordx4 v9, s[32:35], s36 offen offset:1024 lds
    v_mfma_f32_16x16x32_bf16 v[56:59], a[60:63], a[112:115], v[56:59]
    ds_read_b128 a[36:39], v22 offset:4096
    v_mfma_f32_16x16x32_bf16 v[60:63], a[60:63], a[116:119], v[60:63]
    ds_read_b128 a[40:43], v22 offset:6144
    v_mfma_f32_16x16x32_bf16 v[64:67], a[64:67], a[88:91], v[64:67]
    buffer_load_dwordx4 v10, s[32:35], s36 offen offset:2048 lds
    v_mfma_f32_16x16x32_bf16 v[68:71], a[64:67], a[92:95], v[68:71]
    v_mfma_f32_16x16x32_bf16 v[72:75], a[64:67], a[96:99], v[72:75]
    ds_read_b128 a[44:47], v22 offset:8192
    v_mfma_f32_16x16x32_bf16 v[76:79], a[64:67], a[100:103], v[76:79]
    ds_read_b128 a[48:51], v22 offset:10240
    v_mfma_f32_16x16x32_bf16 v[80:83], a[64:67], a[104:107], v[80:83]
    buffer_load_dwordx4 v11, s[32:35], s36 offen offset:3072 lds
    s_add_u32 s36, s36, s37
    s_cmp_eq_u32 s36, s39
    s_cselect_b32 s36, s38, s36
    v_mfma_f32_16x16x32_bf16 v[84:87], a[64:67], a[108:111], v[84:87]
    ds_read_b128 a[52:55], v22 offset:12288
    v_mfma_f32_16x16x32_bf16 v[88:91], a[64:67], a[112:115], v[88:91]
    v_mfma_f32_16x16x32_bf16 v[92:95], a[64:67], a[116:119], v[92:95]
    ds_read_b128 a[56:59], v22 offset:14336
    v_mfma_f32_16x16x32_bf16 v[96:99], a[68:71], a[88:91], v[96:99]
    s_mov_b32 m0, s52
    s_nop 0
    buffer_load_dwordx4 v12, s[44:47], s48 offen lds
    v_mfma_f32_16x16x32_bf16 v[100:103], a[68:71], a[92:95], v[100:103]
    ds_read_b64_tr_b16 a[0:1], v20 offset:0
    v_mfma_f32_16x16x32_bf16 v[104:107], a[68:71], a[96:99], v[104:107]
    ds_read_b64_tr_b16 a[2:3], v20 offset:1792
    v_mfma_f32_16x16x32_bf16 v[108:111], a[68:71], a[100:103], v[108:111]
    v_mfma_f32_16x16x32_bf16 v[112:115], a[68:71], a[104:107], v[112:115]
    buffer_load_dwordx4 v13, s[44:47], s48 offen offset:1024 lds
    v_mfma_f32_16x16x32_bf16 v[116:119], a[68:71], a[108:111], v[116:119]
    ds_read_b64_tr_b16 a[4:5], v20 offset:32
    v_mfma_f32_16x16x32_bf16 v[120:123], a[68:71], a[112:115], v[120:123]
    ds_read_b64_tr_b16 a[6:7], v20 offset:1824
    v_mfma_f32_16x16x32_bf16 v[124:127], a[68:71], a[116:119], v[124:127]
    buffer_load_dwordx4 v14, s[44:47], s48 offen offset:2048 lds
    v_mfma_f32_16x16x32_bf16 v[128:131], a[72:75], a[88:91], v[128:131]
    v_mfma_f32_16x16x32_bf16 v[132:135], a[72:75], a[92:95], v[132:135]
    ds_read_b64_tr_b16 a[8:9], v20 offset:64
    v_mfma_f32_16x16x32_bf16 v[136:139], a[72:75], a[96:99], v[136:139]
    ds_read_b64_tr_b16 a[10:11], v20 offset:1856
    v_mfma_f32_16x16x32_bf16 v[140:143], a[72:75], a[100:103], v[140:143]
    buffer_load_dwordx4 v15, s[44:47], s48 offen offset:3072 lds
    v_mfma_f32_16x16x32_bf16 v[144:147], a[72:75], a[104:107], v[144:147]
    ds_read_b64_tr_b16 a[12:13], v20 offset:8192
    v_mfma_f32_16x16x32_bf16 v[148:151], a[72:75], a[108:111], v[148:151]
    v_mfma_f32_16x16x32_bf16 v[152:155], a[72:75], a[112:115], v[152:155]
    ds_read_b64_tr_b16 a[14:15], v20 offset:9984
    v_mfma_f32_16x16x32_bf16 v[156:159], a[72:75], a[116:119], v[156:159]
    s_add_u32 m0, s52, 4096
    s_add_u32 s52, s52, 32768
    buffer_load_dwordx4 v16, s[44:47], s48 offen lds
    v_mfma_f32_16x16x32_bf16 v[160:163], a[76:79], a[88:91], v[160:163]
    ds_read_b64_tr_b16 a[16:17], v20 offset:8224
    v_mfma_f32_16x16x32_bf16 v[164:167], a[76:79], a[92:95], v[164:167]
    ds_read_b64_tr_b16 a[18:19], v20 offset:10016
    v_mfma_f32_16x16x32_bf16 v[168:171], a[76:79], a[96:99], v[168:171]
    v_mfma_f32_16x16x32_bf16 v[172:175], a[76:79], a[100:103], v[172:175]
    s_cmp_eq_u32 s52, s54
    s_cselect_b32 s52, s53, s52
    buffer_load_dwordx4 v17, s[44:47], s48 offen offset:1024 lds
    v_mfma_f32_16x16x32_bf16 v[176:179], a[76:79], a[104:107], v[176:179]
    ds_read_b64_tr_b16 a[20:21], v20 offset:8256
    v_mfma_f32_16x16x32_bf16 v[180:183], a[76:79], a[108:111], v[180:183]
    ds_read_b64_tr_b16 a[22:23], v20 offset:10048
    v_mfma_f32_16x16x32_bf16 v[184:187], a[76:79], a[112:115], v[184:187]
    buffer_load_dwordx4 v18, s[44:47], s48 offen offset:2048 lds
    v_mfma_f32_16x16x32_bf16 v[188:191], a[76:79], a[116:119], v[188:191]
    v_mfma_f32_16x16x32_bf16 v[192:195], a[80:83], a[88:91], v[192:195]
    ds_read_b64_tr_b16 a[24:25], v21 offset:0
    v_mfma_f32_16x16x32_bf16 v[196:199], a[80:83], a[92:95], v[196:199]
    ds_read_b64_tr_b16 a[26:27], v21 offset:1792
    v_mfma_f32_16x16x32_bf16 v[200:203], a[80:83], a[96:99], v[200:203]
    buffer_load_dwordx4 v19, s[44:47], s48 offen offset:3072 lds
    s_add_u32 s48, s48, s49
    s_cmp_eq_u32 s48, s51
    s_cselect_b32 s48, s50, s48
    v_mfma_f32_16x16x32_bf16 v[204:207], a[80:83], a[100:103], v[204:207]
    v_mfma_f32_16x16x32_bf16 v[208:211], a[80:83], a[104:107], v[208:211]
    v_mfma_f32_16x16x32_bf16 v[212:215], a[80:83], a[108:111], v[212:215]
    v_mfma_f32_16x16x32_bf16 v[216:219], a[80:83], a[112:115], v[216:219]
    v_mfma_f32_16x16x32_bf16 v[220:223], a[80:83], a[116:119], v[220:223]
    v_mfma_f32_16x16x32_bf16 a[128:131], a[84:87], a[88:91], a[128:131]
    v_mfma_f32_16x16x32_bf16 a[132:135], a[84:87], a[92:95], a[132:135]
    v_mfma_f32_16x16x32_bf16 a[136:139], a[84:87], a[96:99], a[136:139]
    v_mfma_f32_16x16x32_bf16 a[140:143], a[84:87], a[100:103], a[140:143]
    v_mfma_f32_16x16x32_bf16 a[144:147], a[84:87], a[104:107], a[144:147]
    v_mfma_f32_16x16x32_bf16 a[148:151], a[84:87], a[108:111], a[148:151]
    s_waitcnt vmcnt(16)
    v_mfma_f32_16x16x32_bf16 a[152:155], a[84:87], a[112:115], a[152:155]
    v_mfma_f32_16x16x32_bf16 a[156:159], a[84:87], a[116:119], a[156:159]
    s_mov_b32 s61, 1
La_loop:
    s_cmp_eq_u32 s61, s28
    s_cbranch_scc1 La_bodyB
    s_waitcnt lgkmcnt(0)
    s_barrier
    v_mfma_f32_16x16x32_bf16 v[32:35], a[0:3], a[28:31], v[32:35]
    buffer_load_dword a254, v26, s[72:75], s76 offen
    s_add_u32 s76, s76, s77
    v_mfma_f32_16x16x32_bf16 v[36:39], a[0:3], a[32:35], v[36:39]
    ds_read_b128 a[88:91], v23 offset:0
    v_mfma_f32_16x16x32_bf16 v[40:43], a[0:3], a[36:39], v[40:43]
    v_mfma_f32_16x16x32_bf16 v[44:47], a[0:3], a[40:43], v[44:47]
    ds_read_b128 a[92:95], v23 offset:2048
    v_mfma_f32_16x16x32_bf16 v[48:51], a[0:3], a[44:47], v[48:51]
    v_mfma_f32_16x16x32_bf16 v[52:55], a[0:3], a[48:51], v[52:55]
    ds_read_b128 a[96:99], v23 offset:4096
    v_mfma_f32_16x16x32_bf16 v[56:59], a[0:3], a[52:55], v[56:59]
    v_mfma_f32_16x16x32_bf16 v[60:63], a[0:3], a[56:59], v[60:63]
    ds_read_b128 a[100:103], v23 offset:6144
    v_mfma_f32_16x16x32_bf16 v[64:67], a[4:7], a[28:31], v[64:67]
    v_mfma_f32_16x16x32_bf16 v[68:71], a[4:7], a[32:35], v[68:71]
    ds_read_b128 a[104:107], v23 offset:8192
    v_mfma_f32_16x16x32_bf16 v[72:75], a[4:7], a[36:39], v[72:75]
    v_mfma_f32_16x16x32_bf16 v[76:79], a[4:7], a[40:43], v[76:79]
    ds_read_b128 a[108:111], v23 offset:10240
    v_mfma_f32_16x16x32_bf16 v[80:83], a[4:7], a[44:47], v[80:83]
    v_mfma_f32_16x16x32_bf16 v[84:87], a[4:7], a[48:51], v[84:87]
    ds_read_b128 a[112:115], v23 offset:12288
    v_mfma_f32_16x16x32_bf16 v[88:91], a[4:7], a[52:55], v[88:91]
    v_mfma_f32_16x16x32_bf16 v[92:95], a[4:7], a[56:59], v[92:95]
    ds_read_b128 a[116:119], v23 offset:14336
    v_mfma_f32_16x16x32_bf16 v[96:99], a[8:11], a[28:31], v[96:99]
    v_mfma_f32_16x16x32_bf16 v[100:103], a[8:11], a[32:35], v[100:103]
    ds_read_b64_tr_b16 a[60:61], v20 offset:16384
    v_mfma_f32_16x16x32_bf16 v[104:107], a[8:11], a[36:39], v[104:107]
    v_mfma_f32_16x16x32_bf16 v[108:111], a[8:11], a[40:43], v[108:111]
    ds_read_b64_tr_b16 a[62:63], v20 offset:18176
    v_mfma_f32_16x16x32_bf16 v[112:115], a[8:11], a[44:47], v[112:115]
    v_mfma_f32_16x16x32_bf16 v[116:119], a[8:11], a[48:51], v[116:119]
    ds_read_b64_tr_b16 a[64:65], v20 offset:16416
    v_mfma_f32_16x16x32_bf16 v[120:123], a[8:11], a[52:55], v[120:123]
    ds_read_b64_tr_b16 a[66:67], v20 offset:18208
    v_mfma_f32_16x16x32_bf16 v[124:127], a[8:11], a[56:59], v[124:127]
    v_mfma_f32_16x16x32_bf16 v[128:131], a[12:15], a[28:31], v[128:131]
    ds_read_b64_tr_b16 a[68:69], v20 offset:16448
    v_mfma_f32_16x16x32_bf16 v[132:135], a[12:15], a[32:35], v[132:135]
    v_mfma_f32_16x16x32_bf16 v[136:139], a[12:15], a[36:39], v[136:139]
    ds_read_b64_tr_b16 a[70:71], v20 offset:18240
    v_mfma_f32_16x16x32_bf16 v[140:143], a[12:15], a[40:43], v[140:143]
    v_mfma_f32_16x16x32_bf16 v[144:147], a[12:15], a[44:47], v[144:147]
    ds_read_b64_tr_b16 a[72:73], v20 offset:24576
    v_mfma_f32_16x16x32_bf16 v[148:151], a[12:15], a[48:51], v[148:151]
    v_mfma_f32_16x16x32_bf16 v[152:155], a[12:15], a[52:55], v[152:155]
    ds_read_b64_tr_b16 a[74:75], v20 offset:26368
    v_mfma_f32_16x16x32_bf16 v[156:159], a[12:15], a[56:59], v[156:159]
    v_mfma_f32_16x16x32_bf16 v[160:163], a[16:19], a[28:31], v[160:163]
    ds_read_b64_tr_b16 a[76:77], v20 offset:24608
    v_mfma_f32_16x16x32_bf16 v[164:167], a[16:19], a[32:35], v[164:167]
    v_mfma_f32_16x16x32_bf16 v[168:171], a[16:19], a[36:39], v[168:171]
    ds_read_b64_tr_b16 a[78:79], v20 offset:26400
    v_mfma_f32_16x16x32_bf16 v[172:175], a[16:19], a[40:43], v[172:175]
    v_mfma_f32_16x16x32_bf16 v[176:179], a[16:19], a[44:47], v[176:179]
    ds_read_b64_tr_b16 a[80:81], v20 offset:24640
    v_mfma_f32_16x16x32_bf16 v[180:183], a[16:19], a[48:51], v[180:183]
    v_mfma_f32_16x16x32_bf16 v[184:187], a[16:19], a[52:55], v[184:187]
    ds_read_b64_tr_b16 a[82:83], v20 offset:26432
    v_mfma_f32_16x16x32_bf16 v[188:191], a[16:19], a[56:59], v[188:191]
    v_mfma_f32_16x16x32_bf16 v[192:195], a[20:23], a[28:31], v[192:195]
    ds_read_b64_tr_b16 a[84:85], v21 offset:16384
    v_mfma_f32_16x16x32_bf16 v[196:199], a[20:23], a[32:35], v[196:199]
    v_mfma_f32_16x16x32_bf16 v[200:203], a[20:23], a[36:39], v[200:203]
    ds_read_b64_tr_b16 a[86:87], v21 offset:18176
    v_mfma_f32_16x16x32_bf16 v[204:207], a[20:23], a[40:43], v[204:207]
    v_mfma_f32_16x16x32_bf16 v[208:211], a[20:23], a[44:47], v[208:211]
    v_mfma_f32_16x16x32_bf16 v[212:215], a[20:23], a[48:51], v[212:215]
    v_mfma_f32_16x16x32_bf16 v[216:219], a[20:23], a[52:55], v[216:219]
    v_mfma_f32_16x16x32_bf16 v[220:223], a[20:23], a[56:59], v[220:223]
    v_mfma_f32_16x16x32_bf16 a[128:131], a[24:27], a[28:31], a[128:131]
    v_mfma_f32_16x16x32_bf16 a[132:135], a[24:27], a[32:35], a[132:135]
    v_mfma_f32_16x16x32_bf16 a[136:139], a[24:27], a[36:39], a[136:139]
    v_mfma_f32_16x16x32_bf16 a[140:143], a[24:27], a[40:43], a[140:143]
    v_mfma_f32_16x16x32_bf16 a[144:147], a[24:27], a[44:47], a[144:147]
    v_mfma_f32_16x16x32_bf16 a[148:151], a[24:27], a[48:51], a[148:151]
    s_waitcnt vmcnt(9)
    v_mfma_f32_16x16x32_bf16 a[152:155], a[24:27], a[52:55], a[152:155]
    v_mfma_f32_16x16x32_bf16 a[156:159], a[24:27], a[56:59], a[156:159]
    s_waitcnt lgkmcnt(0)
    s_barrier
    v_mfma_f32_16x16x32_bf16 v[32:35], a[60:63], a[88:91], v[32:35]
    s_add_u32 s60, s60, 32768
    s_cmp_eq_u32 s60, 98304
    s_cselect_b32 s60, 0, s60
    v_mfma_f32_16x16x32_bf16 v[36:39], a[60:63], a[92:95], v[36:39]
    v_add_u32 v22, s60, v24
    v_add_u32 v23, s60, v25
    v_mfma_f32_16x16x32_bf16 v[40:43], a[60:63], a[96:99], v[40:43]
    ds_read_b128 a[28:31], v22 offset:0
    v_mfma_f32_16x16x32_bf16 v[44:47], a[60:63], a[100:103], v[44:47]
    ds_read_b128 a[32:35], v22 offset:2048
    v_mfma_f32_16x16x32_bf16 v[48:51], a[60:63], a[104:107], v[48:51]
    v_mfma_f32_16x16x32_bf16 v[52:55], a[60:63], a[108:111], v[52:55]
    s_mov_b32 m0, s40
    s_nop 0
    buffer_load_dwordx4 v4, s[32:35], s36 offen lds
    v_mfma_f32_16x16x32_bf16 v[56:59], a[60:63], a[112:115], v[56:59]
    ds_read_b128 a[36:39], v22 offset:4096
    v_mfma_f32_16x16x32_bf16 v[60:63], a[60:63], a[116:119], v[60:63]
    ds_read_b128 a[40:43], v22 offset:6144
    v_mfma_f32_16x16x32_bf16 v[64:67], a[64:67], a[88:91], v[64:67]
    buffer_load_dwordx4 v5, s[32:35], s36 offen offset:1024 lds
    v_mfma_f32_16x16x32_bf16 v[68:71], a[64:67], a[92:95], v[68:71]
    v_mfma_f32_16x16x32_bf16 v[72:75], a[64:67], a[96:99], v[72:75]
    ds_read_b128 a[44:47], v22 offset:8192
    v_mfma_f32_16x16x32_bf16 v[76:79], a[64:67], a[100:103], v[76:79]
    ds_read_b128 a[48:51], v22 offset:10240
    v_mfma_f32_16x16x32_bf16 v[80:83], a[64:67], a[104:107], v[80:83]
    buffer_load_dwordx4 v6, s[32:35], s36 offen offset:2048 lds
    v_mfma_f32_16x16x32_bf16 v[84:87], a[64:67], a[108:111], v[84:87]
    ds_read_b128 a[52:55], v22 offset:12288
    v_mfma_f32_16x16x32_bf16 v[88:91], a[64:67], a[112:115], v[88:91]
    v_mfma_f32_16x16x32_bf16 v[92:95], a[64:67], a[116:119], v[92:95]
    ds_read_b128 a[56:59], v22 offset:14336
    v_mfma_f32_16x16x32_bf16 v[96:99], a[68:71], a[88:91], v[96:99]
    buffer_load_dwordx4 v7, s[32:35], s36 offen offset:3072 lds
    v_mfma_f32_16x16x32_bf16 v[100:103], a[68:71], a[92:95], v[100:103]
    ds_read_b64_tr_b16 a[0:1], v20 offset:32768
    v_mfma_f32_16x16x32_bf16 v[104:107], a[68:71], a[96:99], v[104:107]
    ds_read_b64_tr_b16 a[2:3], v20 offset:34560
    v_mfma_f32_16x16x32_bf16 v[108:111], a[68:71], a[100:103], v[108:111]
    v_mfma_f32_16x16x32_bf16 v[112:115], a[68:71], a[104:107], v[112:115]
    s_add_u32 m0, s40, 4096
    s_add_u32 s40, s40, 32768
    buffer_load_dwordx4 v8, s[32:35], s36 offen lds
    v_mfma_f32_16x16x32_bf16 v[116:119], a[68:71], a[108:111], v[116:119]
    ds_read_b64_tr_b16 a[4:5], v20 offset:32800
    v_mfma_f32_16x16x32_bf16 v[120:123], a[68:71], a[112:115], v[120:123]
    ds_read_b64_tr_b16 a[6:7], v20 offset:34592
    v_mfma_f32_16x16x32_bf16 v[124:127], a[68:71], a[116:119], v[124:127]
    s_cmp_eq_u32 s40, s42
    s_cselect_b32 s40, s41, s40
    buffer_load_dwordx4 v9, s[32:35], s36 offen offset:1024 lds
    v_mfma_f32_16x16x32_bf16 v[128:131], a[72:75], a[88:91], v[128:131]
    v_mfma_f32_16x16x32_bf16 v[132:135], a[72:75], a[92:95], v[132:135]
    ds_read_b64_tr_b16 a[8:9], v20 offset:32832
    v_mfma_f32_16x16x32_bf16 v[136:139], a[72:75], a[96:99], v[136:139]
    ds_read_b64_tr_b16 a[10:11], v20 offset:34624
    v_mfma_f32_16x16x32_bf16 v[140:143], a[72:75], a[100:103], v[140:143]
    buffer_load_dwordx4 v10, s[32:35], s36 offen offset:2048 lds
    v_mfma_f32_16x16x32_bf16 v[144:147], a[72:75], a[104:107], v[144:147]
    ds_read_b64_tr_b16 a[12:13], v20 offset:40960
    v_mfma_f32_16x16x32_bf16 v[148:151], a[72:75], a[108:111], v[148:151]
    v_mfma_f32_16x16x32_bf16 v[152:155], a[72:75], a[112:115], v[152:155]
    ds_read_b64_tr_b16 a[14:15], v20 offset:42752
    v_mfma_f32_16x16x32_bf16 v[156:159], a[72:75], a[116:119], v[156:159]
    buffer_load_dwordx4 v11, s[32:35], s36 offen offset:3072 lds
    s_add_u32 s36, s36, s37
    s_cmp_eq_u32 s36, s39
    s_cselect_b32 s36, s38, s36
    v_mfma_f32_16x16x32_bf16 v[160:163], a[76:79], a[88:91], v[160:163]
    ds_read_b64_tr_b16 a[16:17], v20 offset:40992
    v_mfma_f32_16x16x32_bf16 v[164:167], a[76:79], a[92:95], v[164:167]
    ds_read_b64_tr_b16 a[18:19], v20 offset:42784
    v_mfma_f32_16x16x32_bf16 v[168:171], a[76:79], a[96:99], v[168:171]
    v_mfma_f32_16x16x32_bf16 v[172:175], a[76:79], a[100:103], v[172:175]
    s_mov_b32 m0, s52
    s_nop 0
    buffer_load_dwordx4 v12, s[44:47], s48 offen lds
    v_mfma_f32_16x16x32_bf16 v[176:179], a[76:79], a[104:107], v[176:179]
    ds_read_b64_tr_b16 a[20:21], v20 offset:41024
    v_mfma_f32_16x16x32_bf16 v[180:183], a[76:79], a[108:111], v[180:183]
    ds_read_b64_tr_b16 a[22:23], v20 offset:42816
    v_mfma_f32_16x16x32_bf16 v[184:187], a[76:79], a[112:115], v[184:187]
    buffer_load_dwordx4 v13, s[44:47], s48 offen offset:1024 lds
    v_mfma_f32_16x16x32_bf16 v[188:191], a[76:79], a[116:119], v[188:191]
    v_mfma_f32_16x16x32_bf16 v[192:195], a[80:83], a[88:91], v[192:195]
    ds_read_b64_tr_b16 a[24:25], v21 offset:32768
    v_mfma_f32_16x16x32_bf16 v[196:199], a[80:83], a[92:95], v[196:199]
    ds_read_b64_tr_b16 a[26:27], v21 offset:34560
    v_mfma_f32_16x16x32_bf16 v[200:203], a[80:83], a[96:99], v[200:203]
    buffer_load_dwordx4 v14, s[44:47], s48 offen offset:2048 lds
    v_mfma_f32_16x16x32_bf16 v[204:207], a[80:83], a[100:103], v[204:207]
    v_mfma_f32_16x16x32_bf16 v[208:211], a[80:83], a[104:107], v[208:211]
    v_mfma_f32_16x16x32_bf16 v[212:215], a[80:83], a[108:111], v[212:215]
    v_mfma_f32_16x16x32_bf16 v[216:219], a[80:83], a[112:115], v[216:219]
    v_mfma_f32_16x16x32_bf16 v[220:223], a[80:83], a[116:119], v[220:223]
    v_mfma_f32_16x16x32_bf16 a[128:131], a[84:87], a[88:91], a[128:131]
    v_mfma_f32_16x16x32_bf16 a[132:135], a[84:87], a[92:95], a[132:135]
    v_mfma_f32_16x16x32_bf16 a[136:139], a[84:87], a[96:99], a[136:139]
    v_mfma_f32_16x16x32_bf16 a[140:143], a[84:87], a[100:103], a[140:143]
    v_mfma_f32_16x16x32_bf16 a[144:147], a[84:87], a[104:107], a[144:147]
    v_mfma_f32_16x16x32_bf16 a[148:151], a[84:87], a[108:111], a[148:151]
    s_waitcnt vmcnt(12)
    v_mfma_f32_16x16x32_bf16 a[152:155], a[84:87], a[112:115], a[152:155]
    v_mfma_f32_16x16x32_bf16 a[156:159], a[84:87], a[116:119], a[156:159]
    s_waitcnt lgkmcnt(0)
    s_barrier
    v_mfma_f32_16x16x32_bf16 v[32:35], a[0:3], a[28:31], v[32:35]
    ds_read_b128 a[88:91], v23 offset:0
    v_mfma_f32_16x16x32_bf16 v[36:39], a[0:3], a[32:35], v[36:39]
    ds_read_b128 a[92:95], v23 offset:2048
    v_mfma_f32_16x16x32_bf16 v[40:43], a[0:3], a[36:39], v[40:43]
    buffer_load_dwordx4 v15, s[44:47], s48 offen offset:3072 lds
    v_mfma_f32_16x16x32_bf16 v[44:47], a[0:3], a[40:43], v[44:47]
    v_mfma_f32_16x16x32_bf16 v[48:51], a[0:3], a[44:47], v[48:51]
    ds_read_b128 a[96:99], v23 offset:4096
    v_mfma_f32_16x16x32_bf16 v[52:55], a[0:3], a[48:51], v[52:55]
    ds_read_b128 a[100:103], v23 offset:6144
    v_mfma_f32_16x16x32_bf16 v[56:59], a[0:3], a[52:55], v[56:59]
    s_add_u32 m0, s52, 4096
    s_add_u32 s52, s52, 32768
    buffer_load_dwordx4 v16, s[44:47], s48 offen lds
    v_mfma_f32_16x16x32_bf16 v[60:63], a[0:3], a[56:59], v[60:63]
    v_mfma_f32_16x16x32_bf16 v[64:67], a[4:7], a[28:31], v[64:67]
    ds_read_b128 a[104:107], v23 offset:8192
    v_mfma_f32_16x16x32_bf16 v[68:71], a[4:7], a[32:35], v[68:71]
    ds_read_b128 a[108:111], v23 offset:10240
    v_mfma_f32_16x16x32_bf16 v[72:75], a[4:7], a[36:39], v[72:75]
    v_mfma_f32_16x16x32_bf16 v[76:79], a[4:7], a[40:43], v[76:79]
    s_cmp_eq_u32 s52, s54
    s_cselect_b32 s52, s53, s52
    buffer_load_dwordx4 v17, s[44:47], s48 offen offset:1024 lds
    v_mfma_f32_16x16x32_bf16 v[80:83], a[4:7], a[44:47], v[80:83]
    ds_read_b128 a[112:115], v23 offset:12288
    v_mfma_f32_16x16x32_bf16 v[84:87], a[4:7], a[48:51], v[84:87]
    ds_read_b128 a[116:119], v23 offset:14336
    v_mfma_f32_16x16x32_bf16 v[88:91], a[4:7], a[52:55], v[88:91]
    v_mfma_f32_16x16x32_bf16 v[92:95], a[4:7], a[56:59], v[92:95]
    buffer_load_dwordx4 v18, s[44:47], s48 offen offset:2048 lds
    v_mfma_f32_16x16x32_bf16 v[96:99], a[8:11], a[28:31], v[96:99]
    ds_read_b64_tr_b16 a[60:61], v20 offset:49152
    v_mfma_f32_16x16x32_bf16 v[100:103], a[8:11], a[32:35], v[100:103]
    ds_read_b64_tr_b16 a[62:63], v20 offset:50944
    v_mfma_f32_16x16x32_bf16 v[104:107], a[8:11], a[36:39], v[104:107]
    v_mfma_f32_16x16x32_bf16 v[108:111], a[8:11], a[40:43], v[108:111]
    buffer_load_dwordx4 v19, s[44:47], s48 offen offset:3072 lds
    s_add_u32 s48, s48, s49
    s_cmp_eq_u32 s48, s51
    s_cselect_b32 s48, s50, s48
    v_mfma_f32_16x16x32_bf16 v[112:115], a[8:11], a[44:47], v[112:115]
    ds_read_b64_tr_b16 a[64:65], v20 offset:49184
    v_mfma_f32_16x16x32_bf16 v[116:119], a[8:11], a[48:51], v[116:119]
    v_mfma_f32_16x16x32_bf16 v[120:123], a[8:11], a[52:55], v[120:123]
    ds_read_b64_tr_b16 a[66:67], v20 offset:50976
    v_mfma_f32_16x16x32_bf16 v[124:127], a[8:11], a[56:59], v[124:127]
    s_mov_b32 m0, s40
    s_nop 0
    buffer_load_dwordx4 v4, s[32:35], s36 offen lds
    v_mfma_f32_16x16x32_bf16 v[128:131], a[12:15], a[28:31], v[128:131]
    ds_read_b64_tr_b16 a[68:69], v20 offset:49216
    v_mfma_f32_16x16x32_bf16 v[132:135], a[12:15], a[32:35], v[132:135]
    v_mfma_f32_16x16x32_bf16 v[136:139], a[12:15], a[36:39], v[136:139]
    ds_read_b64_tr_b16 a[70:71], v20 offset:51008
    v_mfma_f32_16x16x32_bf16 v[140:143], a[12:15], a[40:43], v[140:143]
    buffer_load_dwordx4 v5, s[32:35], s36 offen offset:1024 lds
    v_mfma_f32_16x16x32_bf16 v[144:147], a[12:15], a[44:47], v[144:147]
    ds_read_b64_tr_b16 a[72:73], v20 offset:57344
    v_mfma_f32_16x16x32_bf16 v[148:151], a[12:15], a[48:51], v[148:151]
    v_mfma_f32_16x16x32_bf16 v[152:155], a[12:15], a[52:55], v[152:155]
    ds_read_b64_tr_b16 a[74:75], v20 offset:59136
    v_mfma_f32_16x16x32_bf16 v[156:159], a[12:15], a[56:59], v[156:159]
    buffer_load_dwordx4 v6, s[32:35], s36 offen offset:2048 lds
    v_mfma_f32_16x16x32_bf16 v[160:163], a[16:19], a[28:31], v[160:163]
    v_mfma_f32_16x16x32_bf16 v[164:167], a[16:19], a[32:35], v[164:167]
    ds_read_b64_tr_b16 a[76:77], v20 offset:57376
    v_mfma_f32_16x16x32_bf16 v[168:171], a[16:19], a[36:39], v[168:171]
    ds_read_b64_tr_b16 a[78:79], v20 offset:59168
    v_mfma_f32_16x16x32_bf16 v[172:175], a[16:19], a[40:43], v[172:175]
    buffer_load_dwordx4 v7, s[32:35], s36 offen offset:3072 lds
    v_mfma_f32_16x16x32_bf16 v[176:179], a[16:19], a[44:47], v[176:179]
    v_mfma_f32_16x16x32_bf16 v[180:183], a[16:19], a[48:51], v[180:183]
    ds_read_b64_tr_b16 a[80:81], v20 offset:57408
    v_mfma_f32_16x16x32_bf16 v[184:187], a[16:19], a[52:55], v[184:187]
    ds_read_b64_tr_b16 a[82:83], v20 offset:59200
    v_mfma_f32_16x16x32_bf16 v[188:191], a[16:19], a[56:59], v[188:191]
    s_add_u32 m0, s40, 4096
    s_add_u32 s40, s40, 32768
    buffer_load_dwordx4 v8, s[32:35], s36 offen lds
    v_mfma_f32_16x16x32_bf16 v[192:195], a[20:23], a[28:31], v[192:195]
    v_mfma_f32_16x16x32_bf16 v[196:199], a[20:23], a[32:35], v[196:199]
    ds_read_b64_tr_b16 a[84:85], v21 offset:49152
    v_mfma_f32_16x16x32_bf16 v[200:203], a[20:23], a[36:39], v[200:203]
    ds_read_b64_tr_b16 a[86:87], v21 offset:50944
    v_mfma_f32_16x16x32_bf16 v[204:207], a[20:23], a[40:43], v[204:207]
    v_mfma_f32_16x16x32_bf16 v[208:211], a[20:23], a[44:47], v[208:211]
    v_mfma_f32_16x16x32_bf16 v[212:215], a[20:23], a[48:51], v[212:215]
    v_mfma_f32_16x16x32_bf16 v[216:219], a[20:23], a[52:55], v[216:219]
    v_mfma_f32_16x16x32_bf16 v[220:223], a[20:23], a[56:59], v[220:223]
    v_mfma_f32_16x16x32_bf16 a[128:131], a[24:27], a[28:31], a[128:131]
    v_mfma_f32_16x16x32_bf16 a[132:135], a[24:27], a[32:35], a[132:135]
    v_mfma_f32_16x16x32_bf16 a[136:139], a[24:27], a[36:39], a[136:139]
    v_mfma_f32_16x16x32_bf16 a[140:143], a[24:27], a[40:43], a[140:143]
    v_mfma_f32_16x16x32_bf16 a[144:147], a[24:27], a[44:47], a[144:147]
    v_mfma_f32_16x16x32_bf16 a[148:151], a[24:27], a[48:51], a[148:151]
    s_waitcnt vmcnt(13)
    v_mfma_f32_16x16x32_bf16 a[152:155], a[24:27], a[52:55], a[152:155]
    v_mfma_f32_16x16x32_bf16 a[156:159], a[24:27], a[56:59], a[156:159]
    s_waitcnt lgkmcnt(0)
    s_barrier
    v_mfma_f32_16x16x32_bf16 v[32:35], a[60:63], a[88:91], v[32:35]
    s_add_u32 s60, s60, 32768
    s_cmp_eq_u32 s60, 98304
    s_cselect_b32 s60, 0, s60
    v_mfma_f32_16x16x32_bf16 v[36:39], a[60:63], a[92:95], v[36:39]
    v_add_u32 v22, s60, v24
    v_add_u32 v23, s60, v25
    v_mfma_f32_16x16x32_bf16 v[40:43], a[60:63], a[96:99], v[40:43]
    ds_read_b128 a[28:31], v22 offset:0
    v_mfma_f32_16x16x32_bf16 v[44:47], a[60:63], a[100:103], v[44:47]
    ds_read_b128 a[32:35], v22 offset:2048
    v_mfma_f32_16x16x32_bf16 v[48:51], a[60:63], a[104:107], v[48:51]
    s_cmp_eq_u32 s40, s42
    s_cselect_b32 s40, s41, s40
    buffer_load_dwordx4 v9, s[32:35], s36 offen offset:1024 lds
    v_mfma_f32_16x16x32_bf16 v[52:55], a[60:63], a[108:111], v[52:55]
    ds_read_b128 a[36:39], v22 offset:4096
    v_mfma_f32_16x16x32_bf16 v[56:59], a[60:63], a[112:115], v[56:59]
    ds_read_b128 a[40:43], v22 offset:6144
    v_mfma_f32_16x16x32_bf16 v[60:63], a[60:63], a[116:119], v[60:63]
    v_mfma_f32_16x16x32_bf16 v[64:67], a[64:67], a[88:91], v[64:67]
    buffer_load_dwordx4 v10, s[32:35], s36 offen offset:2048 lds
    v_mfma_f32_16x16x32_bf16 v[68:71], a[64:67], a[92:95], v[68:71]
    ds_read_b128 a[44:47], v22 offset:8192
    v_mfma_f32_16x16x32_bf16 v[72:75], a[64:67], a[96:99], v[72:75]
    ds_read_b128 a[48:51], v22 offset:10240
    v_mfma_f32_16x16x32_bf16 v[76:79], a[64:67], a[100:103], v[76:79]
    buffer_load_dwordx4 v11, s[32:35], s36 offen offset:3072 lds
    s_add_u32 s36, s36, s37
    s_cmp_eq_u32 s36, s39
    s_cselect_b32 s36, s38, s36
    v_mfma_f32_16x16x32_bf16 v[80:83], a[64:67], a[104:107], v[80:83]
    ds_read_b128 a[52:55], v22 offset:12288
    v_mfma_f32_16x16x32_bf16 v[84:87], a[64:67], a[108:111], v[84:87]
    ds_read_b128 a[56:59], v22 offset:14336
    v_mfma_f32_16x16x32_bf16 v[88:91], a[64:67], a[112:115], v[88:91]
    v_mfma_f32_16x16x32_bf16 v[92:95], a[64:67], a[116:119], v[92:95]
    s_mov_b32 m0, s52
    s_nop 0
    buffer_load_dwordx4 v12, s[44:47], s48 offen lds
    v_mfma_f32_16x16x32_bf16 v[96:99], a[68:71], a[88:91], v[96:99]
    ds_read_b64_tr_b16 a[0:1], v20 offset:0
    v_mfma_f32_16x16x32_bf16 v[100:103], a[68:71], a[92:95], v[100:103]
    ds_read_b64_tr_b16 a[2:3], v20 offset:1792
    v_mfma_f32_16x16x32_bf16 v[104:107], a[68:71], a[96:99], v[104:107]
    buffer_load_dwordx4 v13, s[44:47], s48 offen offset:1024 lds
    v_mfma_f32_16x16x32_bf16 v[108:111], a[68:71], a[100:103], v[108:111]
    ds_read_b64_tr_b16 a[4:5], v20 offset:32
    v_mfma_f32_16x16x32_bf16 v[112:115], a[68:71], a[104:107], v[112:115]
    ds_read_b64_tr_b16 a[6:7], v20 offset:1824
    v_mfma_f32_16x16x32_bf16 v[116:119], a[68:71], a[108:111], v[116:119]
    v_mfma_f32_16x16x32_bf16 v[120:123], a[68:71], a[112:115], v[120:123]
    buffer_load_dwordx4 v14, s[44:47], s48 offen offset:2048 lds
    v_mfma_f32_16x16x32_bf16 v[124:127], a[68:71], a[116:119], v[124:127]
    ds_read_b64_tr_b16 a[8:9], v20 offset:64
    v_mfma_f32_16x16x32_bf16 v[128:131], a[72:75], a[88:91], v[128:131]
    ds_read_b64_tr_b16 a[10:11], v20 offset:1856
    v_mfma_f32_16x16x32_bf16 v[132:135], a[72:75], a[92:95], v[132:135]
    buffer_load_dwordx4 v15, s[44:47], s48 offen offset:3072 lds
    v_mfma_f32_16x16x32_bf16 v[136:139], a[72:75], a[96:99], v[136:139]
    ds_read_b64_tr_b16 a[12:13], v20 offset:8192
    v_mfma_f32_16x16x32_bf16 v[140:143], a[72:75], a[100:103], v[140:143]
    ds_read_b64_tr_b16 a[14:15], v20 offset:9984
    v_mfma_f32_16x16x32_bf16 v[144:147], a[72:75], a[104:107], v[144:147]
    s_add_u32 m0, s52, 4096
    s_add_u32 s52, s52, 32768
    buffer_load_dwordx4 v16, s[44:47], s48 offen lds
    v_mfma_f32_16x16x32_bf16 v[148:151], a[72:75], a[108:111], v[148:151]
    v_mfma_f32_16x16x32_bf16 v[152:155], a[72:75], a[112:115], v[152:155]
    ds_read_b64_tr_b16 a[16:17], v20 offset:8224
    v_mfma_f32_16x16x32_bf16 v[156:159], a[72:75], a[116:119], v[156:159]
    ds_read_b64_tr_b16 a[18:19], v20 offset:10016
    v_mfma_f32_16x16x32_bf16 v[160:163], a[76:79], a[88:91], v[160:163]
    s_cmp_eq_u32 s52, s54
    s_cselect_b32 s52, s53, s52
    buffer_load_dwordx4 v17, s[44:47], s48 offen offset:1024 lds
    v_mfma_f32_16x16x32_bf16 v[164:167], a[76:79], a[92:95], v[164:167]
    ds_read_b64_tr_b16 a[20:21], v20 offset:8256
    v_mfma_f32_16x16x32_bf16 v[168:171], a[76:79], a[96:99], v[168:171]
    ds_read_b64_tr_b16 a[22:23], v20 offset:10048
    v_mfma_f32_16x16x32_bf16 v[172:175], a[76:79], a[100:103], v[172:175]
    buffer_load_dwordx4 v18, s[44:47], s48 offen offset:2048 lds
    v_mfma_f32_16x16x32_bf16 v[176:179], a[76:79], a[104:107], v[176:179]
    v_mfma_f32_16x16x32_bf16 v[180:183], a[76:79], a[108:111], v[180:183]
    ds_read_b64_tr_b16 a[24:25], v21 offset:0
    v_mfma_f32_16x16x32_bf16 v[184:187], a[76:79], a[112:115], v[184:187]
    ds_read_b64_tr_b16 a[26:27], v21 offset:1792
    v_mfma_f32_16x16x32_bf16 v[188:191], a[76:79], a[116:119], v[188:191]
    buffer_load_dwordx4 v19, s[44:47], s48 offen offset:3072 lds
    s_add_u32 s48, s48, s49
    s_cmp_eq_u32 s48, s51
    s_cselect_b32 s48, s50, s48
    v_mfma_f32_16x16x32_bf16 v[192:195], a[80:83], a[88:91], v[192:195]
    s_cmp_eq_u32 s61, 2
    s_cselect_b64 vcc, -1, 0
    s_cselect_b64 s[72:73], s[6:7], s[72:73]
    s_cselect_b32 s74, 4194304, s74
    v_mfma_f32_16x16x32_bf16 v[196:199], a[80:83], a[92:95], v[196:199]
    v_cndmask_b32 v26, v26, v255, vcc
    s_cmp_ge_u32 s61, 2
    s_cselect_b32 s76, 0, s76
    v_mfma_f32_16x16x32_bf16 v[200:203], a[80:83], a[96:99], v[200:203]
    s_cmp_eq_u32 s61, 3
    s_cselect_b64 s[72:73], s[8:9], s[72:73]
    v_mfma_f32_16x16x32_bf16 v[204:207], a[80:83], a[100:103], v[204:207]
    v_mfma_f32_16x16x32_bf16 v[208:211], a[80:83], a[104:107], v[208:211]
    v_mfma_f32_16x16x32_bf16 v[212:215], a[80:83], a[108:111], v[212:215]
    v_mfma_f32_16x16x32_bf16 v[216:219], a[80:83], a[112:115], v[216:219]
    v_mfma_f32_16x16x32_bf16 v[220:223], a[80:83], a[116:119], v[220:223]
    v_mfma_f32_16x16x32_bf16 a[128:131], a[84:87], a[88:91], a[128:131]
    v_mfma_f32_16x16x32_bf16 a[132:135], a[84:87], a[92:95], a[132:135]
    v_mfma_f32_16x16x32_bf16 a[136:139], a[84:87], a[96:99], a[136:139]
    v_mfma_f32_16x16x32_bf16 a[140:143], a[84:87], a[100:103], a[140:143]
    v_mfma_f32_16x16x32_bf16 a[144:147], a[84:87], a[104:107], a[144:147]
    v_mfma_f32_16x16x32_bf16 a[148:151], a[84:87], a[108:111], a[148:151]
    s_waitcnt vmcnt(16)
    v_mfma_f32_16x16x32_bf16 a[152:155], a[84:87], a[112:115], a[152:155]
    v_mfma_f32_16x16x32_bf16 a[156:159], a[84:87], a[116:119], a[156:159]
La_next:
    s_add_u32 s61, s61, 1
    s_cmp_lt_u32 s61, 5
    s_cbranch_scc1 La_loop
    s_waitcnt lgkmcnt(0)
    s_barrier
    v_mfma_f32_16x16x32_bf16 v[32:35], a[0:3], a[28:31], v[32:35]
    s_mov_b32 s72, s22
    s_mov_b32 s73, s23
    s_mov_b32 s74, 7340032
    s_mov_b32 s75, 0x00020000
    v_mfma_f32_16x16x32_bf16 v[36:39], a[0:3], a[32:35], v[36:39]
    s_mov_b32 s3, 4194304
    buffer_load_dword a254, v26, s[72:75], s3 offen
    v_mfma_f32_16x16x32_bf16 v[40:43], a[0:3], a[36:39], v[40:43]
    buffer_load_dword v29, v30, s[68:71], 0 offen sc1
    v_mfma_f32_16x16x32_bf16 v[44:47], a[0:3], a[40:43], v[44:47]
    v_mfma_f32_16x16x32_bf16 v[48:51], a[0:3], a[44:47], v[48:51]
    s_lshr_b32 s3, s2, 4
    s_lshl_b32 s3, s3, 7
    s_lshl_b32 s81, s24, 5
    v_mfma_f32_16x16x32_bf16 v[52:55], a[0:3], a[48:51], v[52:55]
    ds_read_b128 a[88:91], v23 offset:0
    v_mfma_f32_16x16x32_bf16 v[56:59], a[0:3], a[52:55], v[56:59]
    v_mfma_f32_16x16x32_bf16 v[60:63], a[0:3], a[56:59], v[60:63]
    ds_read_b128 a[92:95], v23 offset:2048
    v_mfma_f32_16x16x32_bf16 v[64:67], a[4:7], a[28:31], v[64:67]
    ds_read_b128 a[96:99], v23 offset:4096
    s_add_u32 s3, s3, s81
    v_lshrrev_b32 v224, 4, v1
    v_lshl_add_u32 v224, v224, 3, s3
    v_mfma_f32_16x16x32_bf16 v[68:71], a[4:7], a[32:35], v[68:71]
    v_mfma_f32_16x16x32_bf16 v[72:75], a[4:7], a[36:39], v[72:75]
    ds_read_b128 a[100:103], v23 offset:6144
    v_mfma_f32_16x16x32_bf16 v[76:79], a[4:7], a[40:43], v[76:79]
    s_and_b32 s3, s2, 15
    s_lshl_b32 s3, s3, 6
    v_and_b32 v225, 15, v1
    v_mfma_f32_16x16x32_bf16 v[80:83], a[4:7], a[44:47], v[80:83]
    ds_read_b128 a[104:107], v23 offset:8192
    v_mfma_f32_16x16x32_bf16 v[84:87], a[4:7], a[48:51], v[84:87]
    v_mfma_f32_16x16x32_bf16 v[88:91], a[4:7], a[52:55], v[88:91]
    ds_read_b128 a[108:111], v23 offset:10240
    v_lshl_add_u32 v225, v225, 2, s3
    v_lshlrev_b32 v226, 11, v224
    v_lshl_add_u32 v226, v225, 1, v226
    v_mfma_f32_16x16x32_bf16 v[92:95], a[4:7], a[56:59], v[92:95]
    ds_read_b128 a[112:115], v23 offset:12288
    v_mfma_f32_16x16x32_bf16 v[96:99], a[8:11], a[28:31], v[96:99]
    v_mfma_f32_16x16x32_bf16 v[100:103], a[8:11], a[32:35], v[100:103]
    ds_read_b128 a[116:119], v23 offset:14336
    v_mfma_f32_16x16x32_bf16 v[104:107], a[8:11], a[36:39], v[104:107]
    v_subrev_u32 v227, 6144, v226
    v_cmp_eq_u32 vcc, 0, v224
    v_lshlrev_b32 v228, 3, v225
    v_mfma_f32_16x16x32_bf16 v[108:111], a[8:11], a[40:43], v[108:111]
    ds_read_b64_tr_b16 a[60:61], v20 offset:16384
    v_mfma_f32_16x16x32_bf16 v[112:115], a[8:11], a[44:47], v[112:115]
    v_lshlrev_b32 v28, 12, v225
    v_cndmask_b32 v227, v227, v31, vcc
    v_sub_u32 v224, 2040, v224
    v_mfma_f32_16x16x32_bf16 v[116:119], a[8:11], a[48:51], v[116:119]
    ds_read_b64_tr_b16 a[62:63], v20 offset:18176
    v_mfma_f32_16x16x32_bf16 v[120:123], a[8:11], a[52:55], v[120:123]
    ds_read_b64_tr_b16 a[64:65], v20 offset:16416
    v_mfma_f32_16x16x32_bf16 v[124:127], a[8:11], a[56:59], v[124:127]
    v_mfma_f32_16x16x32_bf16 v[128:131], a[12:15], a[28:31], v[128:131]
    ds_read_b64_tr_b16 a[66:67], v20 offset:18208
    v_lshl_add_u32 v28, v224, 1, v28
    v_add_u32 v224, 4096, v226
    v_add_u32 v225, 8192, v226
    v_mfma_f32_16x16x32_bf16 v[132:135], a[12:15], a[32:35], v[132:135]
    v_mfma_f32_16x16x32_bf16 v[136:139], a[12:15], a[36:39], v[136:139]
    ds_read_b64_tr_b16 a[68:69], v20 offset:16448
    v_add_u32 v229, 12288, v226
    v_add_u32 v230, 4096, v227
    v_mfma_f32_16x16x32_bf16 v[140:143], a[12:15], a[40:43], v[140:143]
    v_mfma_f32_16x16x32_bf16 v[144:147], a[12:15], a[44:47], v[144:147]
    ds_read_b64_tr_b16 a[70:71], v20 offset:18240
    v_mfma_f32_16x16x32_bf16 v[148:151], a[12:15], a[48:51], v[148:151]
    ds_read_b64_tr_b16 a[72:73], v20 offset:24576
    v_mfma_f32_16x16x32_bf16 v[152:155], a[12:15], a[52:55], v[152:155]
    s_mov_b32 s64, s10
    s_mov_b32 s65, s11
    s_mov_b32 s66, 8192
    s_mov_b32 s67, 0x00020000
    v_mfma_f32_16x16x32_bf16 v[156:159], a[12:15], a[56:59], v[156:159]
    ds_read_b64_tr_b16 a[74:75], v20 offset:26368
    v_mfma_f32_16x16x32_bf16 v[160:163], a[16:19], a[28:31], v[160:163]
    buffer_load_dwordx4 a[208:211], v228, s[64:67], 0 offen
    buffer_load_dwordx4 a[212:215], v228, s[64:67], 0 offen offset:16
    v_mfma_f32_16x16x32_bf16 v[164:167], a[16:19], a[32:35], v[164:167]
    ds_read_b64_tr_b16 a[76:77], v20 offset:24608
    v_mfma_f32_16x16x32_bf16 v[168:171], a[16:19], a[36:39], v[168:171]
    v_mfma_f32_16x16x32_bf16 v[172:175], a[16:19], a[40:43], v[172:175]
    ds_read_b64_tr_b16 a[78:79], v20 offset:26400
    v_mfma_f32_16x16x32_bf16 v[176:179], a[16:19], a[44:47], v[176:179]
    ds_read_b64_tr_b16 a[80:81], v20 offset:24640
    v_mfma_f32_16x16x32_bf16 v[180:183], a[16:19], a[48:51], v[180:183]
    s_mov_b32 s64, s6
    s_mov_b32 s65, s7
    s_mov_b32 s66, 4194304
    s_mov_b32 s67, 0x00020000
    v_mfma_f32_16x16x32_bf16 v[184:187], a[16:19], a[52:55], v[184:187]
    ds_read_b64_tr_b16 a[82:83], v20 offset:26432
    buffer_load_dwordx2 a[216:217], v227, s[64:67], 0 offen
    v_mfma_f32_16x16x32_bf16 v[188:191], a[16:19], a[56:59], v[188:191]
    buffer_load_dwordx2 a[218:219], v227, s[64:67], 0 offen offset:2048
    v_mfma_f32_16x16x32_bf16 v[192:195], a[20:23], a[28:31], v[192:195]
    ds_read_b64_tr_b16 a[84:85], v21 offset:16384
    buffer_load_dwordx2 a[220:221], v230, s[64:67], 0 offen
    v_mfma_f32_16x16x32_bf16 v[196:199], a[20:23], a[32:35], v[196:199]
    buffer_load_dwordx2 a[222:223], v226, s[64:67], 0 offen offset:0
    v_mfma_f32_16x16x32_bf16 v[200:203], a[20:23], a[36:39], v[200:203]
    ds_read_b64_tr_b16 a[86:87], v21 offset:18176
    buffer_load_dwordx2 a[224:225], v226, s[64:67], 0 offen offset:2048
    v_mfma_f32_16x16x32_bf16 v[204:207], a[20:23], a[40:43], v[204:207]
    buffer_load_dwordx2 a[226:227], v224, s[64:67], 0 offen offset:0
    v_mfma_f32_16x16x32_bf16 v[208:211], a[20:23], a[44:47], v[208:211]
    buffer_load_dwordx2 a[228:229], v224, s[64:67], 0 offen offset:2048
    v_mfma_f32_16x16x32_bf16 v[212:215], a[20:23], a[48:51], v[212:215]
    buffer_load_dwordx2 a[230:231], v225, s[64:67], 0 offen offset:0
    v_mfma_f32_16x16x32_bf16 v[216:219], a[20:23], a[52:55], v[216:219]
    buffer_load_dwordx2 a[232:233], v225, s[64:67], 0 offen offset:2048
    buffer_load_dwordx2 a[234:235], v229, s[64:67], 0 offen offset:0
    v_mfma_f32_16x16x32_bf16 v[220:223], a[20:23], a[56:59], v[220:223]
    buffer_load_dwordx2 a[236:237], v229, s[64:67], 0 offen offset:2048
    v_mfma_f32_16x16x32_bf16 a[128:131], a[24:27], a[28:31], a[128:131]
    v_mfma_f32_16x16x32_bf16 a[132:135], a[24:27], a[32:35], a[132:135]
    v_mfma_f32_16x16x32_bf16 a[136:139], a[24:27], a[36:39], a[136:139]
    v_mfma_f32_16x16x32_bf16 a[140:143], a[24:27], a[40:43], a[140:143]
    v_mfma_f32_16x16x32_bf16 a[144:147], a[24:27], a[44:47], a[144:147]
    v_mfma_f32_16x16x32_bf16 a[148:151], a[24:27], a[48:51], a[148:151]
    s_waitcnt vmcnt(23)
    v_mfma_f32_16x16x32_bf16 a[152:155], a[24:27], a[52:55], a[152:155]
    v_mfma_f32_16x16x32_bf16 a[156:159], a[24:27], a[56:59], a[156:159]
    s_waitcnt lgkmcnt(0)
    s_barrier
    v_mfma_f32_16x16x32_bf16 v[32:35], a[60:63], a[88:91], v[32:35]
    s_mov_b32 s64, s8
    s_mov_b32 s65, s9
    s_mov_b32 s66, 4194304
    s_mov_b32 s67, 0x00020000
    v_mfma_f32_16x16x32_bf16 v[36:39], a[60:63], a[92:95], v[36:39]
    buffer_load_dwordx2 a[238:239], v226, s[64:67], 0 offen offset:0
    v_mfma_f32_16x16x32_bf16 v[40:43], a[60:63], a[96:99], v[40:43]
    buffer_load_dwordx2 a[240:241], v226, s[64:67], 0 offen offset:2048
    v_mfma_f32_16x16x32_bf16 v[44:47], a[60:63], a[100:103], v[44:47]
    buffer_load_dwordx2 a[242:243], v224, s[64:67], 0 offen offset:0
    v_mfma_f32_16x16x32_bf16 v[48:51], a[60:63], a[104:107], v[48:51]
    buffer_load_dwordx2 a[244:245], v224, s[64:67], 0 offen offset:2048
    v_mfma_f32_16x16x32_bf16 v[52:55], a[60:63], a[108:111], v[52:55]
    buffer_load_dwordx2 a[246:247], v225, s[64:67], 0 offen offset:0
    v_mfma_f32_16x16x32_bf16 v[56:59], a[60:63], a[112:115], v[56:59]
    buffer_load_dwordx2 a[248:249], v225, s[64:67], 0 offen offset:2048
    v_mfma_f32_16x16x32_bf16 v[60:63], a[60:63], a[116:119], v[60:63]
    buffer_load_dwordx2 a[250:251], v229, s[64:67], 0 offen offset:0
    v_mfma_f32_16x16x32_bf16 v[64:67], a[64:67], a[88:91], v[64:67]
    buffer_load_dwordx2 a[252:253], v229, s[64:67], 0 offen offset:2048
    v_mfma_f32_16x16x32_bf16 v[68:71], a[64:67], a[92:95], v[68:71]
    s_add_u32 s64, s18, 4194304
    s_addc_u32 s65, s19, 0
    s_mov_b32 s66, 4194304
    s_mov_b32 s67, 0x00020000
    v_mfma_f32_16x16x32_bf16 v[72:75], a[64:67], a[96:99], v[72:75]
    s_add_u32 s60, s60, 32768
    s_cmp_eq_u32 s60, 98304
    s_cselect_b32 s60, 0, s60
    v_mfma_f32_16x16x32_bf16 v[76:79], a[64:67], a[100:103], v[76:79]
    v_add_u32 v22, s60, v24
    v_add_u32 v23, s60, v25
    v_mfma_f32_16x16x32_bf16 v[80:83], a[64:67], a[104:107], v[80:83]
    ds_read_b128 a[28:31], v22 offset:0
    v_mfma_f32_16x16x32_bf16 v[84:87], a[64:67], a[108:111], v[84:87]
    ds_read_b128 a[32:35], v22 offset:2048
    v_mfma_f32_16x16x32_bf16 v[88:91], a[64:67], a[112:115], v[88:91]
    s_mov_b32 m0, s40
    s_nop 0
    buffer_load_dwordx4 v4, s[32:35], s36 offen lds
    v_mfma_f32_16x16x32_bf16 v[92:95], a[64:67], a[116:119], v[92:95]
    ds_read_b128 a[36:39], v22 offset:4096
    v_mfma_f32_16x16x32_bf16 v[96:99], a[68:71], a[88:91], v[96:99]
    ds_read_b128 a[40:43], v22 offset:6144
    v_mfma_f32_16x16x32_bf16 v[100:103], a[68:71], a[92:95], v[100:103]
    buffer_load_dwordx4 v5, s[32:35], s36 offen offset:1024 lds
    v_mfma_f32_16x16x32_bf16 v[104:107], a[68:71], a[96:99], v[104:107]
    ds_read_b128 a[44:47], v22 offset:8192
    v_mfma_f32_16x16x32_bf16 v[108:111], a[68:71], a[100:103], v[108:111]
    ds_read_b128 a[48:51], v22 offset:10240
    v_mfma_f32_16x16x32_bf16 v[112:115], a[68:71], a[104:107], v[112:115]
    buffer_load_dwordx4 v6, s[32:35], s36 offen offset:2048 lds
    v_mfma_f32_16x16x32_bf16 v[116:119], a[68:71], a[108:111], v[116:119]
    ds_read_b128 a[52:55], v22 offset:12288
    v_mfma_f32_16x16x32_bf16 v[120:123], a[68:71], a[112:115], v[120:123]
    ds_read_b128 a[56:59], v22 offset:14336
    v_mfma_f32_16x16x32_bf16 v[124:127], a[68:71], a[116:119], v[124:127]
    buffer_load_dwordx4 v7, s[32:35], s36 offen offset:3072 lds
    v_mfma_f32_16x16x32_bf16 v[128:131], a[72:75], a[88:91], v[128:131]
    ds_read_b64_tr_b16 a[0:1], v20 offset:32768
    v_mfma_f32_16x16x32_bf16 v[132:135], a[72:75], a[92:95], v[132:135]
    ds_read_b64_tr_b16 a[2:3], v20 offset:34560
    v_mfma_f32_16x16x32_bf16 v[136:139], a[72:75], a[96:99], v[136:139]
    s_add_u32 m0, s40, 4096
    s_add_u32 s40, s40, 32768
    buffer_load_dwordx4 v8, s[32:35], s36 offen lds
    v_mfma_f32_16x16x32_bf16 v[140:143], a[72:75], a[100:103], v[140:143]
    ds_read_b64_tr_b16 a[4:5], v20 offset:32800
    v_mfma_f32_16x16x32_bf16 v[144:147], a[72:75], a[104:107], v[144:147]
    ds_read_b64_tr_b16 a[6:7], v20 offset:34592
    v_mfma_f32_16x16x32_bf16 v[148:151], a[72:75], a[108:111], v[148:151]
    s_cmp_eq_u32 s40, s42
    s_cselect_b32 s40, s41, s40
    buffer_load_dwordx4 v9, s[32:35], s36 offen offset:1024 lds
    v_mfma_f32_16x16x32_bf16 v[152:155], a[72:75], a[112:115], v[152:155]
    ds_read_b64_tr_b16 a[8:9], v20 offset:32832
    v_mfma_f32_16x16x32_bf16 v[156:159], a[72:75], a[116:119], v[156:159]
    ds_read_b64_tr_b16 a[10:11], v20 offset:34624
    v_mfma_f32_16x16x32_bf16 v[160:163], a[76:79], a[88:91], v[160:163]
    buffer_load_dwordx4 v10, s[32:35], s36 offen offset:2048 lds
    v_mfma_f32_16x16x32_bf16 v[164:167], a[76:79], a[92:95], v[164:167]
    ds_read_b64_tr_b16 a[12:13], v20 offset:40960
    v_mfma_f32_16x16x32_bf16 v[168:171], a[76:79], a[96:99], v[168:171]
    ds_read_b64_tr_b16 a[14:15], v20 offset:42752
    v_mfma_f32_16x16x32_bf16 v[172:175], a[76:79], a[100:103], v[172:175]
    buffer_load_dwordx4 v11, s[32:35], s36 offen offset:3072 lds
    s_add_u32 s36, s36, s37
    s_cmp_eq_u32 s36, s39
    s_cselect_b32 s36, s38, s36
    v_mfma_f32_16x16x32_bf16 v[176:179], a[76:79], a[104:107], v[176:179]
    ds_read_b64_tr_b16 a[16:17], v20 offset:40992
    v_mfma_f32_16x16x32_bf16 v[180:183], a[76:79], a[108:111], v[180:183]
    ds_read_b64_tr_b16 a[18:19], v20 offset:42784
    v_mfma_f32_16x16x32_bf16 v[184:187], a[76:79], a[112:115], v[184:187]
    s_mov_b32 m0, s52
    s_nop 0
    buffer_load_dwordx4 v12, s[44:47], s48 offen lds
    v_mfma_f32_16x16x32_bf16 v[188:191], a[76:79], a[116:119], v[188:191]
    ds_read_b64_tr_b16 a[20:21], v20 offset:41024
    v_mfma_f32_16x16x32_bf16 v[192:195], a[80:83], a[88:91], v[192:195]
    ds_read_b64_tr_b16 a[22:23], v20 offset:42816
    v_mfma_f32_16x16x32_bf16 v[196:199], a[80:83], a[92:95], v[196:199]
    buffer_load_dwordx4 v13, s[44:47], s48 offen offset:1024 lds
    v_mfma_f32_16x16x32_bf16 v[200:203], a[80:83], a[96:99], v[200:203]
    ds_read_b64_tr_b16 a[24:25], v21 offset:32768
    v_mfma_f32_16x16x32_bf16 v[204:207], a[80:83], a[100:103], v[204:207]
    ds_read_b64_tr_b16 a[26:27], v21 offset:34560
    v_mfma_f32_16x16x32_bf16 v[208:211], a[80:83], a[104:107], v[208:211]
    buffer_load_dwordx4 v14, s[44:47], s48 offen offset:2048 lds
    v_mfma_f32_16x16x32_bf16 v[212:215], a[80:83], a[108:111], v[212:215]
    v_mfma_f32_16x16x32_bf16 v[216:219], a[80:83], a[112:115], v[216:219]
    v_mfma_f32_16x16x32_bf16 v[220:223], a[80:83], a[116:119], v[220:223]
    v_mfma_f32_16x16x32_bf16 a[128:131], a[84:87], a[88:91], a[128:131]
    v_mfma_f32_16x16x32_bf16 a[132:135], a[84:87], a[92:95], a[132:135]
    v_mfma_f32_16x16x32_bf16 a[136:139], a[84:87], a[96:99], a[136:139]
    v_mfma_f32_16x16x32_bf16 a[140:143], a[84:87], a[100:103], a[140:143]
    v_mfma_f32_16x16x32_bf16 a[144:147], a[84:87], a[104:107], a[144:147]
    v_mfma_f32_16x16x32_bf16 a[148:151], a[84:87], a[108:111], a[148:151]
    s_waitcnt vmcnt(34)
    v_mfma_f32_16x16x32_bf16 a[152:155], a[84:87], a[112:115], a[152:155]
    v_mfma_f32_16x16x32_bf16 a[156:159], a[84:87], a[116:119], a[156:159]
    s_waitcnt lgkmcnt(0)
    s_barrier
    v_mfma_f32_16x16x32_bf16 v[32:35], a[0:3], a[28:31], v[32:35]
    ds_read_b128 a[88:91], v23 offset:0
    v_mfma_f32_16x16x32_bf16 v[36:39], a[0:3], a[32:35], v[36:39]
    ds_read_b128 a[92:95], v23 offset:2048
    v_mfma_f32_16x16x32_bf16 v[40:43], a[0:3], a[36:39], v[40:43]
    buffer_load_dwordx4 v15, s[44:47], s48 offen offset:3072 lds
    v_mfma_f32_16x16x32_bf16 v[44:47], a[0:3], a[40:43], v[44:47]
    v_mfma_f32_16x16x32_bf16 v[48:51], a[0:3], a[44:47], v[48:51]
    ds_read_b128 a[96:99], v23 offset:4096
    v_mfma_f32_16x16x32_bf16 v[52:55], a[0:3], a[48:51], v[52:55]
    ds_read_b128 a[100:103], v23 offset:6144
    v_mfma_f32_16x16x32_bf16 v[56:59], a[0:3], a[52:55], v[56:59]
    s_add_u32 m0, s52, 4096
    s_add_u32 s52, s52, 32768
    buffer_load_dwordx4 v16, s[44:47], s48 offen lds
    v_mfma_f32_16x16x32_bf16 v[60:63], a[0:3], a[56:59], v[60:63]
    v_mfma_f32_16x16x32_bf16 v[64:67], a[4:7], a[28:31], v[64:67]
    ds_read_b128 a[104:107], v23 offset:8192
    v_mfma_f32_16x16x32_bf16 v[68:71], a[4:7], a[32:35], v[68:71]
    ds_read_b128 a[108:111], v23 offset:10240
    v_mfma_f32_16x16x32_bf16 v[72:75], a[4:7], a[36:39], v[72:75]
    v_mfma_f32_16x16x32_bf16 v[76:79], a[4:7], a[40:43], v[76:79]
    s_cmp_eq_u32 s52, s54
    s_cselect_b32 s52, s53, s52
    buffer_load_dwordx4 v17, s[44:47], s48 offen offset:1024 lds
    v_mfma_f32_16x16x32_bf16 v[80:83], a[4:7], a[44:47], v[80:83]
    ds_read_b128 a[112:115], v23 offset:12288
    v_mfma_f32_16x16x32_bf16 v[84:87], a[4:7], a[48:51], v[84:87]
    ds_read_b128 a[116:119], v23 offset:14336
    v_mfma_f32_16x16x32_bf16 v[88:91], a[4:7], a[52:55], v[88:91]
    v_mfma_f32_16x16x32_bf16 v[92:95], a[4:7], a[56:59], v[92:95]
    buffer_load_dwordx4 v18, s[44:47], s48 offen offset:2048 lds
    v_mfma_f32_16x16x32_bf16 v[96:99], a[8:11], a[28:31], v[96:99]
    ds_read_b64_tr_b16 a[60:61], v20 offset:49152
    v_mfma_f32_16x16x32_bf16 v[100:103], a[8:11], a[32:35], v[100:103]
    ds_read_b64_tr_b16 a[62:63], v20 offset:50944
    v_mfma_f32_16x16x32_bf16 v[104:107], a[8:11], a[36:39], v[104:107]
    v_mfma_f32_16x16x32_bf16 v[108:111], a[8:11], a[40:43], v[108:111]
    buffer_load_dwordx4 v19, s[44:47], s48 offen offset:3072 lds
    s_add_u32 s48, s48, s49
    s_cmp_eq_u32 s48, s51
    s_cselect_b32 s48, s50, s48
    v_mfma_f32_16x16x32_bf16 v[112:115], a[8:11], a[44:47], v[112:115]
    ds_read_b64_tr_b16 a[64:65], v20 offset:49184
    s_waitcnt vmcnt(16)
    v_mfma_f32_16x16x32_bf16 v[116:119], a[8:11], a[48:51], v[116:119]
    v_mfma_f32_16x16x32_bf16 v[120:123], a[8:11], a[52:55], v[120:123]
    ds_read_b64_tr_b16 a[66:67], v20 offset:50976
    v_mfma_f32_16x16x32_bf16 v[124:127], a[8:11], a[56:59], v[124:127]
    s_mov_b32 m0, s40
    s_nop 0
    buffer_load_dwordx4 v4, s[32:35], s36 offen lds
    v_mfma_f32_16x16x32_bf16 v[128:131], a[12:15], a[28:31], v[128:131]
    ds_read_b64_tr_b16 a[68:69], v20 offset:49216
    v_mfma_f32_16x16x32_bf16 v[132:135], a[12:15], a[32:35], v[132:135]
    s_mov_b32 s90, 0
La_tchk:
    v_readfirstlane_b32 s63, v29
    s_cmp_lg_u32 s24, 0
    s_cselect_b32 s3, 1, s63
    s_cmp_eq_u32 s3, 0
    s_cbranch_scc1 La_tspin
La_tgo:
    v_mfma_f32_16x16x32_bf16 v[136:139], a[12:15], a[36:39], v[136:139]
    ds_read_b64_tr_b16 a[70:71], v20 offset:51008
    v_mfma_f32_16x16x32_bf16 v[140:143], a[12:15], a[40:43], v[140:143]
    buffer_load_dwordx4 v5, s[32:35], s36 offen offset:1024 lds
    v_mfma_f32_16x16x32_bf16 v[144:147], a[12:15], a[44:47], v[144:147]
    ds_read_b64_tr_b16 a[72:73], v20 offset:57344
    v_mfma_f32_16x16x32_bf16 v[148:151], a[12:15], a[48:51], v[148:151]
    s_add_u32 s68, s18, 524288
    s_addc_u32 s69, s19, 0
    s_mov_b32 s70, 8192
    s_mov_b32 s71, 0x00020000
    v_mfma_f32_16x16x32_bf16 v[152:155], a[12:15], a[52:55], v[152:155]
    ds_read_b64_tr_b16 a[74:75], v20 offset:59136
    v_mfma_f32_16x16x32_bf16 v[156:159], a[12:15], a[56:59], v[156:159]
    buffer_load_dwordx4 v6, s[32:35], s36 offen offset:2048 lds
    v_mfma_f32_16x16x32_bf16 v[160:163], a[16:19], a[28:31], v[160:163]
    v_mov_b32 v29, s63
    s_lshl_b32 s3, s25, 7
    s_lshl_b32 s81, s26, 2
    s_add_u32 s3, s3, s81
    v_mfma_f32_16x16x32_bf16 v[164:167], a[16:19], a[32:35], v[164:167]
    ds_read_b64_tr_b16 a[76:77], v20 offset:57376
    v_mfma_f32_16x16x32_bf16 v[168:171], a[16:19], a[36:39], v[168:171]
    ds_read_b64_tr_b16 a[78:79], v20 offset:59168
    v_mfma_f32_16x16x32_bf16 v[172:175], a[16:19], a[40:43], v[172:175]
    buffer_load_dwordx4 v7, s[32:35], s36 offen offset:3072 lds
    v_writelane_b32 v30, s3, 0
    s_lshl_b32 s3, s26, 7
    s_lshl_b32 s81, s25, 2
    s_add_u32 s3, s3, s81
    v_mfma_f32_16x16x32_bf16 v[176:179], a[16:19], a[44:47], v[176:179]
    v_mfma_f32_16x16x32_bf16 v[180:183], a[16:19], a[48:51], v[180:183]
    ds_read_b64_tr_b16 a[80:81], v20 offset:57408
    v_mfma_f32_16x16x32_bf16 v[184:187], a[16:19], a[52:55], v[184:187]
    ds_read_b64_tr_b16 a[82:83], v20 offset:59200
    s_add_u32 s3, s3, 1024
    v_writelane_b32 v30, s3, 1
    s_lshl_b32 s3, s24, 20
    v_add_u32 v3, s3, v30
    v_mfma_f32_16x16x32_bf16 v[188:191], a[16:19], a[56:59], v[188:191]
    s_add_u32 m0, s40, 4096
    s_add_u32 s40, s40, 32768
    buffer_load_dwordx4 v8, s[32:35], s36 offen lds
    v_mfma_f32_16x16x32_bf16 v[192:195], a[20:23], a[28:31], v[192:195]
    v_accvgpr_read_b32 v254, a208
    v_lshlrev_b32 v224, 16, v254
    v_mfma_f32_16x16x32_bf16 v[196:199], a[20:23], a[32:35], v[196:199]
    ds_read_b64_tr_b16 a[84:85], v21 offset:49152
    v_and_b32 v226, 0xffff0000, v254
    v_mfma_f32_16x16x32_bf16 v[200:203], a[20:23], a[36:39], v[200:203]
    ds_read_b64_tr_b16 a[86:87], v21 offset:50944
    v_accvgpr_read_b32 v255, a209
    v_mfma_f32_16x16x32_bf16 v[204:207], a[20:23], a[40:43], v[204:207]
    v_lshlrev_b32 v228, 16, v255
    v_and_b32 v230, 0xffff0000, v255
    v_mfma_f32_16x16x32_bf16 v[208:211], a[20:23], a[44:47], v[208:211]
    v_accvgpr_read_b32 v254, a210
    v_lshlrev_b32 v225, 16, v254
    v_mfma_f32_16x16x32_bf16 v[212:215], a[20:23], a[48:51], v[212:215]
    v_and_b32 v227, 0xffff0000, v254
    v_accvgpr_read_b32 v255, a211
    v_mfma_f32_16x16x32_bf16 v[216:219], a[20:23], a[52:55], v[216:219]
    v_lshlrev_b32 v229, 16, v255
    v_and_b32 v231, 0xffff0000, v255
    v_mfma_f32_16x16x32_bf16 v[220:223], a[20:23], a[56:59], v[220:223]
    v_accvgpr_read_b32 v254, a216
    v_lshlrev_b32 v232, 16, v254
    v_mfma_f32_16x16x32_bf16 a[128:131], a[24:27], a[28:31], a[128:131]
    v_and_b32 v233, 0xffff0000, v254
    v_accvgpr_read_b32 v255, a218
    v_mfma_f32_16x16x32_bf16 a[132:135], a[24:27], a[32:35], a[132:135]
    v_lshlrev_b32 v234, 16, v255
    v_and_b32 v235, 0xffff0000, v255
    v_mfma_f32_16x16x32_bf16 a[136:139], a[24:27], a[36:39], a[136:139]
    v_accvgpr_read_b32 v254, a220
    v_lshlrev_b32 v236, 16, v254
    v_mfma_f32_16x16x32_bf16 a[140:143], a[24:27], a[40:43], a[140:143]
    v_and_b32 v237, 0xffff0000, v254
    v_accvgpr_read_b32 v254, a222
    v_mfma_f32_16x16x32_bf16 a[144:147], a[24:27], a[44:47], a[144:147]
    v_lshlrev_b32 v238, 16, v254
    v_and_b32 v239, 0xffff0000, v254
    v_mfma_f32_16x16x32_bf16 a[148:151], a[24:27], a[48:51], a[148:151]
    v_accvgpr_read_b32 v255, a238
    v_lshlrev_b32 v244, 16, v255
    s_waitcnt vmcnt(13)
    v_mfma_f32_16x16x32_bf16 a[152:155], a[24:27], a[52:55], a[152:155]
    v_and_b32 v245, 0xffff0000, v255
    v_mul_f32 v240, v232, v230
    v_mfma_f32_16x16x32_bf16 a[156:159], a[24:27], a[56:59], a[156:159]
    v_mul_f32 v241, v233, v231
    v_fmac_f32 v240, v234, v228
    s_waitcnt lgkmcnt(0)
    s_barrier
    v_mfma_f32_16x16x32_bf16 v[32:35], a[60:63], a[88:91], v[32:35]
    buffer_store_dword v29, v3, s[68:71], 0 offen sc1
    v_fmac_f32 v241, v235, v229
    v_mfma_f32_16x16x32_bf16 v[36:39], a[60:63], a[92:95], v[36:39]
    s_add_u32 s60, s60, 32768
    s_cmp_eq_u32 s60, 98304
    s_cselect_b32 s60, 0, s60
    v_mfma_f32_16x16x32_bf16 v[40:43], a[60:63], a[96:99], v[40:43]
    v_add_u32 v22, s60, v24
    v_add_u32 v23, s60, v25
    v_mfma_f32_16x16x32_bf16 v[44:47], a[60:63], a[100:103], v[44:47]
    ds_read_b128 a[28:31], v22 offset:0
    v_fmac_f32 v240, v236, v226
    v_mfma_f32_16x16x32_bf16 v[48:51], a[60:63], a[104:107], v[48:51]
    ds_read_b128 a[32:35], v22 offset:2048
    v_fmac_f32 v241, v237, v227
    v_mfma_f32_16x16x32_bf16 v[52:55], a[60:63], a[108:111], v[52:55]
    v_fmac_f32 v240, v238, v224
    v_fmac_f32 v241, v239, v225
    v_mfma_f32_16x16x32_bf16 v[56:59], a[60:63], a[112:115], v[56:59]
    s_cmp_eq_u32 s40, s42
    s_cselect_b32 s40, s41, s40
    buffer_load_dwordx4 v9, s[32:35], s36 offen offset:1024 lds
    v_mfma_f32_16x16x32_bf16 v[60:63], a[60:63], a[116:119], v[60:63]
    ds_read_b128 a[36:39], v22 offset:4096
    v_mul_f32 v240, v240, v244
    v_mfma_f32_16x16x32_bf16 v[64:67], a[64:67], a[88:91], v[64:67]
    ds_read_b128 a[40:43], v22 offset:6144
    v_mul_f32 v241, v241, v245
    v_mfma_f32_16x16x32_bf16 v[68:71], a[64:67], a[92:95], v[68:71]
    buffer_load_dwordx4 v10, s[32:35], s36 offen offset:2048 lds
    v_accvgpr_read_b32 v254, a224
    v_mfma_f32_16x16x32_bf16 v[72:75], a[64:67], a[96:99], v[72:75]
    v_lshlrev_b32 v232, 16, v254
    v_and_b32 v233, 0xffff0000, v254
    v_mfma_f32_16x16x32_bf16 v[76:79], a[64:67], a[100:103], v[76:79]
    ds_read_b128 a[44:47], v22 offset:8192
    v_accvgpr_read_b32 v255, a240
    v_mfma_f32_16x16x32_bf16 v[80:83], a[64:67], a[104:107], v[80:83]
    ds_read_b128 a[48:51], v22 offset:10240
    v_lshlrev_b32 v244, 16, v255
    v_mfma_f32_16x16x32_bf16 v[84:87], a[64:67], a[108:111], v[84:87]
    buffer_load_dwordx4 v11, s[32:35], s36 offen offset:3072 lds
    s_add_u32 s36, s36, s37
    s_cmp_eq_u32 s36, s39
    s_cselect_b32 s36, s38, s36
    v_and_b32 v245, 0xffff0000, v255
    v_mfma_f32_16x16x32_bf16 v[88:91], a[64:67], a[112:115], v[88:91]
    ds_read_b128 a[52:55], v22 offset:12288
    v_mul_f32 v242, v234, v230
    v_mfma_f32_16x16x32_bf16 v[92:95], a[64:67], a[116:119], v[92:95]
    ds_read_b128 a[56:59], v22 offset:14336
    v_mul_f32 v243, v235, v231
    v_mfma_f32_16x16x32_bf16 v[96:99], a[68:71], a[88:91], v[96:99]
    v_fmac_f32 v242, v236, v228
    v_fmac_f32 v243, v237, v229
    v_mfma_f32_16x16x32_bf16 v[100:103], a[68:71], a[92:95], v[100:103]
    s_mov_b32 m0, s52
    s_nop 0
    buffer_load_dwordx4 v12, s[44:47], s48 offen lds
    v_mfma_f32_16x16x32_bf16 v[104:107], a[68:71], a[96:99], v[104:107]
    ds_read_b64_tr_b16 a[0:1], v20 offset:0
    v_fmac_f32 v242, v238, v226
    v_mfma_f32_16x16x32_bf16 v[108:111], a[68:71], a[100:103], v[108:111]
    ds_read_b64_tr_b16 a[2:3], v20 offset:1792
    v_fmac_f32 v243, v239, v227
    v_mfma_f32_16x16x32_bf16 v[112:115], a[68:71], a[104:107], v[112:115]
    buffer_load_dwordx4 v13, s[44:47], s48 offen offset:1024 lds
    v_fmac_f32 v242, v232, v224
    v_mfma_f32_16x16x32_bf16 v[116:119], a[68:71], a[108:111], v[116:119]
    v_fmac_f32 v243, v233, v225
    v_mul_f32 v242, v242, v244
    v_mfma_f32_16x16x32_bf16 v[120:123], a[68:71], a[112:115], v[120:123]
    ds_read_b64_tr_b16 a[4:5], v20 offset:32
    v_mul_f32 v243, v243, v245
    v_mfma_f32_16x16x32_bf16 v[124:127], a[68:71], a[116:119], v[124:127]
    ds_read_b64_tr_b16 a[6:7], v20 offset:1824
    v_cvt_pk_bf16_f32 v249, v242, v240
    v_mfma_f32_16x16x32_bf16 v[128:131], a[72:75], a[88:91], v[128:131]
    buffer_load_dwordx4 v14, s[44:47], s48 offen offset:2048 lds
    v_cvt_pk_bf16_f32 v253, v243, v241
    v_mfma_f32_16x16x32_bf16 v[132:135], a[72:75], a[92:95], v[132:135]
    ds_read_b64_tr_b16 a[8:9], v20 offset:64
    v_accvgpr_read_b32 v254, a226
    v_mfma_f32_16x16x32_bf16 v[136:139], a[72:75], a[96:99], v[136:139]
    ds_read_b64_tr_b16 a[10:11], v20 offset:1856
    v_lshlrev_b32 v234, 16, v254
    v_mfma_f32_16x16x32_bf16 v[140:143], a[72:75], a[100:103], v[140:143]
    v_and_b32 v235, 0xffff0000, v254
    v_accvgpr_read_b32 v255, a242
    v_mfma_f32_16x16x32_bf16 v[144:147], a[72:75], a[104:107], v[144:147]
    buffer_load_dwordx4 v15, s[44:47], s48 offen offset:3072 lds
    v_lshlrev_b32 v244, 16, v255
    v_mfma_f32_16x16x32_bf16 v[148:151], a[72:75], a[108:111], v[148:151]
    ds_read_b64_tr_b16 a[12:13], v20 offset:8192
    v_and_b32 v245, 0xffff0000, v255
    v_mfma_f32_16x16x32_bf16 v[152:155], a[72:75], a[112:115], v[152:155]
    ds_read_b64_tr_b16 a[14:15], v20 offset:9984
    v_mul_f32 v240, v236, v230
    v_mfma_f32_16x16x32_bf16 v[156:159], a[72:75], a[116:119], v[156:159]
    s_add_u32 m0, s52, 4096
    s_add_u32 s52, s52, 32768
    buffer_load_dwordx4 v16, s[44:47], s48 offen lds
    v_mfma_f32_16x16x32_bf16 v[160:163], a[76:79], a[88:91], v[160:163]
    v_mul_f32 v241, v237, v231
    v_fmac_f32 v240, v238, v228
    v_mfma_f32_16x16x32_bf16 v[164:167], a[76:79], a[92:95], v[164:167]
    ds_read_b64_tr_b16 a[16:17], v20 offset:8224
    v_fmac_f32 v241, v239, v229
    v_mfma_f32_16x16x32_bf16 v[168:171], a[76:79], a[96:99], v[168:171]
    ds_read_b64_tr_b16 a[18:19], v20 offset:10016
    v_fmac_f32 v240, v232, v226
    v_mfma_f32_16x16x32_bf16 v[172:175], a[76:79], a[100:103], v[172:175]
    s_cmp_eq_u32 s52, s54
    s_cselect_b32 s52, s53, s52
    buffer_load_dwordx4 v17, s[44:47], s48 offen offset:1024 lds
    v_mfma_f32_16x16x32_bf16 v[176:179], a[76:79], a[104:107], v[176:179]
    ds_read_b64_tr_b16 a[20:21], v20 offset:8256
    v_fmac_f32 v241, v233, v227
    v_mfma_f32_16x16x32_bf16 v[180:183], a[76:79], a[108:111], v[180:183]
    ds_read_b64_tr_b16 a[22:23], v20 offset:10048
    v_fmac_f32 v240, v234, v224
    v_mfma_f32_16x16x32_bf16 v[184:187], a[76:79], a[112:115], v[184:187]
    v_fmac_f32 v241, v235, v225
    v_mul_f32 v240, v240, v244
    v_mfma_f32_16x16x32_bf16 v[188:191], a[76:79], a[116:119], v[188:191]
    buffer_load_dwordx4 v18, s[44:47], s48 offen offset:2048 lds
    v_mul_f32 v241, v241, v245
    v_mfma_f32_16x16x32_bf16 v[192:195], a[80:83], a[88:91], v[192:195]
    ds_read_b64_tr_b16 a[24:25], v21 offset:0
    v_accvgpr_read_b32 v254, a228
    v_mfma_f32_16x16x32_bf16 v[196:199], a[80:83], a[92:95], v[196:199]
    ds_read_b64_tr_b16 a[26:27], v21 offset:1792
    v_lshlrev_b32 v236, 16, v254
    v_and_b32 v237, 0xffff0000, v254
    v_mfma_f32_16x16x32_bf16 v[200:203], a[80:83], a[96:99], v[200:203]
    buffer_load_dwordx4 v19, s[44:47], s48 offen offset:3072 lds
    s_add_u32 s48, s48, s49
    s_cmp_eq_u32 s48, s51
    s_cselect_b32 s48, s50, s48
    v_mfma_f32_16x16x32_bf16 v[204:207], a[80:83], a[100:103], v[204:207]
    v_accvgpr_read_b32 v255, a244
    v_lshlrev_b32 v244, 16, v255
    v_mfma_f32_16x16x32_bf16 v[208:211], a[80:83], a[104:107], v[208:211]
    v_and_b32 v245, 0xffff0000, v255
    v_mul_f32 v242, v238, v230
    v_mfma_f32_16x16x32_bf16 v[212:215], a[80:83], a[108:111], v[212:215]
    v_mul_f32 v243, v239, v231
    v_fmac_f32 v242, v232, v228
    v_mfma_f32_16x16x32_bf16 v[216:219], a[80:83], a[112:115], v[216:219]
    v_fmac_f32 v243, v233, v229
    v_fmac_f32 v242, v234, v226
    v_mfma_f32_16x16x32_bf16 v[220:223], a[80:83], a[116:119], v[220:223]
    v_fmac_f32 v243, v235, v227
    v_fmac_f32 v242, v236, v224
    v_mfma_f32_16x16x32_bf16 a[128:131], a[84:87], a[88:91], a[128:131]
    v_fmac_f32 v243, v237, v225
    v_mul_f32 v242, v242, v244
    v_mfma_f32_16x16x32_bf16 a[132:135], a[84:87], a[92:95], a[132:135]
    v_mul_f32 v243, v243, v245
    v_cvt_pk_bf16_f32 v248, v242, v240
    v_mfma_f32_16x16x32_bf16 a[136:139], a[84:87], a[96:99], a[136:139]
    v_cvt_pk_bf16_f32 v252, v243, v241
    v_accvgpr_read_b32 v254, a230
    v_mfma_f32_16x16x32_bf16 a[140:143], a[84:87], a[100:103], a[140:143]
    v_lshlrev_b32 v238, 16, v254
    v_and_b32 v239, 0xffff0000, v254
    v_mfma_f32_16x16x32_bf16 a[144:147], a[84:87], a[104:107], a[144:147]
    v_accvgpr_read_b32 v255, a246
    v_lshlrev_b32 v244, 16, v255
    v_mfma_f32_16x16x32_bf16 a[148:151], a[84:87], a[108:111], a[148:151]
    v_and_b32 v245, 0xffff0000, v255
    v_mul_f32 v240, v232, v230
    s_waitcnt vmcnt(16)
    v_mfma_f32_16x16x32_bf16 a[152:155], a[84:87], a[112:115], a[152:155]
    v_mul_f32 v241, v233, v231
    v_fmac_f32 v240, v234, v228
    v_mfma_f32_16x16x32_bf16 a[156:159], a[84:87], a[116:119], a[156:159]
    v_fmac_f32 v241, v235, v229
    v_fmac_f32 v240, v236, v226
    s_waitcnt lgkmcnt(0)
    s_barrier
    v_mfma_f32_16x16x32_bf16 v[32:35], a[0:3], a[28:31], v[32:35]
    s_mov_b32 s72, s22
    s_mov_b32 s73, s23
    s_mov_b32 s74, 7340032
    s_mov_b32 s75, 0x00020000
    v_mfma_f32_16x16x32_bf16 v[36:39], a[0:3], a[32:35], v[36:39]
    buffer_load_dword a254, v26, s[72:75], 0 offen
    v_fmac_f32 v241, v237, v227
    v_mfma_f32_16x16x32_bf16 v[40:43], a[0:3], a[36:39], v[40:43]
    v_fmac_f32 v240, v238, v224
    v_fmac_f32 v241, v239, v225
    v_mul_f32 v240, v240, v244
    v_mfma_f32_16x16x32_bf16 v[44:47], a[0:3], a[40:43], v[44:47]
    v_mul_f32 v241, v241, v245
    v_accvgpr_read_b32 v254, a232
    v_mfma_f32_16x16x32_bf16 v[48:51], a[0:3], a[44:47], v[48:51]
    v_lshlrev_b32 v232, 16, v254
    v_and_b32 v233, 0xffff0000, v254
    v_mfma_f32_16x16x32_bf16 v[52:55], a[0:3], a[48:51], v[52:55]
    ds_read_b128 a[88:91], v23 offset:0
    v_accvgpr_read_b32 v255, a248
    v_mfma_f32_16x16x32_bf16 v[56:59], a[0:3], a[52:55], v[56:59]
    v_lshlrev_b32 v244, 16, v255
    v_and_b32 v245, 0xffff0000, v255
    v_mul_f32 v242, v234, v230
    v_mfma_f32_16x16x32_bf16 v[60:63], a[0:3], a[56:59], v[60:63]
    ds_read_b128 a[92:95], v23 offset:2048
    v_mul_f32 v243, v235, v231
    v_mfma_f32_16x16x32_bf16 v[64:67], a[4:7], a[28:31], v[64:67]
    ds_read_b128 a[96:99], v23 offset:4096
    v_fmac_f32 v242, v236, v228
    v_mfma_f32_16x16x32_bf16 v[68:71], a[4:7], a[32:35], v[68:71]
    v_fmac_f32 v243, v237, v229
    v_fmac_f32 v242, v238, v226
    v_mfma_f32_16x16x32_bf16 v[72:75], a[4:7], a[36:39], v[72:75]
    ds_read_b128 a[100:103], v23 offset:6144
    v_fmac_f32 v243, v239, v227
    v_fmac_f32 v242, v232, v224
    v_mfma_f32_16x16x32_bf16 v[76:79], a[4:7], a[40:43], v[76:79]
    v_fmac_f32 v243, v233, v225
    v_mul_f32 v242, v242, v244
    v_mfma_f32_16x16x32_bf16 v[80:83], a[4:7], a[44:47], v[80:83]
    ds_read_b128 a[104:107], v23 offset:8192
    v_mul_f32 v243, v243, v245
    v_mfma_f32_16x16x32_bf16 v[84:87], a[4:7], a[48:51], v[84:87]
    v_cvt_pk_bf16_f32 v247, v242, v240
    v_cvt_pk_bf16_f32 v251, v243, v241
    v_mfma_f32_16x16x32_bf16 v[88:91], a[4:7], a[52:55], v[88:91]
    ds_read_b128 a[108:111], v23 offset:10240
    v_accvgpr_read_b32 v254, a234
    v_mfma_f32_16x16x32_bf16 v[92:95], a[4:7], a[56:59], v[92:95]
    ds_read_b128 a[112:115], v23 offset:12288
    v_lshlrev_b32 v234, 16, v254
    v_and_b32 v235, 0xffff0000, v254
    v_mfma_f32_16x16x32_bf16 v[96:99], a[8:11], a[28:31], v[96:99]
    v_accvgpr_read_b32 v255, a250
    v_lshlrev_b32 v244, 16, v255
    v_mfma_f32_16x16x32_bf16 v[100:103], a[8:11], a[32:35], v[100:103]
    ds_read_b128 a[116:119], v23 offset:14336
    v_and_b32 v245, 0xffff0000, v255
    v_mfma_f32_16x16x32_bf16 v[104:107], a[8:11], a[36:39], v[104:107]
    v_mul_f32 v240, v236, v230
    v_mul_f32 v241, v237, v231
    v_mfma_f32_16x16x32_bf16 v[108:111], a[8:11], a[40:43], v[108:111]
    ds_read_b64_tr_b16 a[60:61], v20 offset:16384
    v_fmac_f32 v240, v238, v228
    v_fmac_f32 v241, v239, v229
    v_mfma_f32_16x16x32_bf16 v[112:115], a[8:11], a[44:47], v[112:115]
    v_fmac_f32 v240, v232, v226
    v_fmac_f32 v241, v233, v227
    v_mfma_f32_16x16x32_bf16 v[116:119], a[8:11], a[48:51], v[116:119]
    ds_read_b64_tr_b16 a[62:63], v20 offset:18176
    v_fmac_f32 v240, v234, v224
    v_mfma_f32_16x16x32_bf16 v[120:123], a[8:11], a[52:55], v[120:123]
    ds_read_b64_tr_b16 a[64:65], v20 offset:16416
    v_fmac_f32 v241, v235, v225
    v_mfma_f32_16x16x32_bf16 v[124:127], a[8:11], a[56:59], v[124:127]
    v_mul_f32 v240, v240, v244
    v_mul_f32 v241, v241, v245
    v_accvgpr_read_b32 v254, a236
    v_mfma_f32_16x16x32_bf16 v[128:131], a[12:15], a[28:31], v[128:131]
    ds_read_b64_tr_b16 a[66:67], v20 offset:18208
    v_lshlrev_b32 v236, 16, v254
    v_mfma_f32_16x16x32_bf16 v[132:135], a[12:15], a[32:35], v[132:135]
    v_and_b32 v237, 0xffff0000, v254
    v_accvgpr_read_b32 v255, a252
    v_mfma_f32_16x16x32_bf16 v[136:139], a[12:15], a[36:39], v[136:139]
    ds_read_b64_tr_b16 a[68:69], v20 offset:16448
    v_lshlrev_b32 v244, 16, v255
    v_mfma_f32_16x16x32_bf16 v[140:143], a[12:15], a[40:43], v[140:143]
    v_and_b32 v245, 0xffff0000, v255
    v_mul_f32 v242, v238, v230
    v_mul_f32 v243, v239, v231
    v_mfma_f32_16x16x32_bf16 v[144:147], a[12:15], a[44:47], v[144:147]
    ds_read_b64_tr_b16 a[70:71], v20 offset:18240
    v_fmac_f32 v242, v232, v228
    v_mfma_f32_16x16x32_bf16 v[148:151], a[12:15], a[48:51], v[148:151]
    ds_read_b64_tr_b16 a[72:73], v20 offset:24576
    v_fmac_f32 v243, v233, v229
    v_mfma_f32_16x16x32_bf16 v[152:155], a[12:15], a[52:55], v[152:155]
    v_fmac_f32 v242, v234, v226
    v_fmac_f32 v243, v235, v227
    v_mfma_f32_16x16x32_bf16 v[156:159], a[12:15], a[56:59], v[156:159]
    ds_read_b64_tr_b16 a[74:75], v20 offset:26368
    v_fmac_f32 v242, v236, v224
    v_mfma_f32_16x16x32_bf16 v[160:163], a[16:19], a[28:31], v[160:163]
    v_fmac_f32 v243, v237, v225
    v_mul_f32 v242, v242, v244
    v_mul_f32 v243, v243, v245
    v_mfma_f32_16x16x32_bf16 v[164:167], a[16:19], a[32:35], v[164:167]
    ds_read_b64_tr_b16 a[76:77], v20 offset:24608
    v_cvt_pk_bf16_f32 v246, v242, v240
    v_mfma_f32_16x16x32_bf16 v[168:171], a[16:19], a[36:39], v[168:171]
    v_cvt_pk_bf16_f32 v250, v243, v241
    buffer_store_dwordx4 v[246:249], v28, s[64:67], 0 offen sc1
    v_mfma_f32_16x16x32_bf16 v[172:175], a[16:19], a[40:43], v[172:175]
    ds_read_b64_tr_b16 a[78:79], v20 offset:26400
    v_add_u32 v28, 4096, v28
    v_mfma_f32_16x16x32_bf16 v[176:179], a[16:19], a[44:47], v[176:179]
    ds_read_b64_tr_b16 a[80:81], v20 offset:24640
    buffer_store_dwordx4 v[250:253], v28, s[64:67], 0 offen sc1
    v_add_u32 v28, 4096, v28
    v_mfma_f32_16x16x32_bf16 v[180:183], a[16:19], a[48:51], v[180:183]
    v_accvgpr_read_b32 v254, a212
    v_lshlrev_b32 v224, 16, v254
    v_mfma_f32_16x16x32_bf16 v[184:187], a[16:19], a[52:55], v[184:187]
    ds_read_b64_tr_b16 a[82:83], v20 offset:26432
    v_and_b32 v226, 0xffff0000, v254
    v_mfma_f32_16x16x32_bf16 v[188:191], a[16:19], a[56:59], v[188:191]
    v_accvgpr_read_b32 v255, a213
    v_lshlrev_b32 v228, 16, v255
    v_mfma_f32_16x16x32_bf16 v[192:195], a[20:23], a[28:31], v[192:195]
    ds_read_b64_tr_b16 a[84:85], v21 offset:16384
    v_and_b32 v230, 0xffff0000, v255
    v_accvgpr_read_b32 v254, a214
    v_mfma_f32_16x16x32_bf16 v[196:199], a[20:23], a[32:35], v[196:199]
    v_lshlrev_b32 v225, 16, v254
    v_and_b32 v227, 0xffff0000, v254
    v_mfma_f32_16x16x32_bf16 v[200:203], a[20:23], a[36:39], v[200:203]
    ds_read_b64_tr_b16 a[86:87], v21 offset:18176
    v_accvgpr_read_b32 v255, a215
    v_mfma_f32_16x16x32_bf16 v[204:207], a[20:23], a[40:43], v[204:207]
    v_lshlrev_b32 v229, 16, v255
    v_and_b32 v231, 0xffff0000, v255
    v_mfma_f32_16x16x32_bf16 v[208:211], a[20:23], a[44:47], v[208:211]
    v_accvgpr_read_b32 v254, a217
    v_lshlrev_b32 v232, 16, v254
    v_mfma_f32_16x16x32_bf16 v[212:215], a[20:23], a[48:51], v[212:215]
    v_and_b32 v233, 0xffff0000, v254
    v_accvgpr_read_b32 v255, a219
    v_lshlrev_b32 v234, 16, v255
    v_mfma_f32_16x16x32_bf16 v[216:219], a[20:23], a[52:55], v[216:219]
    v_and_b32 v235, 0xffff0000, v255
    v_accvgpr_read_b32 v254, a221
    v_mfma_f32_16x16x32_bf16 v[220:223], a[20:23], a[56:59], v[220:223]
    v_lshlrev_b32 v236, 16, v254
    v_and_b32 v237, 0xffff0000, v254
    v_mfma_f32_16x16x32_bf16 a[128:131], a[24:27], a[28:31], a[128:131]
    v_accvgpr_read_b32 v254, a223
    v_lshlrev_b32 v238, 16, v254
    v_mfma_f32_16x16x32_bf16 a[132:135], a[24:27], a[32:35], a[132:135]
    v_and_b32 v239, 0xffff0000, v254
    v_accvgpr_read_b32 v255, a239
    v_lshlrev_b32 v244, 16, v255
    v_mfma_f32_16x16x32_bf16 a[136:139], a[24:27], a[36:39], a[136:139]
    v_and_b32 v245, 0xffff0000, v255
    v_mul_f32 v240, v232, v230
    v_mfma_f32_16x16x32_bf16 a[140:143], a[24:27], a[40:43], a[140:143]
    v_mul_f32 v241, v233, v231
    v_fmac_f32 v240, v234, v228
    v_mfma_f32_16x16x32_bf16 a[144:147], a[24:27], a[44:47], a[144:147]
    v_fmac_f32 v241, v235, v229
    v_fmac_f32 v240, v236, v226
    v_mfma_f32_16x16x32_bf16 a[148:151], a[24:27], a[48:51], a[148:151]
    v_fmac_f32 v241, v237, v227
    v_fmac_f32 v240, v238, v224
    v_fmac_f32 v241, v239, v225
    s_waitcnt vmcnt(9)
    v_mfma_f32_16x16x32_bf16 a[152:155], a[24:27], a[52:55], a[152:155]
    v_mul_f32 v240, v240, v244
    v_mul_f32 v241, v241, v245
    v_mfma_f32_16x16x32_bf16 a[156:159], a[24:27], a[56:59], a[156:159]
    v_accvgpr_read_b32 v254, a225
    v_lshlrev_b32 v232, 16, v254
    s_waitcnt lgkmcnt(0)
    s_barrier
    v_mfma_f32_16x16x32_bf16 v[32:35], a[60:63], a[88:91], v[32:35]
    s_add_u32 s60, s60, 32768
    s_cmp_eq_u32 s60, 98304
    s_cselect_b32 s60, 0, s60
    v_mfma_f32_16x16x32_bf16 v[36:39], a[60:63], a[92:95], v[36:39]
    v_add_u32 v22, s60, v24
    v_add_u32 v23, s60, v25
    v_mfma_f32_16x16x32_bf16 v[40:43], a[60:63], a[96:99], v[40:43]
    ds_read_b128 a[28:31], v22 offset:0
    v_and_b32 v233, 0xffff0000, v254
    v_mfma_f32_16x16x32_bf16 v[44:47], a[60:63], a[100:103], v[44:47]
    ds_read_b128 a[32:35], v22 offset:2048
    v_accvgpr_read_b32 v255, a241
    v_mfma_f32_16x16x32_bf16 v[48:51], a[60:63], a[104:107], v[48:51]
    v_lshlrev_b32 v244, 16, v255
    v_and_b32 v245, 0xffff0000, v255
    v_mfma_f32_16x16x32_bf16 v[52:55], a[60:63], a[108:111], v[52:55]
    s_mov_b32 m0, s40
    s_nop 0
    buffer_load_dwordx4 v4, s[32:35], s36 offen lds
    v_mul_f32 v242, v234, v230
    v_mfma_f32_16x16x32_bf16 v[56:59], a[60:63], a[112:115], v[56:59]
    ds_read_b128 a[36:39], v22 offset:4096
    v_mul_f32 v243, v235, v231
    v_mfma_f32_16x16x32_bf16 v[60:63], a[60:63], a[116:119], v[60:63]
    ds_read_b128 a[40:43], v22 offset:6144
    v_fmac_f32 v242, v236, v228
    v_mfma_f32_16x16x32_bf16 v[64:67], a[64:67], a[88:91], v[64:67]
    buffer_load_dwordx4 v5, s[32:35], s36 offen offset:1024 lds
    v_fmac_f32 v243, v237, v229
    v_mfma_f32_16x16x32_bf16 v[68:71], a[64:67], a[92:95], v[68:71]
    v_fmac_f32 v242, v238, v226
    v_fmac_f32 v243, v239, v227
    v_mfma_f32_16x16x32_bf16 v[72:75], a[64:67], a[96:99], v[72:75]
    ds_read_b128 a[44:47], v22 offset:8192
    v_fmac_f32 v242, v232, v224
    v_mfma_f32_16x16x32_bf16 v[76:79], a[64:67], a[100:103], v[76:79]
    ds_read_b128 a[48:51], v22 offset:10240
    v_fmac_f32 v243, v233, v225
    v_mfma_f32_16x16x32_bf16 v[80:83], a[64:67], a[104:107], v[80:83]
    buffer_load_dwordx4 v6, s[32:35], s36 offen offset:2048 lds
    v_mul_f32 v242, v242, v244
    v_mfma_f32_16x16x32_bf16 v[84:87], a[64:67], a[108:111], v[84:87]
    ds_read_b128 a[52:55], v22 offset:12288
    v_mul_f32 v243, v243, v245
    v_mfma_f32_16x16x32_bf16 v[88:91], a[64:67], a[112:115], v[88:91]
    v_cvt_pk_bf16_f32 v249, v242, v240
    v_cvt_pk_bf16_f32 v253, v243, v241
    v_mfma_f32_16x16x32_bf16 v[92:95], a[64:67], a[116:119], v[92:95]
    ds_read_b128 a[56:59], v22 offset:14336
    v_accvgpr_read_b32 v254, a227
    v_mfma_f32_16x16x32_bf16 v[96:99], a[68:71], a[88:91], v[96:99]
    buffer_load_dwordx4 v7, s[32:35], s36 offen offset:3072 lds
    v_lshlrev_b32 v234, 16, v254
    v_and_b32 v235, 0xffff0000, v254
    v_mfma_f32_16x16x32_bf16 v[100:103], a[68:71], a[92:95], v[100:103]
    ds_read_b64_tr_b16 a[0:1], v20 offset:32768
    v_accvgpr_read_b32 v255, a243
    v_mfma_f32_16x16x32_bf16 v[104:107], a[68:71], a[96:99], v[104:107]
    ds_read_b64_tr_b16 a[2:3], v20 offset:34560
    v_lshlrev_b32 v244, 16, v255
    v_mfma_f32_16x16x32_bf16 v[108:111], a[68:71], a[100:103], v[108:111]
    v_and_b32 v245, 0xffff0000, v255
    v_mul_f32 v240, v236, v230
    v_mfma_f32_16x16x32_bf16 v[112:115], a[68:71], a[104:107], v[112:115]
    s_add_u32 m0, s40, 4096
    s_add_u32 s40, s40, 32768
    buffer_load_dwordx4 v8, s[32:35], s36 offen lds
    v_mfma_f32_16x16x32_bf16 v[116:119], a[68:71], a[108:111], v[116:119]
    ds_read_b64_tr_b16 a[4:5], v20 offset:32800
    v_mul_f32 v241, v237, v231
    v_mfma_f32_16x16x32_bf16 v[120:123], a[68:71], a[112:115], v[120:123]
    ds_read_b64_tr_b16 a[6:7], v20 offset:34592
    v_fmac_f32 v240, v238, v228
    v_mfma_f32_16x16x32_bf16 v[124:127], a[68:71], a[116:119], v[124:127]
    s_cmp_eq_u32 s40, s42
    s_cselect_b32 s40, s41, s40
    buffer_load_dwordx4 v9, s[32:35], s36 offen offset:1024 lds
    v_mfma_f32_16x16x32_bf16 v[128:131], a[72:75], a[88:91], v[128:131]
    v_fmac_f32 v241, v239, v229
    v_fmac_f32 v240, v232, v226
    v_mfma_f32_16x16x32_bf16 v[132:135], a[72:75], a[92:95], v[132:135]
    ds_read_b64_tr_b16 a[8:9], v20 offset:32832
    v_fmac_f32 v241, v233, v227
    v_mfma_f32_16x16x32_bf16 v[136:139], a[72:75], a[96:99], v[136:139]
    ds_read_b64_tr_b16 a[10:11], v20 offset:34624
    v_fmac_f32 v240, v234, v224
    v_mfma_f32_16x16x32_bf16 v[140:143], a[72:75], a[100:103], v[140:143]
    buffer_load_dwordx4 v10, s[32:35], s36 offen offset:2048 lds
    v_fmac_f32 v241, v235, v225
    v_mfma_f32_16x16x32_bf16 v[144:147], a[72:75], a[104:107], v[144:147]
    ds_read_b64_tr_b16 a[12:13], v20 offset:40960
    v_mul_f32 v240, v240, v244
    v_mul_f32 v241, v241, v245
    v_mfma_f32_16x16x32_bf16 v[148:151], a[72:75], a[108:111], v[148:151]
    v_accvgpr_read_b32 v254, a229
    v_lshlrev_b32 v236, 16, v254
    v_mfma_f32_16x16x32_bf16 v[152:155], a[72:75], a[112:115], v[152:155]
    ds_read_b64_tr_b16 a[14:15], v20 offset:42752
    v_and_b32 v237, 0xffff0000, v254
    v_mfma_f32_16x16x32_bf16 v[156:159], a[72:75], a[116:119], v[156:159]
    buffer_load_dwordx4 v11, s[32:35], s36 offen offset:3072 lds
    s_add_u32 s36, s36, s37
    s_cmp_eq_u32 s36, s39
    s_cselect_b32 s36, s38, s36
    v_mfma_f32_16x16x32_bf16 v[160:163], a[76:79], a[88:91], v[160:163]
    ds_read_b64_tr_b16 a[16:17], v20 offset:40992
    v_accvgpr_read_b32 v255, a245
    v_mfma_f32_16x16x32_bf16 v[164:167], a[76:79], a[92:95], v[164:167]
    ds_read_b64_tr_b16 a[18:19], v20 offset:42784
    v_lshlrev_b32 v244, 16, v255
    v_mfma_f32_16x16x32_bf16 v[168:171], a[76:79], a[96:99], v[168:171]
    v_and_b32 v245, 0xffff0000, v255
    v_mul_f32 v242, v238, v230
    v_mfma_f32_16x16x32_bf16 v[172:175], a[76:79], a[100:103], v[172:175]
    s_mov_b32 m0, s52
    s_nop 0
    buffer_load_dwordx4 v12, s[44:47], s48 offen lds
    v_mfma_f32_16x16x32_bf16 v[176:179], a[76:79], a[104:107], v[176:179]
    ds_read_b64_tr_b16 a[20:21], v20 offset:41024
    v_mul_f32 v243, v239, v231
    v_mfma_f32_16x16x32_bf16 v[180:183], a[76:79], a[108:111], v[180:183]
    ds_read_b64_tr_b16 a[22:23], v20 offset:42816
    v_fmac_f32 v242, v232, v228
    v_mfma_f32_16x16x32_bf16 v[184:187], a[76:79], a[112:115], v[184:187]
    buffer_load_dwordx4 v13, s[44:47], s48 offen offset:1024 lds
    v_fmac_f32 v243, v233, v229
    v_mfma_f32_16x16x32_bf16 v[188:191], a[76:79], a[116:119], v[188:191]
    v_fmac_f32 v242, v234, v226
    v_fmac_f32 v243, v235, v227
    v_fmac_f32 v242, v236, v224
    v_mfma_f32_16x16x32_bf16 v[192:195], a[80:83], a[88:91], v[192:195]
    ds_read_b64_tr_b16 a[24:25], v21 offset:32768
    v_fmac_f32 v243, v237, v225
    v_mfma_f32_16x16x32_bf16 v[196:199], a[80:83], a[92:95], v[196:199]
    ds_read_b64_tr_b16 a[26:27], v21 offset:34560
    v_mul_f32 v242, v242, v244
    v_mfma_f32_16x16x32_bf16 v[200:203], a[80:83], a[96:99], v[200:203]
    buffer_load_dwordx4 v14, s[44:47], s48 offen offset:2048 lds
    v_mul_f32 v243, v243, v245
    v_mfma_f32_16x16x32_bf16 v[204:207], a[80:83], a[100:103], v[204:207]
    v_cvt_pk_bf16_f32 v248, v242, v240
    v_cvt_pk_bf16_f32 v252, v243, v241
    v_mfma_f32_16x16x32_bf16 v[208:211], a[80:83], a[104:107], v[208:211]
    v_accvgpr_read_b32 v254, a231
    v_lshlrev_b32 v238, 16, v254
    v_mfma_f32_16x16x32_bf16 v[212:215], a[80:83], a[108:111], v[212:215]
    v_and_b32 v239, 0xffff0000, v254
    v_accvgpr_read_b32 v255, a247
    v_mfma_f32_16x16x32_bf16 v[216:219], a[80:83], a[112:115], v[216:219]
    v_lshlrev_b32 v244, 16, v255
    v_and_b32 v245, 0xffff0000, v255
    v_mfma_f32_16x16x32_bf16 v[220:223], a[80:83], a[116:119], v[220:223]
    v_mul_f32 v240, v232, v230
    v_mul_f32 v241, v233, v231
    v_mfma_f32_16x16x32_bf16 a[128:131], a[84:87], a[88:91], a[128:131]
    v_fmac_f32 v240, v234, v228
    v_fmac_f32 v241, v235, v229
    v_mfma_f32_16x16x32_bf16 a[132:135], a[84:87], a[92:95], a[132:135]
    v_fmac_f32 v240, v236, v226
    v_fmac_f32 v241, v237, v227
    v_mfma_f32_16x16x32_bf16 a[136:139], a[84:87], a[96:99], a[136:139]
    v_fmac_f32 v240, v238, v224
    v_fmac_f32 v241, v239, v225
    v_mul_f32 v240, v240, v244
    v_mfma_f32_16x16x32_bf16 a[140:143], a[84:87], a[100:103], a[140:143]
    v_mul_f32 v241, v241, v245
    v_accvgpr_read_b32 v254, a233
    v_mfma_f32_16x16x32_bf16 a[144:147], a[84:87], a[104:107], a[144:147]
    v_lshlrev_b32 v232, 16, v254
    v_and_b32 v233, 0xffff0000, v254
    v_mfma_f32_16x16x32_bf16 a[148:151], a[84:87], a[108:111], a[148:151]
    v_accvgpr_read_b32 v255, a249
    v_lshlrev_b32 v244, 16, v255
    s_waitcnt vmcnt(12)
    v_mfma_f32_16x16x32_bf16 a[152:155], a[84:87], a[112:115], a[152:155]
    v_and_b32 v245, 0xffff0000, v255
    v_mul_f32 v242, v234, v230
    v_mfma_f32_16x16x32_bf16 a[156:159], a[84:87], a[116:119], a[156:159]
    v_mul_f32 v243, v235, v231
    v_fmac_f32 v242, v236, v228
    s_waitcnt lgkmcnt(0)
    s_barrier
    v_mfma_f32_16x16x32_bf16 v[32:35], a[0:3], a[28:31], v[32:35]
    ds_read_b128 a[88:91], v23 offset:0
    v_fmac_f32 v243, v237, v229
    v_mfma_f32_16x16x32_bf16 v[36:39], a[0:3], a[32:35], v[36:39]
    ds_read_b128 a[92:95], v23 offset:2048
    v_fmac_f32 v242, v238, v226
    v_mfma_f32_16x16x32_bf16 v[40:43], a[0:3], a[36:39], v[40:43]
    buffer_load_dwordx4 v15, s[44:47], s48 offen offset:3072 lds
    v_fmac_f32 v243, v239, v227
    v_mfma_f32_16x16x32_bf16 v[44:47], a[0:3], a[40:43], v[44:47]
    v_fmac_f32 v242, v232, v224
    v_fmac_f32 v243, v233, v225
    v_mfma_f32_16x16x32_bf16 v[48:51], a[0:3], a[44:47], v[48:51]
    ds_read_b128 a[96:99], v23 offset:4096
    v_mul_f32 v242, v242, v244
    v_mfma_f32_16x16x32_bf16 v[52:55], a[0:3], a[48:51], v[52:55]
    ds_read_b128 a[100:103], v23 offset:6144
    v_mfma_f32_16x16x32_bf16 v[56:59], a[0:3], a[52:55], v[56:59]
    s_add_u32 m0, s52, 4096
    s_add_u32 s52, s52, 32768
    buffer_load_dwordx4 v16, s[44:47], s48 offen lds
    v_mfma_f32_16x16x32_bf16 v[60:63], a[0:3], a[56:59], v[60:63]
    v_mul_f32 v243, v243, v245
    v_cvt_pk_bf16_f32 v247, v242, v240
    v_mfma_f32_16x16x32_bf16 v[64:67], a[4:7], a[28:31], v[64:67]
    ds_read_b128 a[104:107], v23 offset:8192
    v_cvt_pk_bf16_f32 v251, v243, v241
    v_mfma_f32_16x16x32_bf16 v[68:71], a[4:7], a[32:35], v[68:71]
    ds_read_b128 a[108:111], v23 offset:10240
    v_accvgpr_read_b32 v254, a235
    v_mfma_f32_16x16x32_bf16 v[72:75], a[4:7], a[36:39], v[72:75]
    v_lshlrev_b32 v234, 16, v254
    v_and_b32 v235, 0xffff0000, v254
    v_mfma_f32_16x16x32_bf16 v[76:79], a[4:7], a[40:43], v[76:79]
    s_cmp_eq_u32 s52, s54
    s_cselect_b32 s52, s53, s52
    buffer_load_dwordx4 v17, s[44:47], s48 offen offset:1024 lds
    v_mfma_f32_16x16x32_bf16 v[80:83], a[4:7], a[44:47], v[80:83]
    ds_read_b128 a[112:115], v23 offset:12288
    v_accvgpr_read_b32 v255, a251
    v_mfma_f32_16x16x32_bf16 v[84:87], a[4:7], a[48:51], v[84:87]
    ds_read_b128 a[116:119], v23 offset:14336
    v_lshlrev_b32 v244, 16, v255
    v_mfma_f32_16x16x32_bf16 v[88:91], a[4:7], a[52:55], v[88:91]
    v_and_b32 v245, 0xffff0000, v255
    v_mul_f32 v240, v236, v230
    v_mfma_f32_16x16x32_bf16 v[92:95], a[4:7], a[56:59], v[92:95]
    buffer_load_dwordx4 v18, s[44:47], s48 offen offset:2048 lds
    v_mul_f32 v241, v237, v231
    v_mfma_f32_16x16x32_bf16 v[96:99], a[8:11], a[28:31], v[96:99]
    ds_read_b64_tr_b16 a[60:61], v20 offset:49152
    v_mfma_f32_16x16x32_bf16 v[100:103], a[8:11], a[32:35], v[100:103]
    ds_read_b64_tr_b16 a[62:63], v20 offset:50944
    v_fmac_f32 v240, v238, v228
    v_mfma_f32_16x16x32_bf16 v[104:107], a[8:11], a[36:39], v[104:107]
    v_fmac_f32 v241, v239, v229
    v_fmac_f32 v240, v232, v226
    v_mfma_f32_16x16x32_bf16 v[108:111], a[8:11], a[40:43], v[108:111]
    buffer_load_dwordx4 v19, s[44:47], s48 offen offset:3072 lds
    s_add_u32 s48, s48, s49
    s_cmp_eq_u32 s48, s51
    s_cselect_b32 s48, s50, s48
    v_mfma_f32_16x16x32_bf16 v[112:115], a[8:11], a[44:47], v[112:115]
    ds_read_b64_tr_b16 a[64:65], v20 offset:49184
    v_fmac_f32 v241, v233, v227
    v_mfma_f32_16x16x32_bf16 v[116:119], a[8:11], a[48:51], v[116:119]
    v_fmac_f32 v240, v234, v224
    v_fmac_f32 v241, v235, v225
    v_mfma_f32_16x16x32_bf16 v[120:123], a[8:11], a[52:55], v[120:123]
    ds_read_b64_tr_b16 a[66:67], v20 offset:50976
    v_mul_f32 v240, v240, v244
    v_mfma_f32_16x16x32_bf16 v[124:127], a[8:11], a[56:59], v[124:127]
    s_mov_b32 m0, s40
    s_nop 0
    buffer_load_dwordx4 v4, s[32:35], s36 offen lds
    v_mfma_f32_16x16x32_bf16 v[128:131], a[12:15], a[28:31], v[128:131]
    ds_read_b64_tr_b16 a[68:69], v20 offset:49216
    v_mul_f32 v241, v241, v245
    v_mfma_f32_16x16x32_bf16 v[132:135], a[12:15], a[32:35], v[132:135]
    v_accvgpr_read_b32 v254, a237
    v_lshlrev_b32 v236, 16, v254
    v_mfma_f32_16x16x32_bf16 v[136:139], a[12:15], a[36:39], v[136:139]
    ds_read_b64_tr_b16 a[70:71], v20 offset:51008
    v_and_b32 v237, 0xffff0000, v254
    v_mfma_f32_16x16x32_bf16 v[140:143], a[12:15], a[40:43], v[140:143]
    buffer_load_dwordx4 v5, s[32:35], s36 offen offset:1024 lds
    v_accvgpr_read_b32 v255, a253
    v_mfma_f32_16x16x32_bf16 v[144:147], a[12:15], a[44:47], v[144:147]
    ds_read_b64_tr_b16 a[72:73], v20 offset:57344
    v_mfma_f32_16x16x32_bf16 v[148:151], a[12:15], a[48:51], v[148:151]
    v_lshlrev_b32 v244, 16, v255
    v_and_b32 v245, 0xffff0000, v255
    v_mfma_f32_16x16x32_bf16 v[152:155], a[12:15], a[52:55], v[152:155]
    ds_read_b64_tr_b16 a[74:75], v20 offset:59136
    v_mul_f32 v242, v238, v230
    v_mfma_f32_16x16x32_bf16 v[156:159], a[12:15], a[56:59], v[156:159]
    buffer_load_dwordx4 v6, s[32:35], s36 offen offset:2048 lds
    v_mul_f32 v243, v239, v231
    v_mfma_f32_16x16x32_bf16 v[160:163], a[16:19], a[28:31], v[160:163]
    v_fmac_f32 v242, v232, v228
    v_fmac_f32 v243, v233, v229
    v_mfma_f32_16x16x32_bf16 v[164:167], a[16:19], a[32:35], v[164:167]
    ds_read_b64_tr_b16 a[76:77], v20 offset:57376
    v_fmac_f32 v242, v234, v226
    v_mfma_f32_16x16x32_bf16 v[168:171], a[16:19], a[36:39], v[168:171]
    ds_read_b64_tr_b16 a[78:79], v20 offset:59168
    v_fmac_f32 v243, v235, v227
    v_mfma_f32_16x16x32_bf16 v[172:175], a[16:19], a[40:43], v[172:175]
    buffer_load_dwordx4 v7, s[32:35], s36 offen offset:3072 lds
    v_fmac_f32 v242, v236, v224
    v_mfma_f32_16x16x32_bf16 v[176:179], a[16:19], a[44:47], v[176:179]
    v_fmac_f32 v243, v237, v225
    v_mul_f32 v242, v242, v244
    v_mfma_f32_16x16x32_bf16 v[180:183], a[16:19], a[48:51], v[180:183]
    ds_read_b64_tr_b16 a[80:81], v20 offset:57408
    v_mfma_f32_16x16x32_bf16 v[184:187], a[16:19], a[52:55], v[184:187]
    ds_read_b64_tr_b16 a[82:83], v20 offset:59200
    v_mul_f32 v243, v243, v245
    v_mfma_f32_16x16x32_bf16 v[188:191], a[16:19], a[56:59], v[188:191]
    s_add_u32 m0, s40, 4096
    s_add_u32 s40, s40, 32768
    buffer_load_dwordx4 v8, s[32:35], s36 offen lds
    v_mfma_f32_16x16x32_bf16 v[192:195], a[20:23], a[28:31], v[192:195]
    v_cvt_pk_bf16_f32 v246, v242, v240
    v_cvt_pk_bf16_f32 v250, v243, v241
    v_mfma_f32_16x16x32_bf16 v[196:199], a[20:23], a[32:35], v[196:199]
    ds_read_b64_tr_b16 a[84:85], v21 offset:49152
    buffer_store_dwordx4 v[246:249], v28, s[64:67], 0 offen sc1
    v_mfma_f32_16x16x32_bf16 v[200:203], a[20:23], a[36:39], v[200:203]
    ds_read_b64_tr_b16 a[86:87], v21 offset:50944
    v_add_u32 v28, 4096, v28
    v_mfma_f32_16x16x32_bf16 v[204:207], a[20:23], a[40:43], v[204:207]
    buffer_store_dwordx4 v[250:253], v28, s[64:67], 0 offen sc1
    v_add_u32 v28, 4096, v28
    v_mfma_f32_16x16x32_bf16 v[208:211], a[20:23], a[44:47], v[208:211]
    v_mfma_f32_16x16x32_bf16 v[212:215], a[20:23], a[48:51], v[212:215]
    s_and_b32 s3, s2, 15
    s_lshl_b32 s3, s3, 7
    s_lshr_b32 s81, s2, 4
    v_mfma_f32_16x16x32_bf16 v[216:219], a[20:23], a[52:55], v[216:219]
    v_mfma_f32_16x16x32_bf16 v[220:223], a[20:23], a[56:59], v[220:223]
    s_lshl_b32 s81, s81, 2
    s_add_u32 s3, s3, s81
    s_add_u32 s3, s3, 5120
    v_mfma_f32_16x16x32_bf16 a[128:131], a[24:27], a[28:31], a[128:131]
    s_lshl_b32 s81, s24, 20
    s_add_u32 s3, s3, s81
    v_writelane_b32 v3, s3, 0
    v_mfma_f32_16x16x32_bf16 a[132:135], a[24:27], a[32:35], a[132:135]
    v_writelane_b32 v3, s3, 1
    v_mfma_f32_16x16x32_bf16 a[136:139], a[24:27], a[36:39], a[136:139]
    s_lshl_b32 s3, s25, 7
    v_lshlrev_b32 v28, 2, v1
    v_and_b32 v254, 28, v28
    v_mfma_f32_16x16x32_bf16 a[140:143], a[24:27], a[40:43], a[140:143]
    v_mfma_f32_16x16x32_bf16 a[144:147], a[24:27], a[44:47], a[144:147]
    v_add_u32 v28, s3, v28
    s_lshl_b32 s3, s26, 7
    s_add_u32 s3, s3, 1024
    v_mfma_f32_16x16x32_bf16 a[148:151], a[24:27], a[48:51], a[148:151]
    s_waitcnt vmcnt(13)
    v_mfma_f32_16x16x32_bf16 a[152:155], a[24:27], a[52:55], a[152:155]
    v_cmp_lt_u32 vcc, 31, v1
    v_add_u32 v254, s3, v254
    s_lshl_b32 s3, s24, 20
    v_mfma_f32_16x16x32_bf16 a[156:159], a[24:27], a[56:59], a[156:159]
    v_cndmask_b32 v28, v28, v254, vcc
    v_add_u32 v28, s3, v28
    buffer_load_dword v254, v28, s[68:71], 0 offen sc1
    s_waitcnt lgkmcnt(0)
    s_barrier
    v_mfma_f32_16x16x32_bf16 v[32:35], a[60:63], a[88:91], v[32:35]
    s_add_u32 s60, s60, 32768
    s_cmp_eq_u32 s60, 98304
    s_cselect_b32 s60, 0, s60
    v_mfma_f32_16x16x32_bf16 v[36:39], a[60:63], a[92:95], v[36:39]
    v_add_u32 v22, s60, v24
    v_add_u32 v23, s60, v25
    v_mfma_f32_16x16x32_bf16 v[40:43], a[60:63], a[96:99], v[40:43]
    ds_read_b128 a[28:31], v22 offset:0
    v_mfma_f32_16x16x32_bf16 v[44:47], a[60:63], a[100:103], v[44:47]
    ds_read_b128 a[32:35], v22 offset:2048
    v_mfma_f32_16x16x32_bf16 v[48:51], a[60:63], a[104:107], v[48:51]
    v_mfma_f32_16x16x32_bf16 v[52:55], a[60:63], a[108:111], v[52:55]
    s_cmp_eq_u32 s40, s42
    s_cselect_b32 s40, s41, s40
    buffer_load_dwordx4 v9, s[32:35], s36 offen offset:1024 lds
    v_mfma_f32_16x16x32_bf16 v[56:59], a[60:63], a[112:115], v[56:59]
    ds_read_b128 a[36:39], v22 offset:4096
    v_mfma_f32_16x16x32_bf16 v[60:63], a[60:63], a[116:119], v[60:63]
    ds_read_b128 a[40:43], v22 offset:6144
    v_mfma_f32_16x16x32_bf16 v[64:67], a[64:67], a[88:91], v[64:67]
    buffer_load_dwordx4 v10, s[32:35], s36 offen offset:2048 lds
    v_mfma_f32_16x16x32_bf16 v[68:71], a[64:67], a[92:95], v[68:71]
    v_mfma_f32_16x16x32_bf16 v[72:75], a[64:67], a[96:99], v[72:75]
    ds_read_b128 a[44:47], v22 offset:8192
    v_mfma_f32_16x16x32_bf16 v[76:79], a[64:67], a[100:103], v[76:79]
    ds_read_b128 a[48:51], v22 offset:10240
    v_mfma_f32_16x16x32_bf16 v[80:83], a[64:67], a[104:107], v[80:83]
    buffer_load_dwordx4 v11, s[32:35], s36 offen offset:3072 lds
    s_add_u32 s36, s36, s37
    s_cmp_eq_u32 s36, s39
    s_cselect_b32 s36, s38, s36
    v_mfma_f32_16x16x32_bf16 v[84:87], a[64:67], a[108:111], v[84:87]
    ds_read_b128 a[52:55], v22 offset:12288
    v_mfma_f32_16x16x32_bf16 v[88:91], a[64:67], a[112:115], v[88:91]
    v_mfma_f32_16x16x32_bf16 v[92:95], a[64:67], a[116:119], v[92:95]
    ds_read_b128 a[56:59], v22 offset:14336
    v_mfma_f32_16x16x32_bf16 v[96:99], a[68:71], a[88:91], v[96:99]
    s_cmp_eq_u32 s29, 0
    s_cselect_b32 s46, 0, s46
    s_mov_b32 m0, s52
    s_nop 0
    buffer_load_dwordx4 v12, s[44:47], s48 offen lds
    v_mfma_f32_16x16x32_bf16 v[100:103], a[68:71], a[92:95], v[100:103]
    ds_read_b64_tr_b16 a[0:1], v20 offset:0
    v_mfma_f32_16x16x32_bf16 v[104:107], a[68:71], a[96:99], v[104:107]
    ds_read_b64_tr_b16 a[2:3], v20 offset:1792
    v_mfma_f32_16x16x32_bf16 v[108:111], a[68:71], a[100:103], v[108:111]
    v_mfma_f32_16x16x32_bf16 v[112:115], a[68:71], a[104:107], v[112:115]
    buffer_load_dwordx4 v13, s[44:47], s48 offen offset:1024 lds
    v_mfma_f32_16x16x32_bf16 v[116:119], a[68:71], a[108:111], v[116:119]
    ds_read_b64_tr_b16 a[4:5], v20 offset:32
    v_mfma_f32_16x16x32_bf16 v[120:123], a[68:71], a[112:115], v[120:123]
    ds_read_b64_tr_b16 a[6:7], v20 offset:1824
    v_mfma_f32_16x16x32_bf16 v[124:127], a[68:71], a[116:119], v[124:127]
    buffer_load_dwordx4 v14, s[44:47], s48 offen offset:2048 lds
    v_mfma_f32_16x16x32_bf16 v[128:131], a[72:75], a[88:91], v[128:131]
    v_mfma_f32_16x16x32_bf16 v[132:135], a[72:75], a[92:95], v[132:135]
    ds_read_b64_tr_b16 a[8:9], v20 offset:64
    v_mfma_f32_16x16x32_bf16 v[136:139], a[72:75], a[96:99], v[136:139]
    ds_read_b64_tr_b16 a[10:11], v20 offset:1856
    v_mfma_f32_16x16x32_bf16 v[140:143], a[72:75], a[100:103], v[140:143]
    buffer_load_dwordx4 v15, s[44:47], s48 offen offset:3072 lds
    v_mfma_f32_16x16x32_bf16 v[144:147], a[72:75], a[104:107], v[144:147]
    ds_read_b64_tr_b16 a[12:13], v20 offset:8192
    v_mfma_f32_16x16x32_bf16 v[148:151], a[72:75], a[108:111], v[148:151]
    v_mfma_f32_16x16x32_bf16 v[152:155], a[72:75], a[112:115], v[152:155]
    ds_read_b64_tr_b16 a[14:15], v20 offset:9984
    v_mfma_f32_16x16x32_bf16 v[156:159], a[72:75], a[116:119], v[156:159]
    s_add_u32 m0, s52, 4096
    s_add_u32 s52, s52, 32768
    buffer_load_dwordx4 v16, s[44:47], s48 offen lds
    v_mfma_f32_16x16x32_bf16 v[160:163], a[76:79], a[88:91], v[160:163]
    ds_read_b64_tr_b16 a[16:17], v20 offset:8224
    v_mfma_f32_16x16x32_bf16 v[164:167], a[76:79], a[92:95], v[164:167]
    ds_read_b64_tr_b16 a[18:19], v20 offset:10016
    v_mfma_f32_16x16x32_bf16 v[168:171], a[76:79], a[96:99], v[168:171]
    v_mfma_f32_16x16x32_bf16 v[172:175], a[76:79], a[100:103], v[172:175]
    s_cmp_eq_u32 s52, s54
    s_cselect_b32 s52, s53, s52
    buffer_load_dwordx4 v17, s[44:47], s48 offen offset:1024 lds
    v_mfma_f32_16x16x32_bf16 v[176:179], a[76:79], a[104:107], v[176:179]
    ds_read_b64_tr_b16 a[20:21], v20 offset:8256
    v_mfma_f32_16x16x32_bf16 v[180:183], a[76:79], a[108:111], v[180:183]
    ds_read_b64_tr_b16 a[22:23], v20 offset:10048
    v_mfma_f32_16x16x32_bf16 v[184:187], a[76:79], a[112:115], v[184:187]
    buffer_load_dwordx4 v18, s[44:47], s48 offen offset:2048 lds
    v_mfma_f32_16x16x32_bf16 v[188:191], a[76:79], a[116:119], v[188:191]
    v_mfma_f32_16x16x32_bf16 v[192:195], a[80:83], a[88:91], v[192:195]
    ds_read_b64_tr_b16 a[24:25], v21 offset:0
    v_mfma_f32_16x16x32_bf16 v[196:199], a[80:83], a[92:95], v[196:199]
    ds_read_b64_tr_b16 a[26:27], v21 offset:1792
    v_mfma_f32_16x16x32_bf16 v[200:203], a[80:83], a[96:99], v[200:203]
    buffer_load_dwordx4 v19, s[44:47], s48 offen offset:3072 lds
    s_add_u32 s48, s48, s49
    s_cmp_eq_u32 s48, s51
    s_cselect_b32 s48, s50, s48
    v_mfma_f32_16x16x32_bf16 v[204:207], a[80:83], a[100:103], v[204:207]
    v_mfma_f32_16x16x32_bf16 v[208:211], a[80:83], a[104:107], v[208:211]
    v_mfma_f32_16x16x32_bf16 v[212:215], a[80:83], a[108:111], v[212:215]
    v_mfma_f32_16x16x32_bf16 v[216:219], a[80:83], a[112:115], v[216:219]
    v_mfma_f32_16x16x32_bf16 v[220:223], a[80:83], a[116:119], v[220:223]
    v_mfma_f32_16x16x32_bf16 a[128:131], a[84:87], a[88:91], a[128:131]
    v_mfma_f32_16x16x32_bf16 a[132:135], a[84:87], a[92:95], a[132:135]
    v_mfma_f32_16x16x32_bf16 a[136:139], a[84:87], a[96:99], a[136:139]
    v_mfma_f32_16x16x32_bf16 a[140:143], a[84:87], a[100:103], a[140:143]
    v_mfma_f32_16x16x32_bf16 a[144:147], a[84:87], a[104:107], a[144:147]
    v_mfma_f32_16x16x32_bf16 a[148:151], a[84:87], a[108:111], a[148:151]
    s_waitcnt vmcnt(11)
    v_mfma_f32_16x16x32_bf16 a[152:155], a[84:87], a[112:115], a[152:155]
    v_mfma_f32_16x16x32_bf16 a[156:159], a[84:87], a[116:119], a[156:159]
    s_cmp_lg_u32 s24, 0
    s_cbranch_scc1 La_go
    s_mov_b32 s90, 0
La_chk:
    v_cmp_eq_u32 vcc, s63, v254
    s_nop 0
    s_cmp_eq_u64 vcc, -1
    s_cbranch_scc0 La_spin
La_go:
La_tail:
    s_load_dwordx2 s[12:13], s[0:1], 40
    s_waitcnt lgkmcnt(0)
    s_barrier
    v_mfma_f32_16x16x32_bf16 v[32:35], a[0:3], a[28:31], v[32:35]
    buffer_store_dword v29, v3, s[68:71], 0 offen sc1
    v_mfma_f32_16x16x32_bf16 v[36:39], a[0:3], a[32:35], v[36:39]
    s_mov_b32 s72, s20
    s_mov_b32 s73, s21
    s_mov_b32 s74, 4194304
    s_mov_b32 s75, 0x00020000
    v_lshlrev_b32 v9, 2, v1
    s_lshr_b32 s3, s2, 4
    s_lshl_b32 s3, s3, 7
    v_mfma_f32_16x16x32_bf16 v[40:43], a[0:3], a[36:39], v[40:43]
    v_mfma_f32_16x16x32_bf16 v[44:47], a[0:3], a[40:43], v[44:47]
    buffer_load_dword a254, v26, s[72:75], 0 offen
    s_add_u32 s3, s3, 5120
    v_and_b32 v30, 60, v9
    v_add_u32 v30, s3, v30
    v_mfma_f32_16x16x32_bf16 v[48:51], a[0:3], a[44:47], v[48:51]
    v_and_b32 v9, 15, v1
    v_lshrrev_b32 v10, 4, v1
    v_lshlrev_b32 v11, 4, v9
    v_mfma_f32_16x16x32_bf16 v[52:55], a[0:3], a[48:51], v[52:55]
    ds_read_b128 a[88:91], v23 offset:0
    v_lshlrev_b32 v12, 4, v1
    s_lshl_b32 s3, s25, 1
    s_add_u32 s3, s3, s30
    v_mfma_f32_16x16x32_bf16 v[56:59], a[0:3], a[52:55], v[56:59]
    v_mfma_f32_16x16x32_bf16 v[60:63], a[0:3], a[56:59], v[60:63]
    ds_read_b128 a[92:95], v23 offset:2048
    s_lshl_b32 s32, s3, 11
    s_mul_i32 s33, s24, 12928
    s_add_u32 s33, s33, 65536
    v_mfma_f32_16x16x32_bf16 v[64:67], a[4:7], a[28:31], v[64:67]
    ds_read_b128 a[96:99], v23 offset:4096
    s_lshl_b32 s34, s62, 1
    v_add_u32 v13, 1, v9
    v_and_b32 v4, 1, v13
    v_mfma_f32_16x16x32_bf16 v[68:71], a[4:7], a[32:35], v[68:71]
    v_mul_u32_u24 v4, 4160, v4
    v_lshrrev_b32 v13, 1, v13
    v_lshl_add_u32 v4, v13, 2, v4
    v_mfma_f32_16x16x32_bf16 v[72:75], a[4:7], a[36:39], v[72:75]
    ds_read_b128 a[100:103], v23 offset:6144
    v_mfma_f32_16x16x32_bf16 v[76:79], a[4:7], a[40:43], v[76:79]
    v_lshl_add_u32 v4, v10, 4, v4
    v_add_u32 v4, 4608, v4
    v_add_u32 v4, s33, v4
    v_mfma_f32_16x16x32_bf16 v[80:83], a[4:7], a[44:47], v[80:83]
    ds_read_b128 a[104:107], v23 offset:8192
    v_lshlrev_b32 v5, 1, v9
    v_sub_u32 v5, 30, v5
    v_add_u32 v5, v5, v10
    v_mfma_f32_16x16x32_bf16 v[84:87], a[4:7], a[48:51], v[84:87]
    v_lshlrev_b32 v5, 4, v5
    v_add_u32 v5, s33, v5
    v_lshlrev_b32 v6, 5, v9
    v_mfma_f32_16x16x32_bf16 v[88:91], a[4:7], a[52:55], v[88:91]
    ds_read_b128 a[108:111], v23 offset:10240
    v_mfma_f32_16x16x32_bf16 v[92:95], a[4:7], a[56:59], v[92:95]
    ds_read_b128 a[112:115], v23 offset:12288
    v_lshl_add_u32 v7, v10, 3, v6
    v_sub_u32 v7, 504, v7
    v_add_u32 v7, s33, v7
    v_mfma_f32_16x16x32_bf16 v[96:99], a[8:11], a[28:31], v[96:99]
    v_lshrrev_b32 v13, 5, v1
    v_lshl_add_u32 v6, v13, 4, v6
    v_and_b32 v13, 1, v10
    v_mfma_f32_16x16x32_bf16 v[100:103], a[8:11], a[32:35], v[100:103]
    ds_read_b128 a[116:119], v23 offset:14336
    v_mfma_f32_16x16x32_bf16 v[104:107], a[8:11], a[36:39], v[104:107]
    v_lshl_add_u32 v6, v13, 9, v6
    v_and_b32 v14, 31, v1
    v_lshlrev_b32 v14, 4, v14
    v_mfma_f32_16x16x32_bf16 v[108:111], a[8:11], a[40:43], v[108:111]
    ds_read_b64_tr_b16 a[60:61], v20 offset:16384
    v_add_u32 v14, s33, v14
    v_and_b32 v16, 1, v1
    v_bfe_u32 v13, v1, 2, 2
    v_mfma_f32_16x16x32_bf16 v[112:115], a[8:11], a[44:47], v[112:115]
    v_mul_u32_u24 v15, 4160, v16
    v_lshl_add_u32 v15, v13, 3, v15
    v_add_u32 v15, s33, v15
    v_mfma_f32_16x16x32_bf16 v[116:119], a[8:11], a[48:51], v[116:119]
    ds_read_b64_tr_b16 a[62:63], v20 offset:18176
    v_mfma_f32_16x16x32_bf16 v[120:123], a[8:11], a[52:55], v[120:123]
    ds_read_b64_tr_b16 a[64:65], v20 offset:16416
    v_lshlrev_b32 v16, 4, v16
    v_sub_u32 v16, 48, v16
    v_cmp_eq_u32 s[82:83], 3, v13
    v_mfma_f32_16x16x32_bf16 v[124:127], a[8:11], a[56:59], v[124:127]
    v_mov_b32 v224, 0
    v_mov_b32 v225, 0
    v_mov_b32 v226, 0
    v_mfma_f32_16x16x32_bf16 v[128:131], a[12:15], a[28:31], v[128:131]
    ds_read_b64_tr_b16 a[66:67], v20 offset:18208
    v_mfma_f32_16x16x32_bf16 v[132:135], a[12:15], a[32:35], v[132:135]
    v_mov_b32 v227, 0
    s_lshr_b32 s3, s62, 3
    s_and_b32 s35, s62, 7
    v_mfma_f32_16x16x32_bf16 v[136:139], a[12:15], a[36:39], v[136:139]
    ds_read_b64_tr_b16 a[68:69], v20 offset:16448
    s_lshl_b32 s42, s3, 16
    s_lshl_b32 s43, s35, 8
    s_add_u32 s42, s42, s43
    v_mfma_f32_16x16x32_bf16 v[140:143], a[12:15], a[40:43], v[140:143]
    s_lshl_b32 s43, s24, 13
    s_add_u32 s43, s43, 32768
    s_mul_i32 s40, s35, 224
    v_mfma_f32_16x16x32_bf16 v[144:147], a[12:15], a[44:47], v[144:147]
    ds_read_b64_tr_b16 a[70:71], v20 offset:18240
    v_mfma_f32_16x16x32_bf16 v[148:151], a[12:15], a[48:51], v[148:151]
    ds_read_b64_tr_b16 a[72:73], v20 offset:24576
    s_add_u32 s40, s40, s3
    s_lshl_b32 s40, s40, 12
    s_add_u32 s41, s40, 458752
    v_mfma_f32_16x16x32_bf16 v[152:155], a[12:15], a[52:55], v[152:155]
    v_lshlrev_b32 v17, 1, v10
    v_xor_b32 v17, v17, v9
    v_lshlrev_b32 v17, 4, v17
    v_mfma_f32_16x16x32_bf16 v[156:159], a[12:15], a[56:59], v[156:159]
    ds_read_b64_tr_b16 a[74:75], v20 offset:26368
    v_lshl_add_u32 v17, v10, 11, v17
    v_xor_b32 v19, 0x80, v17
    v_lshrrev_b32 v18, 2, v1
    v_mfma_f32_16x16x32_bf16 v[160:163], a[16:19], a[28:31], v[160:163]
    v_mfma_f32_16x16x32_bf16 v[164:167], a[16:19], a[32:35], v[164:167]
    ds_read_b64_tr_b16 a[76:77], v20 offset:24608
    v_and_b32 v13, 7, v18
    v_lshlrev_b32 v18, 8, v18
    v_lshl_add_u32 v18, v13, 5, v18
    v_mfma_f32_16x16x32_bf16 v[168:171], a[16:19], a[36:39], v[168:171]
    v_and_b32 v13, 3, v1
    v_lshl_add_u32 v18, v13, 3, v18
    v_add_u32 v31, s43, v18
    v_mfma_f32_16x16x32_bf16 v[172:175], a[16:19], a[40:43], v[172:175]
    ds_read_b64_tr_b16 a[78:79], v20 offset:26400
    v_mfma_f32_16x16x32_bf16 v[176:179], a[16:19], a[44:47], v[176:179]
    ds_read_b64_tr_b16 a[80:81], v20 offset:24640
    s_mov_b32 s36, s22
    s_mov_b32 s37, s23
    s_mov_b32 s38, 7340032
    s_mov_b32 s39, 0x00020000
    v_mfma_f32_16x16x32_bf16 v[180:183], a[16:19], a[48:51], v[180:183]
    s_add_u32 m0, s43, 0
    s_add_u32 s3, s42, 0
    buffer_load_dwordx4 v17, s[36:39], s3 offen lds
    v_mfma_f32_16x16x32_bf16 v[184:187], a[16:19], a[52:55], v[184:187]
    ds_read_b64_tr_b16 a[82:83], v20 offset:26432
    v_mfma_f32_16x16x32_bf16 v[188:191], a[16:19], a[56:59], v[188:191]
    s_add_u32 m0, s43, 1024
    s_add_u32 s3, s42, 8192
    buffer_load_dwordx4 v19, s[36:39], s3 offen lds
    v_mfma_f32_16x16x32_bf16 v[192:195], a[20:23], a[28:31], v[192:195]
    ds_read_b64_tr_b16 a[84:85], v21 offset:16384
    s_add_u32 m0, s43, 2048
    s_add_u32 s3, s42, 16384
    buffer_load_dwordx4 v17, s[36:39], s3 offen lds
    v_mfma_f32_16x16x32_bf16 v[196:199], a[20:23], a[32:35], v[196:199]
    s_add_u32 m0, s43, 3072
    s_add_u32 s3, s42, 24576
    buffer_load_dwordx4 v19, s[36:39], s3 offen lds
    v_mfma_f32_16x16x32_bf16 v[200:203], a[20:23], a[36:39], v[200:203]
    ds_read_b64_tr_b16 a[86:87], v21 offset:18176
    v_mfma_f32_16x16x32_bf16 v[204:207], a[20:23], a[40:43], v[204:207]
    s_add_u32 m0, s43, 4096
    s_add_u32 s3, s42, 32768
    buffer_load_dwordx4 v17, s[36:39], s3 offen lds
    v_mfma_f32_16x16x32_bf16 v[208:211], a[20:23], a[44:47], v[208:211]
    s_add_u32 m0, s43, 5120
    s_add_u32 s3, s42, 40960
    buffer_load_dwordx4 v19, s[36:39], s3 offen lds
    v_mfma_f32_16x16x32_bf16 v[212:215], a[20:23], a[48:51], v[212:215]
    s_add_u32 m0, s43, 6144
    s_add_u32 s3, s42, 49152
    buffer_load_dwordx4 v17, s[36:39], s3 offen lds
    v_mfma_f32_16x16x32_bf16 v[216:219], a[20:23], a[52:55], v[216:219]
    s_add_u32 m0, s43, 7168
    s_add_u32 s3, s42, 57344
    buffer_load_dwordx4 v19, s[36:39], s3 offen lds
    v_mfma_f32_16x16x32_bf16 v[220:223], a[20:23], a[56:59], v[220:223]
    v_mfma_f32_16x16x32_bf16 a[128:131], a[24:27], a[28:31], a[128:131]
    s_lshl_b32 s3, s26, 7
    s_lshl_b32 s81, s25, 2
    s_add_u32 s3, s3, s81
    s_add_u32 s3, s3, 1024
    buffer_load_dword v29, v224, s[68:71], s3 offen sc1
    v_mfma_f32_16x16x32_bf16 a[132:135], a[24:27], a[32:35], a[132:135]
    s_mov_b32 s44, s20
    s_mov_b32 s45, s21
    s_mov_b32 s46, 4194304
    s_mov_b32 s47, 0x00020000
    v_mfma_f32_16x16x32_bf16 a[136:139], a[24:27], a[36:39], a[136:139]
    v_mfma_f32_16x16x32_bf16 a[140:143], a[24:27], a[40:43], a[140:143]
    s_mov_b32 s48, s12
    s_mov_b32 s49, s13
    s_mov_b32 s50, 2048
    s_mov_b32 s51, 0x00020000
    buffer_load_dwordx2 v[228:229], v224, s[44:47], s80 offen
    buffer_load_ushort v230, v224, s[48:51], s34 offen
    v_mfma_f32_16x16x32_bf16 a[144:147], a[24:27], a[44:47], a[144:147]
    v_mfma_f32_16x16x32_bf16 a[148:151], a[24:27], a[48:51], a[148:151]
    s_waitcnt vmcnt(21)
    v_mfma_f32_16x16x32_bf16 a[152:155], a[24:27], a[52:55], a[152:155]
    v_mfma_f32_16x16x32_bf16 a[156:159], a[24:27], a[56:59], a[156:159]
    s_waitcnt lgkmcnt(0)
    s_barrier
    v_mfma_f32_16x16x32_bf16 v[32:35], a[60:63], a[88:91], v[32:35]
    s_add_u32 s60, s60, 32768
    s_cmp_eq_u32 s60, 98304
    s_cselect_b32 s60, 0, s60
    v_mfma_f32_16x16x32_bf16 v[36:39], a[60:63], a[92:95], v[36:39]
    v_add_u32 v22, s60, v24
    v_add_u32 v23, s60, v25
    s_add_u32 s92, s18, 12582912
    s_addc_u32 s93, s19, 0
    v_mfma_f32_16x16x32_bf16 v[40:43], a[60:63], a[96:99], v[40:43]
    ds_read_b128 a[28:31], v22 offset:0
    v_mfma_f32_16x16x32_bf16 v[44:47], a[60:63], a[100:103], v[44:47]
    ds_read_b128 a[32:35], v22 offset:2048
    s_mov_b32 s94, 14680064
    s_mov_b32 s95, 0x00020000
    v_mfma_f32_16x16x32_bf16 v[48:51], a[60:63], a[104:107], v[48:51]
    ds_read_b128 a[36:39], v22 offset:4096
    s_add_u32 s64, s18, 8388608
    s_addc_u32 s65, s19, 0
    v_mfma_f32_16x16x32_bf16 v[52:55], a[60:63], a[108:111], v[52:55]
    ds_read_b128 a[40:43], v22 offset:6144
    s_mov_b32 s66, 4194304
    s_mov_b32 s67, 0x00020000
    v_mfma_f32_16x16x32_bf16 v[56:59], a[60:63], a[112:115], v[56:59]
    ds_read_b128 a[44:47], v22 offset:8192
    s_add_u32 s52, s18, 4194304
    s_addc_u32 s53, s19, 0
    v_mfma_f32_16x16x32_bf16 v[60:63], a[60:63], a[116:119], v[60:63]
    ds_read_b128 a[48:51], v22 offset:10240
    s_mov_b32 s54, 4194304
    s_mov_b32 s55, 0x00020000
    v_mfma_f32_16x16x32_bf16 v[64:67], a[64:67], a[88:91], v[64:67]
    ds_read_b128 a[52:55], v22 offset:12288
    v_add_u32 v13, 1024, v4
    v_add_u32 v10, 2048, v4
    v_mfma_f32_16x16x32_bf16 v[68:71], a[64:67], a[92:95], v[68:71]
    ds_read_b128 a[56:59], v22 offset:14336
    v_add_u32 v9, 3072, v4
    s_lshl_b32 s34, s25, 1
    v_mfma_f32_16x16x32_bf16 v[72:75], a[64:67], a[96:99], v[72:75]
    ds_read_b64_tr_b16 a[0:1], v20 offset:32768
    v_mfma_f32_16x16x32_bf16 v[76:79], a[64:67], a[100:103], v[76:79]
    ds_read_b64_tr_b16 a[2:3], v20 offset:34560
    s_add_u32 s34, s34, s30
    s_mul_i32 s34, s34, 112
    v_mfma_f32_16x16x32_bf16 v[80:83], a[64:67], a[104:107], v[80:83]
    ds_read_b64_tr_b16 a[4:5], v20 offset:32800
    s_lshr_b32 s35, s26, 1
    s_mul_i32 s35, s35, 7
    v_mfma_f32_16x16x32_bf16 v[84:87], a[64:67], a[108:111], v[84:87]
    ds_read_b64_tr_b16 a[6:7], v20 offset:34592
    s_add_u32 s34, s34, s35
    s_lshl_b32 s35, s31, 2
    v_mfma_f32_16x16x32_bf16 v[88:91], a[64:67], a[112:115], v[88:91]
    ds_read_b64_tr_b16 a[8:9], v20 offset:32832
    s_add_u32 s35, s35, s34
    s_lshl_b32 s3, s29, 1
    v_mfma_f32_16x16x32_bf16 v[92:95], a[64:67], a[116:119], v[92:95]
    ds_read_b64_tr_b16 a[10:11], v20 offset:34624
    s_add_u32 s3, s3, s35
    s_lshl_b32 s4, s3, 13
    v_mfma_f32_16x16x32_bf16 v[96:99], a[68:71], a[88:91], v[96:99]
    ds_read_b64_tr_b16 a[12:13], v20 offset:40960
    s_add_u32 s5, s4, 4096
    s_add_u32 s35, s35, 1
    v_mfma_f32_16x16x32_bf16 v[100:103], a[68:71], a[92:95], v[100:103]
    ds_read_b64_tr_b16 a[14:15], v20 offset:42752
    s_lshl_b32 s6, s35, 13
    s_add_u32 s7, s6, 4096
    v_mfma_f32_16x16x32_bf16 v[104:107], a[68:71], a[96:99], v[104:107]
    ds_read_b64_tr_b16 a[16:17], v20 offset:40992
    v_mfma_f32_16x16x32_bf16 v[108:111], a[68:71], a[100:103], v[108:111]
    ds_read_b64_tr_b16 a[18:19], v20 offset:42784
    s_add_u32 s34, s34, 3
    s_lshl_b32 s8, s34, 13
    v_mfma_f32_16x16x32_bf16 v[112:115], a[68:71], a[104:107], v[112:115]
    ds_read_b64_tr_b16 a[20:21], v20 offset:41024
    s_add_u32 s9, s8, 4096
    v_cmp_lt_u32 s[84:85], 31, v1
    v_mfma_f32_16x16x32_bf16 v[116:119], a[68:71], a[108:111], v[116:119]
    ds_read_b64_tr_b16 a[22:23], v20 offset:42816
    s_add_u32 s48, s18, 29360128
    s_addc_u32 s49, s19, 0
    v_mfma_f32_16x16x32_bf16 v[120:123], a[68:71], a[112:115], v[120:123]
    ds_read_b64_tr_b16 a[24:25], v21 offset:32768
    s_mov_b32 s50, 7340032
    s_mov_b32 s51, 0x00020000
    v_mfma_f32_16x16x32_bf16 v[124:127], a[68:71], a[116:119], v[124:127]
    ds_read_b64_tr_b16 a[26:27], v21 offset:34560
    s_cmp_ge_u32 s62, 896
    s_cselect_b32 s50, 0, s50
    v_mfma_f32_16x16x32_bf16 v[128:131], a[72:75], a[88:91], v[128:131]
    buffer_load_dwordx4 a[160:163], v12, s[56:59], s78 offen offset:0 sc1
    v_mfma_f32_16x16x32_bf16 v[132:135], a[72:75], a[92:95], v[132:135]
    buffer_load_dwordx4 a[164:167], v12, s[56:59], s78 offen offset:1024 sc1
    v_mfma_f32_16x16x32_bf16 v[136:139], a[72:75], a[96:99], v[136:139]
    buffer_load_dwordx4 a[168:171], v12, s[56:59], s78 offen offset:2048 sc1
    v_mfma_f32_16x16x32_bf16 v[140:143], a[72:75], a[100:103], v[140:143]
    buffer_load_dwordx4 a[172:175], v12, s[56:59], s78 offen offset:3072 sc1
    v_mfma_f32_16x16x32_bf16 v[144:147], a[72:75], a[104:107], v[144:147]
    buffer_load_dwordx4 a[176:179], v11, s[56:59], s32 offen offset:0 sc1
    v_mfma_f32_16x16x32_bf16 v[148:151], a[72:75], a[108:111], v[148:151]
    buffer_load_dwordx4 a[180:183], v11, s[56:59], s32 offen offset:256 sc1
    v_mfma_f32_16x16x32_bf16 v[152:155], a[72:75], a[112:115], v[152:155]
    buffer_load_dwordx4 a[184:187], v11, s[56:59], s32 offen offset:512 sc1
    v_mfma_f32_16x16x32_bf16 v[156:159], a[72:75], a[116:119], v[156:159]
    buffer_load_dwordx4 a[188:191], v11, s[56:59], s32 offen offset:768 sc1
    v_mfma_f32_16x16x32_bf16 v[160:163], a[76:79], a[88:91], v[160:163]
    buffer_load_dwordx4 a[192:195], v11, s[56:59], s32 offen offset:1024 sc1
    v_mfma_f32_16x16x32_bf16 v[164:167], a[76:79], a[92:95], v[164:167]
    buffer_load_dwordx4 a[196:199], v11, s[56:59], s32 offen offset:1280 sc1
    v_mfma_f32_16x16x32_bf16 v[168:171], a[76:79], a[96:99], v[168:171]
    buffer_load_dwordx4 a[200:203], v11, s[56:59], s32 offen offset:1536 sc1
    v_mfma_f32_16x16x32_bf16 v[172:175], a[76:79], a[100:103], v[172:175]
    buffer_load_dwordx4 a[204:207], v11, s[56:59], s32 offen offset:1792 sc1
    v_mfma_f32_16x16x32_bf16 v[176:179], a[76:79], a[104:107], v[176:179]
    s_waitcnt vmcnt(15)
    v_mfma_f32_16x16x32_bf16 v[180:183], a[76:79], a[108:111], v[180:183]
    v_xor_b32 v17, 0, v31
    ds_read_b64_tr_b16 a[208:209], v17 offset:0
    ds_read_b64_tr_b16 a[210:211], v17 offset:4096
    v_mfma_f32_16x16x32_bf16 v[184:187], a[76:79], a[112:115], v[184:187]
    v_xor_b32 v18, 32, v31
    ds_read_b64_tr_b16 a[212:213], v18 offset:0
    ds_read_b64_tr_b16 a[214:215], v18 offset:4096
    v_mfma_f32_16x16x32_bf16 v[188:191], a[76:79], a[116:119], v[188:191]
    v_xor_b32 v17, 64, v31
    ds_read_b64_tr_b16 a[216:217], v17 offset:0
    ds_read_b64_tr_b16 a[218:219], v17 offset:4096
    v_mfma_f32_16x16x32_bf16 v[192:195], a[80:83], a[88:91], v[192:195]
    v_xor_b32 v18, 96, v31
    ds_read_b64_tr_b16 a[220:221], v18 offset:0
    ds_read_b64_tr_b16 a[222:223], v18 offset:4096
    v_mfma_f32_16x16x32_bf16 v[196:199], a[80:83], a[92:95], v[196:199]
    v_xor_b32 v17, 128, v31
    ds_read_b64_tr_b16 a[224:225], v17 offset:0
    ds_read_b64_tr_b16 a[226:227], v17 offset:4096
    v_mfma_f32_16x16x32_bf16 v[200:203], a[80:83], a[96:99], v[200:203]
    v_xor_b32 v18, 160, v31
    ds_read_b64_tr_b16 a[228:229], v18 offset:0
    ds_read_b64_tr_b16 a[230:231], v18 offset:4096
    v_mfma_f32_16x16x32_bf16 v[204:207], a[80:83], a[100:103], v[204:207]
    v_xor_b32 v17, 192, v31
    ds_read_b64_tr_b16 a[232:233], v17 offset:0
    ds_read_b64_tr_b16 a[234:235], v17 offset:4096
    v_mfma_f32_16x16x32_bf16 v[208:211], a[80:83], a[104:107], v[208:211]
    v_xor_b32 v18, 224, v31
    ds_read_b64_tr_b16 a[236:237], v18 offset:0
    ds_read_b64_tr_b16 a[238:239], v18 offset:4096
    v_mfma_f32_16x16x32_bf16 v[212:215], a[80:83], a[108:111], v[212:215]
    v_and_b32 v12, 31, v1
    v_lshlrev_b32 v12, 4, v12
    v_mfma_f32_16x16x32_bf16 v[216:219], a[80:83], a[112:115], v[216:219]
    v_lshrrev_b32 v19, 5, v1
    v_lshl_add_u32 v12, v19, 10, v12
    v_mfma_f32_16x16x32_bf16 v[220:223], a[80:83], a[116:119], v[220:223]
    s_lshl_b32 s3, s29, 9
    v_add_u32 v12, s3, v12
    v_mfma_f32_16x16x32_bf16 a[128:131], a[84:87], a[88:91], a[128:131]
    v_lshl_add_u32 v11, v19, 10, v11
    v_bfe_u32 v19, v1, 4, 1
    v_mfma_f32_16x16x32_bf16 a[132:135], a[84:87], a[92:95], a[132:135]
    v_lshl_add_u32 v11, v19, 11, v11
    s_lshl_b32 s3, s31, 1
    v_mfma_f32_16x16x32_bf16 a[136:139], a[84:87], a[96:99], a[136:139]
    s_add_u32 s3, s3, s29
    s_lshl_b32 s3, s3, 8
    v_mfma_f32_16x16x32_bf16 a[140:143], a[84:87], a[100:103], a[140:143]
    v_add_u32 v11, s3, v11
    v_mfma_f32_16x16x32_bf16 a[144:147], a[84:87], a[104:107], a[144:147]
    v_mfma_f32_16x16x32_bf16 a[148:151], a[84:87], a[108:111], a[148:151]
    s_waitcnt vmcnt(12)
    v_mfma_f32_16x16x32_bf16 a[152:155], a[84:87], a[112:115], a[152:155]
    v_mfma_f32_16x16x32_bf16 a[156:159], a[84:87], a[116:119], a[156:159]
    s_waitcnt lgkmcnt(0)
    s_barrier
    v_mfma_f32_16x16x32_bf16 v[32:35], a[0:3], a[28:31], v[32:35]
    ds_read_b128 a[88:91], v23 offset:0
    ds_read_b128 a[92:95], v23 offset:2048
    v_mfma_f32_16x16x32_bf16 v[128:131], a[12:15], a[28:31], v[128:131]
    ds_read_b128 a[96:99], v23 offset:4096
    v_mfma_f32_16x16x32_bf16 v[64:67], a[4:7], a[28:31], v[64:67]
    ds_read_b128 a[100:103], v23 offset:6144
    v_mfma_f32_16x16x32_bf16 v[160:163], a[16:19], a[28:31], v[160:163]
    ds_read_b128 a[104:107], v23 offset:8192
    v_mfma_f32_16x16x32_bf16 v[36:39], a[0:3], a[32:35], v[36:39]
    ds_read_b128 a[108:111], v23 offset:10240
    v_mfma_f32_16x16x32_bf16 v[132:135], a[12:15], a[32:35], v[132:135]
    ds_read_b128 a[112:115], v23 offset:12288
    ds_read_b128 a[116:119], v23 offset:14336
    v_mfma_f32_16x16x32_bf16 v[68:71], a[4:7], a[32:35], v[68:71]
    ds_read_b64_tr_b16 a[60:61], v20 offset:49152
    v_mfma_f32_16x16x32_bf16 v[164:167], a[16:19], a[32:35], v[164:167]
    ds_read_b64_tr_b16 a[62:63], v20 offset:50944
    v_mfma_f32_16x16x32_bf16 v[40:43], a[0:3], a[36:39], v[40:43]
    ds_read_b64_tr_b16 a[64:65], v20 offset:49184
    v_mfma_f32_16x16x32_bf16 v[136:139], a[12:15], a[36:39], v[136:139]
    ds_read_b64_tr_b16 a[66:67], v20 offset:50976
    v_mfma_f32_16x16x32_bf16 v[72:75], a[4:7], a[36:39], v[72:75]
    ds_read_b64_tr_b16 a[68:69], v20 offset:49216
    ds_read_b64_tr_b16 a[70:71], v20 offset:51008
    v_mfma_f32_16x16x32_bf16 v[168:171], a[16:19], a[36:39], v[168:171]
    ds_read_b64_tr_b16 a[72:73], v20 offset:57344
    v_mfma_f32_16x16x32_bf16 v[44:47], a[0:3], a[40:43], v[44:47]
    ds_read_b64_tr_b16 a[74:75], v20 offset:59136
    v_mfma_f32_16x16x32_bf16 v[140:143], a[12:15], a[40:43], v[140:143]
    ds_read_b64_tr_b16 a[76:77], v20 offset:57376
    v_mfma_f32_16x16x32_bf16 v[76:79], a[4:7], a[40:43], v[76:79]
    ds_read_b64_tr_b16 a[78:79], v20 offset:59168
    v_mfma_f32_16x16x32_bf16 v[172:175], a[16:19], a[40:43], v[172:175]
    ds_read_b64_tr_b16 a[80:81], v20 offset:57408
    ds_read_b64_tr_b16 a[82:83], v20 offset:59200
    v_mfma_f32_16x16x32_bf16 v[48:51], a[0:3], a[44:47], v[48:51]
    ds_read_b64_tr_b16 a[84:85], v21 offset:49152
    v_mfma_f32_16x16x32_bf16 v[144:147], a[12:15], a[44:47], v[144:147]
    ds_read_b64_tr_b16 a[86:87], v21 offset:50944
    v_mfma_f32_16x16x32_bf16 v[80:83], a[4:7], a[44:47], v[80:83]
    s_add_u32 m0, s33, 4640
    s_add_u32 s3, s80, 0
    buffer_load_dwordx4 v2, s[44:47], s3 offen lds
    v_mfma_f32_16x16x32_bf16 v[176:179], a[16:19], a[44:47], v[176:179]
    buffer_load_dwordx4 v2, s[44:47], s3 offen offset:1024 lds
    v_mfma_f32_16x16x32_bf16 v[52:55], a[0:3], a[48:51], v[52:55]
    buffer_load_dwordx4 v2, s[44:47], s3 offen offset:2048 lds
    buffer_load_dwordx4 v2, s[44:47], s3 offen offset:3072 lds
    v_mfma_f32_16x16x32_bf16 v[148:151], a[12:15], a[48:51], v[148:151]
    s_add_u32 m0, s33, 8800
    s_add_u32 s3, s80, 2
    buffer_load_dwordx4 v2, s[44:47], s3 offen lds
    v_mfma_f32_16x16x32_bf16 v[84:87], a[4:7], a[48:51], v[84:87]
    buffer_load_dwordx4 v2, s[44:47], s3 offen offset:1024 lds
    v_mfma_f32_16x16x32_bf16 v[180:183], a[16:19], a[48:51], v[180:183]
    buffer_load_dwordx4 v2, s[44:47], s3 offen offset:2048 lds
    v_mfma_f32_16x16x32_bf16 v[56:59], a[0:3], a[52:55], v[56:59]
    buffer_load_dwordx4 v2, s[44:47], s3 offen offset:3072 lds
    v_mfma_f32_16x16x32_bf16 v[152:155], a[12:15], a[52:55], v[152:155]
    buffer_load_dword v3, v30, s[68:71], 0 offen sc1
    ds_write_b128 v14, v[224:227] offset:4096
    v_mfma_f32_16x16x32_bf16 v[88:91], a[4:7], a[52:55], v[88:91]
    v_lshlrev_b64 v[228:229], 16, v[228:229]
    v_mfma_f32_16x16x32_bf16 v[184:187], a[16:19], a[52:55], v[184:187]
    v_lshlrev_b64 v[228:229], v16, v[228:229]
    v_mfma_f32_16x16x32_bf16 v[60:63], a[0:3], a[56:59], v[60:63]
    v_cndmask_b32 v228, 0, v228, s[82:83]
    v_cndmask_b32 v229, 0, v229, s[82:83]
    v_mfma_f32_16x16x32_bf16 v[156:159], a[12:15], a[56:59], v[156:159]
    ds_write_b64 v15, v[228:229] offset:4608
    v_lshlrev_b32 v8, 16, v230
    v_mfma_f32_16x16x32_bf16 v[92:95], a[4:7], a[56:59], v[92:95]
    v_mfma_f32_16x16x32_bf16 v[188:191], a[16:19], a[56:59], v[188:191]
    s_waitcnt lgkmcnt(0)
    v_mfma_f32_16x16x32_bf16 v[32:35], a[60:63], a[88:91], v[32:35]
    v_mfma_f32_16x16x32_bf16 v[128:131], a[72:75], a[88:91], v[128:131]
    v_mfma_f32_16x16x32_bf16 v[64:67], a[64:67], a[88:91], v[64:67]
    v_mfma_f32_16x16x32_bf16 v[160:163], a[76:79], a[88:91], v[160:163]
    s_waitcnt vmcnt(9)
    v_mfma_f32_16x16x16_bf16 v[32:35], a[160:161], a[176:177], v[32:35]
    v_mfma_f32_16x16x16_bf16 v[128:131], a[166:167], a[176:177], v[128:131]
    v_mfma_f32_16x16x16_bf16 v[64:67], a[162:163], a[176:177], v[64:67]
    v_mfma_f32_16x16x16_bf16 v[160:163], a[168:169], a[176:177], v[160:163]
    v_mfma_f32_16x16x32_bf16 v[96:99], a[8:11], a[28:31], v[96:99]
    buffer_store_dwordx4 a[208:211], v2, s[48:51], s40 offen offset:0 sc1
    v_mfma_f32_16x16x32_bf16 v[192:195], a[20:23], a[28:31], v[192:195]
    v_mfma_f32_16x16x32_bf16 a[128:131], a[24:27], a[28:31], a[128:131]
    v_mfma_f32_16x16x32_bf16 v[36:39], a[60:63], a[92:95], v[36:39]
    v_accvgpr_read_b32 v17, a178
    v_accvgpr_read_b32 v18, a179
    v_mul_f32 v32, v32, v18
    v_mul_f32 v33, v33, v18
    v_mul_f32 v34, v34, v18
    v_mul_f32 v35, v35, v18
    v_mfma_f32_16x16x32_bf16 v[132:135], a[72:75], a[92:95], v[132:135]
    v_exp_f32 v32, v32
    v_exp_f32 v33, v33
    v_exp_f32 v34, v34
    v_mfma_f32_16x16x32_bf16 v[68:71], a[64:67], a[92:95], v[68:71]
    v_exp_f32 v35, v35
    v_fma_f32 v32, v32, v17, v17
    v_fma_f32 v33, v33, v17, v17
    v_fma_f32 v34, v34, v17, v17
    v_mfma_f32_16x16x32_bf16 v[164:167], a[76:79], a[92:95], v[164:167]
    v_fma_f32 v35, v35, v17, v17
    v_rcp_f32 v32, v32
    v_rcp_f32 v33, v33
    v_mfma_f32_16x16x16_bf16 v[36:39], a[160:161], a[180:181], v[36:39]
    v_rcp_f32 v34, v34
    v_rcp_f32 v35, v35
    v_mul_f32 v32, v32, v128
    v_mul_f32 v33, v33, v129
    v_mfma_f32_16x16x16_bf16 v[132:135], a[166:167], a[180:181], v[132:135]
    v_mul_f32 v34, v34, v130
    v_mul_f32 v35, v35, v131
    v_cvt_pk_bf16_f32 v32, v32, v33
    v_cvt_pk_bf16_f32 v33, v34, v35
    v_mul_f32 v64, v64, v18
    v_mfma_f32_16x16x16_bf16 v[68:71], a[162:163], a[180:181], v[68:71]
    v_mul_f32 v65, v65, v18
    v_mul_f32 v66, v66, v18
    v_mul_f32 v67, v67, v18
    v_exp_f32 v64, v64
    v_exp_f32 v65, v65
    v_mfma_f32_16x16x16_bf16 v[164:167], a[168:169], a[180:181], v[164:167]
    v_exp_f32 v66, v66
    v_exp_f32 v67, v67
    v_mfma_f32_16x16x32_bf16 v[100:103], a[8:11], a[32:35], v[100:103]
    buffer_store_dwordx4 a[212:215], v2, s[48:51], s40 offen offset:1024 sc1
    v_fma_f32 v64, v64, v17, v17
    v_fma_f32 v65, v65, v17, v17
    v_fma_f32 v66, v66, v17, v17
    v_fma_f32 v67, v67, v17, v17
    v_rcp_f32 v64, v64
    v_mfma_f32_16x16x32_bf16 v[196:199], a[20:23], a[32:35], v[196:199]
    v_rcp_f32 v65, v65
    v_rcp_f32 v66, v66
    v_rcp_f32 v67, v67
    v_mfma_f32_16x16x32_bf16 a[132:135], a[24:27], a[32:35], a[132:135]
    v_mul_f32 v64, v64, v160
    v_mul_f32 v65, v65, v161
    v_mul_f32 v66, v66, v162
    v_mul_f32 v67, v67, v163
    v_cvt_pk_bf16_f32 v34, v64, v65
    v_mfma_f32_16x16x32_bf16 v[40:43], a[60:63], a[96:99], v[40:43]
    v_cvt_pk_bf16_f32 v35, v66, v67
    buffer_store_dwordx4 v[32:35], v2, s[92:95], s4 offen offset:0 sc1
    v_accvgpr_read_b32 v19, a182
    v_accvgpr_read_b32 v26, a183
    v_mul_f32 v36, v36, v26
    v_mfma_f32_16x16x32_bf16 v[136:139], a[72:75], a[96:99], v[136:139]
    v_mul_f32 v37, v37, v26
    v_mul_f32 v38, v38, v26
    v_mul_f32 v39, v39, v26
    v_exp_f32 v36, v36
    v_exp_f32 v37, v37
    v_mfma_f32_16x16x32_bf16 v[72:75], a[64:67], a[96:99], v[72:75]
    v_exp_f32 v38, v38
    v_exp_f32 v39, v39
    v_mfma_f32_16x16x32_bf16 v[168:171], a[76:79], a[96:99], v[168:171]
    v_fma_f32 v36, v36, v19, v19
    v_fma_f32 v37, v37, v19, v19
    v_fma_f32 v38, v38, v19, v19
    v_fma_f32 v39, v39, v19, v19
    v_rcp_f32 v36, v36
    v_mfma_f32_16x16x16_bf16 v[40:43], a[160:161], a[184:185], v[40:43]
    v_rcp_f32 v37, v37
    v_rcp_f32 v38, v38
    v_rcp_f32 v39, v39
    v_mfma_f32_16x16x16_bf16 v[136:139], a[166:167], a[184:185], v[136:139]
    v_mul_f32 v36, v36, v132
    v_mul_f32 v37, v37, v133
    v_mul_f32 v38, v38, v134
    v_mul_f32 v39, v39, v135
    v_cvt_pk_bf16_f32 v36, v36, v37
    v_mfma_f32_16x16x16_bf16 v[72:75], a[162:163], a[184:185], v[72:75]
    v_cvt_pk_bf16_f32 v37, v38, v39
    v_mul_f32 v68, v68, v26
    v_mul_f32 v69, v69, v26
    v_mul_f32 v70, v70, v26
    v_mul_f32 v71, v71, v26
    v_mfma_f32_16x16x16_bf16 v[168:171], a[168:169], a[184:185], v[168:171]
    v_exp_f32 v68, v68
    v_exp_f32 v69, v69
    v_exp_f32 v70, v70
    v_mfma_f32_16x16x32_bf16 v[104:107], a[8:11], a[36:39], v[104:107]
    buffer_store_dwordx4 a[216:219], v2, s[48:51], s40 offen offset:2048 sc1
    v_exp_f32 v71, v71
    v_fma_f32 v68, v68, v19, v19
    v_fma_f32 v69, v69, v19, v19
    v_fma_f32 v70, v70, v19, v19
    v_mfma_f32_16x16x32_bf16 v[200:203], a[20:23], a[36:39], v[200:203]
    v_fma_f32 v71, v71, v19, v19
    v_rcp_f32 v68, v68
    v_rcp_f32 v69, v69
    v_rcp_f32 v70, v70
    v_mfma_f32_16x16x32_bf16 a[136:139], a[24:27], a[36:39], a[136:139]
    v_rcp_f32 v71, v71
    v_mul_f32 v68, v68, v164
    v_mul_f32 v69, v69, v165
    v_mfma_f32_16x16x32_bf16 v[44:47], a[60:63], a[100:103], v[44:47]
    v_mul_f32 v70, v70, v166
    v_mul_f32 v71, v71, v167
    v_cvt_pk_bf16_f32 v38, v68, v69
    v_cvt_pk_bf16_f32 v39, v70, v71
    buffer_store_dwordx4 v[36:39], v2, s[92:95], s4 offen offset:1024 sc1
    v_accvgpr_read_b32 v27, a186
    v_mfma_f32_16x16x32_bf16 v[140:143], a[72:75], a[100:103], v[140:143]
    v_accvgpr_read_b32 v28, a187
    v_mul_f32 v40, v40, v28
    v_mul_f32 v41, v41, v28
    v_mul_f32 v42, v42, v28
    v_mul_f32 v43, v43, v28
    v_mfma_f32_16x16x32_bf16 v[76:79], a[64:67], a[100:103], v[76:79]
    v_exp_f32 v40, v40
    v_exp_f32 v41, v41
    v_exp_f32 v42, v42
    v_mfma_f32_16x16x32_bf16 v[172:175], a[76:79], a[100:103], v[172:175]
    v_exp_f32 v43, v43
    v_fma_f32 v40, v40, v27, v27
    v_fma_f32 v41, v41, v27, v27
    v_fma_f32 v42, v42, v27, v27
    v_mfma_f32_16x16x16_bf16 v[44:47], a[160:161], a[188:189], v[44:47]
    v_fma_f32 v43, v43, v27, v27
    v_rcp_f32 v40, v40
    v_rcp_f32 v41, v41
    v_rcp_f32 v42, v42
    v_mfma_f32_16x16x16_bf16 v[140:143], a[166:167], a[188:189], v[140:143]
    v_rcp_f32 v43, v43
    v_mul_f32 v40, v40, v136
    v_mul_f32 v41, v41, v137
    v_mfma_f32_16x16x16_bf16 v[76:79], a[162:163], a[188:189], v[76:79]
    v_mul_f32 v42, v42, v138
    v_mul_f32 v43, v43, v139
    v_cvt_pk_bf16_f32 v40, v40, v41
    v_cvt_pk_bf16_f32 v41, v42, v43
    v_mul_f32 v72, v72, v28
    v_mul_f32 v73, v73, v28
    v_mfma_f32_16x16x16_bf16 v[172:175], a[168:169], a[188:189], v[172:175]
    v_mul_f32 v74, v74, v28
    v_mul_f32 v75, v75, v28
    v_exp_f32 v72, v72
    v_exp_f32 v73, v73
    v_mfma_f32_16x16x32_bf16 v[108:111], a[8:11], a[40:43], v[108:111]
    buffer_store_dwordx4 a[220:223], v2, s[48:51], s40 offen offset:3072 sc1
    v_exp_f32 v74, v74
    v_exp_f32 v75, v75
    v_fma_f32 v72, v72, v27, v27
    v_mfma_f32_16x16x32_bf16 v[204:207], a[20:23], a[40:43], v[204:207]
    v_fma_f32 v73, v73, v27, v27
    v_fma_f32 v74, v74, v27, v27
    v_fma_f32 v75, v75, v27, v27
    v_rcp_f32 v72, v72
    v_mfma_f32_16x16x32_bf16 a[140:143], a[24:27], a[40:43], a[140:143]
    v_rcp_f32 v73, v73
    v_rcp_f32 v74, v74
    v_rcp_f32 v75, v75
    v_mfma_f32_16x16x32_bf16 v[48:51], a[60:63], a[104:107], v[48:51]
    v_mul_f32 v72, v72, v168
    v_mul_f32 v73, v73, v169
    v_mul_f32 v74, v74, v170
    v_mul_f32 v75, v75, v171
    v_cvt_pk_bf16_f32 v42, v72, v73
    v_mfma_f32_16x16x32_bf16 v[144:147], a[72:75], a[104:107], v[144:147]
    v_cvt_pk_bf16_f32 v43, v74, v75
    buffer_store_dwordx4 v[40:43], v2, s[92:95], s4 offen offset:2048 sc1
    v_accvgpr_read_b32 v31, a190
    v_accvgpr_read_b32 v20, a191
    v_mul_f32 v44, v44, v20
    v_mul_f32 v45, v45, v20
    v_mfma_f32_16x16x32_bf16 v[80:83], a[64:67], a[104:107], v[80:83]
    v_mul_f32 v46, v46, v20
    v_mul_f32 v47, v47, v20
    v_exp_f32 v44, v44
    v_exp_f32 v45, v45
    v_mfma_f32_16x16x32_bf16 v[176:179], a[76:79], a[104:107], v[176:179]
    v_exp_f32 v46, v46
    v_exp_f32 v47, v47
    v_fma_f32 v44, v44, v31, v31
    v_mfma_f32_16x16x16_bf16 v[48:51], a[160:161], a[192:193], v[48:51]
    v_fma_f32 v45, v45, v31, v31
    v_fma_f32 v46, v46, v31, v31
    v_fma_f32 v47, v47, v31, v31
    v_rcp_f32 v44, v44
    v_mfma_f32_16x16x16_bf16 v[144:147], a[166:167], a[192:193], v[144:147]
    v_rcp_f32 v45, v45
    v_rcp_f32 v46, v46
    v_rcp_f32 v47, v47
    v_mfma_f32_16x16x16_bf16 v[80:83], a[162:163], a[192:193], v[80:83]
    v_mul_f32 v44, v44, v140
    v_mul_f32 v45, v45, v141
    v_mul_f32 v46, v46, v142
    v_mul_f32 v47, v47, v143
    v_cvt_pk_bf16_f32 v44, v44, v45
    v_mfma_f32_16x16x16_bf16 v[176:179], a[168:169], a[192:193], v[176:179]
    v_cvt_pk_bf16_f32 v45, v46, v47
    v_mul_f32 v76, v76, v20
    v_mul_f32 v77, v77, v20
    v_mul_f32 v78, v78, v20
    v_mul_f32 v79, v79, v20
    v_exp_f32 v76, v76
    v_mfma_f32_16x16x32_bf16 v[112:115], a[8:11], a[44:47], v[112:115]
    buffer_store_dwordx4 a[224:227], v2, s[48:51], s41 offen offset:0 sc1
    v_exp_f32 v77, v77
    v_exp_f32 v78, v78
    v_mfma_f32_16x16x32_bf16 v[208:211], a[20:23], a[44:47], v[208:211]
    v_exp_f32 v79, v79
    v_fma_f32 v76, v76, v31, v31
    v_fma_f32 v77, v77, v31, v31
    v_fma_f32 v78, v78, v31, v31
    v_fma_f32 v79, v79, v31, v31
    v_mfma_f32_16x16x32_bf16 a[144:147], a[24:27], a[44:47], a[144:147]
    s_waitcnt vmcnt(8)
    s_mov_b32 s90, 0
La_chk2:
    v_cmp_eq_u32 vcc, v29, v3
    s_nop 0
    s_cmp_eq_u64 vcc, -1
    s_cbranch_scc0 La_spin2
La_go2:
    s_mov_b32 m0, s33
    s_nop 0
    buffer_load_dwordx4 v2, s[52:55], s80 offen offset:0 sc1 lds
    buffer_load_dwordx4 v2, s[52:55], s80 offen offset:1024 sc1 lds
    buffer_load_dwordx4 v2, s[52:55], s80 offen offset:2048 sc1 lds
    buffer_load_dwordx4 v2, s[52:55], s80 offen offset:3072 sc1 lds
    v_rcp_f32 v76, v76
    v_rcp_f32 v77, v77
    v_rcp_f32 v78, v78
    v_mfma_f32_16x16x32_bf16 v[52:55], a[60:63], a[108:111], v[52:55]
    v_rcp_f32 v79, v79
    v_mul_f32 v76, v76, v172
    v_mul_f32 v77, v77, v173
    v_mul_f32 v78, v78, v174
    v_mfma_f32_16x16x32_bf16 v[148:151], a[72:75], a[108:111], v[148:151]
    v_mul_f32 v79, v79, v175
    v_cvt_pk_bf16_f32 v46, v76, v77
    v_cvt_pk_bf16_f32 v47, v78, v79
    buffer_store_dwordx4 v[44:47], v2, s[92:95], s4 offen offset:3072 sc1
    v_accvgpr_read_b32 v21, a194
    v_mfma_f32_16x16x32_bf16 v[84:87], a[64:67], a[108:111], v[84:87]
    v_accvgpr_read_b32 v22, a195
    v_mul_f32 v48, v48, v22
    v_mul_f32 v49, v49, v22
    v_mul_f32 v50, v50, v22
    v_mul_f32 v51, v51, v22
    v_exp_f32 v48, v48
    v_mfma_f32_16x16x32_bf16 v[180:183], a[76:79], a[108:111], v[180:183]
    v_exp_f32 v49, v49
    v_exp_f32 v50, v50
    v_mfma_f32_16x16x16_bf16 v[52:55], a[160:161], a[196:197], v[52:55]
    v_exp_f32 v51, v51
    v_fma_f32 v48, v48, v21, v21
    v_fma_f32 v49, v49, v21, v21
    v_fma_f32 v50, v50, v21, v21
    v_fma_f32 v51, v51, v21, v21
    v_mfma_f32_16x16x16_bf16 v[148:151], a[166:167], a[196:197], v[148:151]
    v_rcp_f32 v48, v48
    v_rcp_f32 v49, v49
    v_rcp_f32 v50, v50
    v_mfma_f32_16x16x16_bf16 v[84:87], a[162:163], a[196:197], v[84:87]
    v_rcp_f32 v51, v51
    v_mul_f32 v48, v48, v144
    v_mul_f32 v49, v49, v145
    v_mul_f32 v50, v50, v146
    v_mfma_f32_16x16x16_bf16 v[180:183], a[168:169], a[196:197], v[180:183]
    v_mul_f32 v51, v51, v147
    v_cvt_pk_bf16_f32 v48, v48, v49
    v_cvt_pk_bf16_f32 v49, v50, v51
    v_mul_f32 v80, v80, v22
    v_mul_f32 v81, v81, v22
    v_mfma_f32_16x16x32_bf16 v[116:119], a[8:11], a[48:51], v[116:119]
    buffer_store_dwordx4 a[228:231], v2, s[48:51], s41 offen offset:1024 sc1
    v_mul_f32 v82, v82, v22
    v_mul_f32 v83, v83, v22
    v_exp_f32 v80, v80
    v_exp_f32 v81, v81
    v_mfma_f32_16x16x32_bf16 v[212:215], a[20:23], a[48:51], v[212:215]
    v_exp_f32 v82, v82
    v_exp_f32 v83, v83
    v_fma_f32 v80, v80, v21, v21
    v_mfma_f32_16x16x32_bf16 a[148:151], a[24:27], a[48:51], a[148:151]
    v_fma_f32 v81, v81, v21, v21
    v_fma_f32 v82, v82, v21, v21
    v_fma_f32 v83, v83, v21, v21
    v_rcp_f32 v80, v80
    v_rcp_f32 v81, v81
    v_mfma_f32_16x16x32_bf16 v[56:59], a[60:63], a[112:115], v[56:59]
    v_rcp_f32 v82, v82
    v_rcp_f32 v83, v83
    v_mfma_f32_16x16x32_bf16 v[152:155], a[72:75], a[112:115], v[152:155]
    v_mul_f32 v80, v80, v176
    v_mul_f32 v81, v81, v177
    v_mul_f32 v82, v82, v178
    v_mul_f32 v83, v83, v179
    v_cvt_pk_bf16_f32 v50, v80, v81
    v_cvt_pk_bf16_f32 v51, v82, v83
    v_mfma_f32_16x16x32_bf16 v[88:91], a[64:67], a[112:115], v[88:91]
    buffer_store_dwordx4 v[48:51], v2, s[92:95], s5 offen offset:0 sc1
    v_accvgpr_read_b32 v23, a198
    v_accvgpr_read_b32 v24, a199
    v_mul_f32 v52, v52, v24
    v_mul_f32 v53, v53, v24
    v_mfma_f32_16x16x32_bf16 v[184:187], a[76:79], a[112:115], v[184:187]
    v_mul_f32 v54, v54, v24
    v_mul_f32 v55, v55, v24
    v_exp_f32 v52, v52
    v_exp_f32 v53, v53
    v_mfma_f32_16x16x16_bf16 v[56:59], a[160:161], a[200:201], v[56:59]
    v_exp_f32 v54, v54
    v_exp_f32 v55, v55
    v_fma_f32 v52, v52, v23, v23
    v_mfma_f32_16x16x16_bf16 v[152:155], a[166:167], a[200:201], v[152:155]
    v_fma_f32 v53, v53, v23, v23
    v_fma_f32 v54, v54, v23, v23
    v_fma_f32 v55, v55, v23, v23
    v_rcp_f32 v52, v52
    v_rcp_f32 v53, v53
    v_mfma_f32_16x16x16_bf16 v[88:91], a[162:163], a[200:201], v[88:91]
    v_rcp_f32 v54, v54
    v_rcp_f32 v55, v55
    v_mfma_f32_16x16x16_bf16 v[184:187], a[168:169], a[200:201], v[184:187]
    v_mul_f32 v52, v52, v148
    v_mul_f32 v53, v53, v149
    v_mul_f32 v54, v54, v150
    v_mul_f32 v55, v55, v151
    v_cvt_pk_bf16_f32 v52, v52, v53
    v_cvt_pk_bf16_f32 v53, v54, v55
    v_mfma_f32_16x16x32_bf16 v[120:123], a[8:11], a[52:55], v[120:123]
    buffer_store_dwordx4 a[232:235], v2, s[48:51], s41 offen offset:2048 sc1
    v_mul_f32 v84, v84, v24
    v_mul_f32 v85, v85, v24
    v_mul_f32 v86, v86, v24
    v_mul_f32 v87, v87, v24
    v_exp_f32 v84, v84
    v_mfma_f32_16x16x32_bf16 v[216:219], a[20:23], a[52:55], v[216:219]
    v_exp_f32 v85, v85
    v_exp_f32 v86, v86
    v_exp_f32 v87, v87
    v_mfma_f32_16x16x32_bf16 a[152:155], a[24:27], a[52:55], a[152:155]
    v_fma_f32 v84, v84, v23, v23
    v_fma_f32 v85, v85, v23, v23
    v_fma_f32 v86, v86, v23, v23
    v_fma_f32 v87, v87, v23, v23
    v_mfma_f32_16x16x32_bf16 v[60:63], a[60:63], a[116:119], v[60:63]
    v_rcp_f32 v84, v84
    v_rcp_f32 v85, v85
    v_rcp_f32 v86, v86
    v_mfma_f32_16x16x32_bf16 v[156:159], a[72:75], a[116:119], v[156:159]
    v_rcp_f32 v87, v87
    v_mul_f32 v84, v84, v180
    v_mul_f32 v85, v85, v181
    v_mul_f32 v86, v86, v182
    v_mfma_f32_16x16x32_bf16 v[92:95], a[64:67], a[116:119], v[92:95]
    v_mul_f32 v87, v87, v183
    v_cvt_pk_bf16_f32 v54, v84, v85
    v_cvt_pk_bf16_f32 v55, v86, v87
    buffer_store_dwordx4 v[52:55], v2, s[92:95], s5 offen offset:1024 sc1
    v_accvgpr_read_b32 v25, a202
    v_accvgpr_read_b32 v14, a203
    v_mfma_f32_16x16x32_bf16 v[188:191], a[76:79], a[116:119], v[188:191]
    v_mul_f32 v56, v56, v14
    v_mul_f32 v57, v57, v14
    v_mul_f32 v58, v58, v14
    v_mul_f32 v59, v59, v14
    v_exp_f32 v56, v56
    v_mfma_f32_16x16x16_bf16 v[60:63], a[160:161], a[204:205], v[60:63]
    v_exp_f32 v57, v57
    v_exp_f32 v58, v58
    v_exp_f32 v59, v59
    v_mfma_f32_16x16x16_bf16 v[156:159], a[166:167], a[204:205], v[156:159]
    v_fma_f32 v56, v56, v25, v25
    v_fma_f32 v57, v57, v25, v25
    v_fma_f32 v58, v58, v25, v25
    v_fma_f32 v59, v59, v25, v25
    v_mfma_f32_16x16x16_bf16 v[92:95], a[162:163], a[204:205], v[92:95]
    v_rcp_f32 v56, v56
    v_rcp_f32 v57, v57
    v_rcp_f32 v58, v58
    v_mfma_f32_16x16x16_bf16 v[188:191], a[168:169], a[204:205], v[188:191]
    v_rcp_f32 v59, v59
    v_mul_f32 v56, v56, v152
    v_mul_f32 v57, v57, v153
    v_mul_f32 v58, v58, v154
    v_mfma_f32_16x16x32_bf16 v[124:127], a[8:11], a[56:59], v[124:127]
    buffer_store_dwordx4 a[236:239], v2, s[48:51], s41 offen offset:3072 sc1
    v_mul_f32 v59, v59, v155
    v_cvt_pk_bf16_f32 v56, v56, v57
    v_cvt_pk_bf16_f32 v57, v58, v59
    v_mul_f32 v88, v88, v14
    v_mul_f32 v89, v89, v14
    v_mul_f32 v90, v90, v14
    v_mfma_f32_16x16x32_bf16 v[220:223], a[20:23], a[56:59], v[220:223]
    v_mul_f32 v91, v91, v14
    v_exp_f32 v88, v88
    v_exp_f32 v89, v89
    v_mfma_f32_16x16x32_bf16 a[156:159], a[24:27], a[56:59], a[156:159]
    v_exp_f32 v90, v90
    v_exp_f32 v91, v91
    v_fma_f32 v88, v88, v25, v25
    v_fma_f32 v89, v89, v25, v25
    v_mfma_f32_16x16x32_bf16 v[96:99], a[68:71], a[88:91], v[96:99]
    v_fma_f32 v90, v90, v25, v25
    v_fma_f32 v91, v91, v25, v25
    v_rcp_f32 v88, v88
    v_rcp_f32 v89, v89
    v_mfma_f32_16x16x32_bf16 v[192:195], a[80:83], a[88:91], v[192:195]
    v_rcp_f32 v90, v90
    v_rcp_f32 v91, v91
    v_mul_f32 v88, v88, v184
    v_mfma_f32_16x16x32_bf16 a[128:131], a[84:87], a[88:91], a[128:131]
    v_mul_f32 v89, v89, v185
    v_mul_f32 v90, v90, v186
    v_mul_f32 v91, v91, v187
    v_cvt_pk_bf16_f32 v58, v88, v89
    v_cvt_pk_bf16_f32 v59, v90, v91
    v_mfma_f32_16x16x16_bf16 v[96:99], a[164:165], a[176:177], v[96:99]
    buffer_store_dwordx4 v[56:59], v2, s[92:95], s5 offen offset:2048 sc1
    v_accvgpr_read_b32 v15, a206
    v_accvgpr_read_b32 v16, a207
    v_mul_f32 v60, v60, v16
    v_mul_f32 v61, v61, v16
    v_mul_f32 v62, v62, v16
    v_mfma_f32_16x16x16_bf16 v[192:195], a[170:171], a[176:177], v[192:195]
    v_mul_f32 v63, v63, v16
    v_exp_f32 v60, v60
    v_exp_f32 v61, v61
    v_mfma_f32_16x16x16_bf16 a[128:131], a[172:173], a[176:177], a[128:131]
    v_exp_f32 v62, v62
    v_exp_f32 v63, v63
    v_fma_f32 v60, v60, v15, v15
    v_fma_f32 v61, v61, v15, v15
    v_mfma_f32_16x16x32_bf16 v[100:103], a[68:71], a[92:95], v[100:103]
    v_fma_f32 v62, v62, v15, v15
    v_fma_f32 v63, v63, v15, v15
    v_rcp_f32 v60, v60
    v_rcp_f32 v61, v61
    v_mfma_f32_16x16x32_bf16 v[196:199], a[80:83], a[92:95], v[196:199]
    v_rcp_f32 v62, v62
    v_rcp_f32 v63, v63
    v_mul_f32 v60, v60, v156
    v_mfma_f32_16x16x32_bf16 a[132:135], a[84:87], a[92:95], a[132:135]
    v_mul_f32 v61, v61, v157
    v_mul_f32 v62, v62, v158
    v_mul_f32 v63, v63, v159
    v_cvt_pk_bf16_f32 v60, v60, v61
    v_cvt_pk_bf16_f32 v61, v62, v63
    v_mfma_f32_16x16x16_bf16 v[100:103], a[164:165], a[180:181], v[100:103]
    v_mul_f32 v92, v92, v16
    v_mul_f32 v93, v93, v16
    v_mul_f32 v94, v94, v16
    v_mul_f32 v95, v95, v16
    v_exp_f32 v92, v92
    v_mfma_f32_16x16x16_bf16 v[196:199], a[170:171], a[180:181], v[196:199]
    v_exp_f32 v93, v93
    v_exp_f32 v94, v94
    v_exp_f32 v95, v95
    v_mfma_f32_16x16x16_bf16 a[132:135], a[172:173], a[180:181], a[132:135]
    v_fma_f32 v92, v92, v15, v15
    v_fma_f32 v93, v93, v15, v15
    v_fma_f32 v94, v94, v15, v15
    v_fma_f32 v95, v95, v15, v15
    v_rcp_f32 v92, v92
    v_mfma_f32_16x16x32_bf16 v[104:107], a[68:71], a[96:99], v[104:107]
    v_rcp_f32 v93, v93
    v_rcp_f32 v94, v94
    v_mfma_f32_16x16x32_bf16 v[200:203], a[80:83], a[96:99], v[200:203]
    v_rcp_f32 v95, v95
    v_mul_f32 v92, v92, v188
    v_mul_f32 v93, v93, v189
    v_mul_f32 v94, v94, v190
    v_mul_f32 v95, v95, v191
    v_mfma_f32_16x16x32_bf16 a[136:139], a[84:87], a[96:99], a[136:139]
    v_cvt_pk_bf16_f32 v62, v92, v93
    v_cvt_pk_bf16_f32 v63, v94, v95
    buffer_store_dwordx4 v[60:63], v2, s[92:95], s5 offen offset:3072 sc1
    v_mul_f32 v96, v96, v18
    v_mul_f32 v97, v97, v18
    v_mfma_f32_16x16x16_bf16 v[104:107], a[164:165], a[184:185], v[104:107]
    v_mul_f32 v98, v98, v18
    v_mul_f32 v99, v99, v18
    v_exp_f32 v96, v96
    v_exp_f32 v97, v97
    v_mfma_f32_16x16x16_bf16 v[200:203], a[170:171], a[184:185], v[200:203]
    v_exp_f32 v98, v98
    v_exp_f32 v99, v99
    v_fma_f32 v96, v96, v17, v17
    v_mfma_f32_16x16x16_bf16 a[136:139], a[172:173], a[184:185], a[136:139]
    v_fma_f32 v97, v97, v17, v17
    v_fma_f32 v98, v98, v17, v17
    v_fma_f32 v99, v99, v17, v17
    v_rcp_f32 v96, v96
    v_rcp_f32 v97, v97
    v_mfma_f32_16x16x32_bf16 v[108:111], a[68:71], a[100:103], v[108:111]
    v_rcp_f32 v98, v98
    v_rcp_f32 v99, v99
    v_mfma_f32_16x16x32_bf16 v[204:207], a[80:83], a[100:103], v[204:207]
    v_mul_f32 v96, v96, v192
    v_mul_f32 v97, v97, v193
    v_mul_f32 v98, v98, v194
    v_mul_f32 v99, v99, v195
    v_cvt_pk_bf16_f32 v96, v96, v97
    v_cvt_pk_bf16_f32 v97, v98, v99
    v_mfma_f32_16x16x32_bf16 a[140:143], a[84:87], a[100:103], a[140:143]
    v_mul_f32 v100, v100, v26
    v_mul_f32 v101, v101, v26
    v_mul_f32 v102, v102, v26
    v_mul_f32 v103, v103, v26
    v_exp_f32 v100, v100
    v_mfma_f32_16x16x16_bf16 v[108:111], a[164:165], a[188:189], v[108:111]
    v_exp_f32 v101, v101
    v_exp_f32 v102, v102
    v_exp_f32 v103, v103
    v_mfma_f32_16x16x16_bf16 v[204:207], a[170:171], a[188:189], v[204:207]
    s_waitcnt vmcnt(8)
    v_fma_f32 v100, v100, v19, v19
    v_fma_f32 v101, v101, v19, v19
    v_fma_f32 v102, v102, v19, v19
    v_fma_f32 v103, v103, v19, v19
    v_mfma_f32_16x16x16_bf16 a[140:143], a[172:173], a[188:189], a[140:143]
    ds_read_b128 a[32:35], v5 offset:3584
    v_rcp_f32 v100, v100
    v_rcp_f32 v101, v101
    v_rcp_f32 v102, v102
    v_mfma_f32_16x16x32_bf16 v[112:115], a[68:71], a[104:107], v[112:115]
    ds_read2_b32 a[0:1], v4 offset0:0 offset1:1
    v_rcp_f32 v103, v103
    v_mul_f32 v100, v100, v196
    v_mul_f32 v101, v101, v197
    v_mul_f32 v102, v102, v198
    v_mfma_f32_16x16x32_bf16 v[208:211], a[80:83], a[104:107], v[208:211]
    ds_read2_b32 a[2:3], v4 offset0:2 offset1:3
    v_mul_f32 v103, v103, v199
    v_cvt_pk_bf16_f32 v98, v100, v101
    v_cvt_pk_bf16_f32 v99, v102, v103
    s_nop 1
    v_permlane32_swap_b32 v96, v98
    v_permlane32_swap_b32 v97, v99
    v_mfma_f32_16x16x32_bf16 a[144:147], a[84:87], a[104:107], a[144:147]
    ds_read_b128 a[36:39], v5 offset:3072
    buffer_store_dwordx4 v[96:99], v12, s[92:95], s6 offen offset:0 sc1
    v_mul_f32 v104, v104, v28
    v_mul_f32 v105, v105, v28
    v_mul_f32 v106, v106, v28
    v_mul_f32 v107, v107, v28
    v_mfma_f32_16x16x16_bf16 v[112:115], a[164:165], a[192:193], v[112:115]
    ds_read2_b32 a[4:5], v4 offset0:128 offset1:129
    v_exp_f32 v104, v104
    v_exp_f32 v105, v105
    v_exp_f32 v106, v106
    v_mfma_f32_16x16x16_bf16 v[208:211], a[170:171], a[192:193], v[208:211]
    ds_read2_b32 a[6:7], v4 offset0:130 offset1:131
    v_exp_f32 v107, v107
    v_fma_f32 v104, v104, v27, v27
    v_fma_f32 v105, v105, v27, v27
    v_fma_f32 v106, v106, v27, v27
    v_mfma_f32_16x16x16_bf16 a[144:147], a[172:173], a[192:193], a[144:147]
    ds_read_b128 a[40:43], v5 offset:2560
    v_fma_f32 v107, v107, v27, v27
    v_rcp_f32 v104, v104
    v_rcp_f32 v105, v105
    v_rcp_f32 v106, v106
    v_mfma_f32_16x16x32_bf16 v[116:119], a[68:71], a[108:111], v[116:119]
    ds_read2_b32 a[8:9], v13 offset0:0 offset1:1
    v_rcp_f32 v107, v107
    v_mul_f32 v104, v104, v200
    v_mul_f32 v105, v105, v201
    v_mfma_f32_16x16x32_bf16 v[212:215], a[80:83], a[108:111], v[212:215]
    ds_read2_b32 a[10:11], v13 offset0:2 offset1:3
    v_mul_f32 v106, v106, v202
    v_mul_f32 v107, v107, v203
    v_cvt_pk_bf16_f32 v104, v104, v105
    v_cvt_pk_bf16_f32 v105, v106, v107
    v_mul_f32 v108, v108, v20
    v_mul_f32 v109, v109, v20
    v_mfma_f32_16x16x32_bf16 a[148:151], a[84:87], a[108:111], a[148:151]
    ds_read_b128 a[44:47], v5 offset:2048
    v_mul_f32 v110, v110, v20
    v_mul_f32 v111, v111, v20
    v_exp_f32 v108, v108
    v_exp_f32 v109, v109
    v_mfma_f32_16x16x16_bf16 v[116:119], a[164:165], a[196:197], v[116:119]
    ds_read2_b32 a[12:13], v13 offset0:128 offset1:129
    v_exp_f32 v110, v110
    v_exp_f32 v111, v111
    v_fma_f32 v108, v108, v31, v31
    v_mfma_f32_16x16x16_bf16 v[212:215], a[170:171], a[196:197], v[212:215]
    ds_read2_b32 a[14:15], v13 offset0:130 offset1:131
    v_fma_f32 v109, v109, v31, v31
    v_fma_f32 v110, v110, v31, v31
    v_fma_f32 v111, v111, v31, v31
    v_rcp_f32 v108, v108
    v_mfma_f32_16x16x16_bf16 a[148:151], a[172:173], a[196:197], a[148:151]
    ds_read_b128 a[48:51], v5 offset:1536
    v_rcp_f32 v109, v109
    v_rcp_f32 v110, v110
    v_rcp_f32 v111, v111
    v_mfma_f32_16x16x32_bf16 v[120:123], a[68:71], a[112:115], v[120:123]
    ds_read2_b32 a[16:17], v10 offset0:0 offset1:1
    v_mul_f32 v108, v108, v204
    v_mul_f32 v109, v109, v205
    v_mul_f32 v110, v110, v206
    v_mul_f32 v111, v111, v207
    v_cvt_pk_bf16_f32 v106, v108, v109
    v_mfma_f32_16x16x32_bf16 v[216:219], a[80:83], a[112:115], v[216:219]
    ds_read2_b32 a[18:19], v10 offset0:2 offset1:3
    v_cvt_pk_bf16_f32 v107, v110, v111
    s_nop 1
    v_permlane32_swap_b32 v104, v106
    v_permlane32_swap_b32 v105, v107
    buffer_store_dwordx4 v[104:107], v12, s[92:95], s6 offen offset:2048 sc1
    v_mul_f32 v112, v112, v22
    v_mfma_f32_16x16x32_bf16 a[152:155], a[84:87], a[112:115], a[152:155]
    ds_read_b128 a[52:55], v5 offset:1024
    v_mul_f32 v113, v113, v22
    v_mul_f32 v114, v114, v22
    v_mul_f32 v115, v115, v22
    v_exp_f32 v112, v112
    v_mfma_f32_16x16x16_bf16 v[120:123], a[164:165], a[200:201], v[120:123]
    ds_read2_b32 a[20:21], v10 offset0:128 offset1:129
    v_exp_f32 v113, v113
    v_exp_f32 v114, v114
    v_exp_f32 v115, v115
    v_mfma_f32_16x16x16_bf16 v[216:219], a[170:171], a[200:201], v[216:219]
    ds_read2_b32 a[22:23], v10 offset0:130 offset1:131
    v_fma_f32 v112, v112, v21, v21
    v_fma_f32 v113, v113, v21, v21
    v_fma_f32 v114, v114, v21, v21
    v_fma_f32 v115, v115, v21, v21
    v_rcp_f32 v112, v112
    v_mfma_f32_16x16x16_bf16 a[152:155], a[172:173], a[200:201], a[152:155]
    ds_read_b128 a[56:59], v5 offset:512
    v_rcp_f32 v113, v113
    v_rcp_f32 v114, v114
    v_rcp_f32 v115, v115
    v_mfma_f32_16x16x32_bf16 v[124:127], a[68:71], a[116:119], v[124:127]
    ds_read2_b32 a[24:25], v9 offset0:0 offset1:1
    v_mul_f32 v112, v112, v208
    v_mul_f32 v113, v113, v209
    v_mul_f32 v114, v114, v210
    v_mul_f32 v115, v115, v211
    v_mfma_f32_16x16x32_bf16 v[220:223], a[80:83], a[116:119], v[220:223]
    ds_read2_b32 a[26:27], v9 offset0:2 offset1:3
    v_cvt_pk_bf16_f32 v112, v112, v113
    v_cvt_pk_bf16_f32 v113, v114, v115
    v_mul_f32 v116, v116, v24
    v_mul_f32 v117, v117, v24
    v_mul_f32 v118, v118, v24
    v_mul_f32 v119, v119, v24
    v_mfma_f32_16x16x32_bf16 a[156:159], a[84:87], a[116:119], a[156:159]
    ds_read_b128 a[60:63], v5 offset:0
    v_exp_f32 v116, v116
    v_exp_f32 v117, v117
    v_exp_f32 v118, v118
    v_mfma_f32_16x16x16_bf16 v[124:127], a[164:165], a[204:205], v[124:127]
    ds_read2_b32 a[28:29], v9 offset0:128 offset1:129
    v_exp_f32 v119, v119
    v_fma_f32 v116, v116, v23, v23
    v_fma_f32 v117, v117, v23, v23
    v_fma_f32 v118, v118, v23, v23
    v_mfma_f32_16x16x16_bf16 v[220:223], a[170:171], a[204:205], v[220:223]
    ds_read2_b32 a[30:31], v9 offset0:130 offset1:131
    v_fma_f32 v119, v119, v23, v23
    v_rcp_f32 v116, v116
    v_rcp_f32 v117, v117
    v_mfma_f32_16x16x16_bf16 a[156:159], a[172:173], a[204:205], a[156:159]
    v_rcp_f32 v118, v118
    v_rcp_f32 v119, v119
    v_mul_f32 v116, v116, v212
    v_mul_f32 v117, v117, v213
    v_mul_f32 v118, v118, v214
    v_mul_f32 v119, v119, v215
    v_cvt_pk_bf16_f32 v114, v116, v117
    v_cvt_pk_bf16_f32 v115, v118, v119
    s_nop 1
    v_permlane32_swap_b32 v112, v114
    v_permlane32_swap_b32 v113, v115
    buffer_store_dwordx4 v[112:115], v12, s[92:95], s7 offen offset:0 sc1
    v_mul_f32 v120, v120, v14
    v_mul_f32 v121, v121, v14
    v_mul_f32 v122, v122, v14
    v_mul_f32 v123, v123, v14
    v_exp_f32 v120, v120
    v_exp_f32 v121, v121
    v_exp_f32 v122, v122
    v_exp_f32 v123, v123
    v_fma_f32 v120, v120, v25, v25
    v_fma_f32 v121, v121, v25, v25
    v_fma_f32 v122, v122, v25, v25
    v_fma_f32 v123, v123, v25, v25
    v_rcp_f32 v120, v120
    v_rcp_f32 v121, v121
    v_rcp_f32 v122, v122
    v_rcp_f32 v123, v123
    v_mul_f32 v120, v120, v216
    v_mul_f32 v121, v121, v217
    v_mul_f32 v122, v122, v218
    v_mul_f32 v123, v123, v219
    v_cvt_pk_bf16_f32 v120, v120, v121
    v_cvt_pk_bf16_f32 v121, v122, v123
    v_mul_f32 v124, v124, v16
    v_mul_f32 v125, v125, v16
    v_mul_f32 v126, v126, v16
    v_mul_f32 v127, v127, v16
    v_exp_f32 v124, v124
    v_exp_f32 v125, v125
    v_exp_f32 v126, v126
    v_exp_f32 v127, v127
    v_fma_f32 v124, v124, v15, v15
    v_fma_f32 v125, v125, v15, v15
    v_fma_f32 v126, v126, v15, v15
    v_fma_f32 v127, v127, v15, v15
    v_rcp_f32 v124, v124
    v_rcp_f32 v125, v125
    v_rcp_f32 v126, v126
    v_rcp_f32 v127, v127
    v_mul_f32 v124, v124, v220
    v_mul_f32 v125, v125, v221
    v_mul_f32 v126, v126, v222
    v_mul_f32 v127, v127, v223
    v_cvt_pk_bf16_f32 v122, v124, v125
    v_cvt_pk_bf16_f32 v123, v126, v127
    s_nop 1
    v_permlane32_swap_b32 v120, v122
    v_permlane32_swap_b32 v121, v123
    buffer_store_dwordx4 v[120:123], v12, s[92:95], s7 offen offset:2048 sc1
    v_accvgpr_read_b32 v64, a128
    v_accvgpr_read_b32 v65, a129
    v_accvgpr_read_b32 v66, a130
    v_accvgpr_read_b32 v67, a131
    v_accvgpr_read_b32 v68, a132
    v_accvgpr_read_b32 v69, a133
    v_accvgpr_read_b32 v70, a134
    v_accvgpr_read_b32 v71, a135
    v_accvgpr_read_b32 v72, a136
    v_accvgpr_read_b32 v73, a137
    v_accvgpr_read_b32 v74, a138
    v_accvgpr_read_b32 v75, a139
    v_accvgpr_read_b32 v76, a140
    v_accvgpr_read_b32 v77, a141
    v_accvgpr_read_b32 v78, a142
    v_accvgpr_read_b32 v79, a143
    v_cndmask_b32 v17, v17, v19, s[84:85]
    v_cndmask_b32 v18, v18, v26, s[84:85]
    v_cndmask_b32 v27, v27, v31, s[84:85]
    v_cndmask_b32 v28, v28, v20, s[84:85]
    v_permlane32_swap_b32 v64, v68
    v_permlane32_swap_b32 v65, v69
    v_permlane32_swap_b32 v66, v70
    v_permlane32_swap_b32 v67, v71
    v_permlane32_swap_b32 v72, v76
    v_permlane32_swap_b32 v73, v77
    v_permlane32_swap_b32 v74, v78
    v_permlane32_swap_b32 v75, v79
    v_mul_f32 v64, v64, v18
    v_mul_f32 v65, v65, v18
    v_mul_f32 v66, v66, v18
    v_mul_f32 v67, v67, v18
    v_exp_f32 v64, v64
    v_exp_f32 v65, v65
    v_exp_f32 v66, v66
    v_exp_f32 v67, v67
    v_fma_f32 v64, v64, v17, v17
    v_fma_f32 v65, v65, v17, v17
    v_fma_f32 v66, v66, v17, v17
    v_fma_f32 v67, v67, v17, v17
    v_rcp_f32 v64, v64
    v_rcp_f32 v65, v65
    v_rcp_f32 v66, v66
    v_rcp_f32 v67, v67
    v_mul_f32 v64, v64, v68
    v_mul_f32 v65, v65, v69
    v_mul_f32 v66, v66, v70
    v_mul_f32 v67, v67, v71
    v_cvt_pk_bf16_f32 v64, v64, v65
    v_cvt_pk_bf16_f32 v65, v66, v67
    v_mul_f32 v72, v72, v28
    v_mul_f32 v73, v73, v28
    v_mul_f32 v74, v74, v28
    v_mul_f32 v75, v75, v28
    v_exp_f32 v72, v72
    v_exp_f32 v73, v73
    v_exp_f32 v74, v74
    v_exp_f32 v75, v75
    v_fma_f32 v72, v72, v27, v27
    v_fma_f32 v73, v73, v27, v27
    v_fma_f32 v74, v74, v27, v27
    v_fma_f32 v75, v75, v27, v27
    v_rcp_f32 v72, v72
    v_rcp_f32 v73, v73
    v_rcp_f32 v74, v74
    v_rcp_f32 v75, v75
    v_mul_f32 v72, v72, v76
    v_mul_f32 v73, v73, v77
    v_mul_f32 v74, v74, v78
    v_mul_f32 v75, v75, v79
    v_cvt_pk_bf16_f32 v66, v72, v73
    v_cvt_pk_bf16_f32 v67, v74, v75
    s_nop 1
    v_permlane16_swap_b32 v64, v66
    v_permlane16_swap_b32 v65, v67
    buffer_store_dwordx4 v[64:67], v11, s[92:95], s8 offen sc1
    v_accvgpr_read_b32 v80, a144
    v_accvgpr_read_b32 v81, a145
    v_accvgpr_read_b32 v82, a146
    v_accvgpr_read_b32 v83, a147
    v_accvgpr_read_b32 v84, a148
    v_accvgpr_read_b32 v85, a149
    v_accvgpr_read_b32 v86, a150
    v_accvgpr_read_b32 v87, a151
    v_accvgpr_read_b32 v88, a152
    v_accvgpr_read_b32 v89, a153
    v_accvgpr_read_b32 v90, a154
    v_accvgpr_read_b32 v91, a155
    v_accvgpr_read_b32 v92, a156
    v_accvgpr_read_b32 v93, a157
    v_accvgpr_read_b32 v94, a158
    v_accvgpr_read_b32 v95, a159
    v_cndmask_b32 v21, v21, v23, s[84:85]
    v_cndmask_b32 v22, v22, v24, s[84:85]
    v_cndmask_b32 v25, v25, v15, s[84:85]
    v_cndmask_b32 v14, v14, v16, s[84:85]
    v_permlane32_swap_b32 v80, v84
    v_permlane32_swap_b32 v81, v85
    v_permlane32_swap_b32 v82, v86
    v_permlane32_swap_b32 v83, v87
    v_permlane32_swap_b32 v88, v92
    v_permlane32_swap_b32 v89, v93
    v_permlane32_swap_b32 v90, v94
    v_permlane32_swap_b32 v91, v95
    v_mul_f32 v80, v80, v22
    v_mul_f32 v81, v81, v22
    v_mul_f32 v82, v82, v22
    v_mul_f32 v83, v83, v22
    v_exp_f32 v80, v80
    v_exp_f32 v81, v81
    v_exp_f32 v82, v82
    v_exp_f32 v83, v83
    v_fma_f32 v80, v80, v21, v21
    v_fma_f32 v81, v81, v21, v21
    v_fma_f32 v82, v82, v21, v21
    v_fma_f32 v83, v83, v21, v21
    v_rcp_f32 v80, v80
    v_rcp_f32 v81, v81
    v_rcp_f32 v82, v82
    v_rcp_f32 v83, v83
    v_mul_f32 v80, v80, v84
    v_mul_f32 v81, v81, v85
    v_mul_f32 v82, v82, v86
    v_mul_f32 v83, v83, v87
    v_cvt_pk_bf16_f32 v80, v80, v81
    v_cvt_pk_bf16_f32 v81, v82, v83
    v_mul_f32 v88, v88, v14
    v_mul_f32 v89, v89, v14
    v_mul_f32 v90, v90, v14
    v_mul_f32 v91, v91, v14
    v_exp_f32 v88, v88
    v_exp_f32 v89, v89
    v_exp_f32 v90, v90
    v_exp_f32 v91, v91
    v_fma_f32 v88, v88, v25, v25
    v_fma_f32 v89, v89, v25, v25
    v_fma_f32 v90, v90, v25, v25
    v_fma_f32 v91, v91, v25, v25
    v_rcp_f32 v88, v88
    v_rcp_f32 v89, v89
    v_rcp_f32 v90, v90
    v_rcp_f32 v91, v91
    v_mul_f32 v88, v88, v92
    v_mul_f32 v89, v89, v93
    v_mul_f32 v90, v90, v94
    v_mul_f32 v91, v91, v95
    v_cvt_pk_bf16_f32 v82, v88, v89
    v_cvt_pk_bf16_f32 v83, v90, v91
    s_nop 1
    v_permlane16_swap_b32 v80, v82
    v_permlane16_swap_b32 v81, v83
    buffer_store_dwordx4 v[80:83], v11, s[92:95], s9 offen sc1
    s_waitcnt lgkmcnt(0)
    v_mfma_f32_16x16x32_bf16 v[224:227], a[0:3], a[32:35], 0
    ds_read_b128 a[224:227], v5 offset:3648
    v_mfma_f32_16x16x32_bf16 v[228:231], a[0:3], a[36:39], 0
    ds_read2_b32 a[192:193], v4 offset0:16 offset1:17
    v_mfma_f32_16x16x32_bf16 v[232:235], a[0:3], a[40:43], 0
    ds_read2_b32 a[194:195], v4 offset0:18 offset1:19
    v_mfma_f32_16x16x32_bf16 v[236:239], a[0:3], a[44:47], 0
    ds_read_b128 a[228:231], v5 offset:3136
    v_mfma_f32_16x16x32_bf16 v[240:243], a[0:3], a[48:51], 0
    ds_read2_b32 a[196:197], v4 offset0:144 offset1:145
    v_mfma_f32_16x16x32_bf16 v[244:247], a[0:3], a[52:55], 0
    ds_read2_b32 a[198:199], v4 offset0:146 offset1:147
    v_mfma_f32_16x16x32_bf16 v[248:251], a[0:3], a[56:59], 0
    ds_read_b128 a[232:235], v5 offset:2624
    v_mfma_f32_16x16x32_bf16 v[252:255], a[0:3], a[60:63], 0
    ds_read2_b32 a[200:201], v13 offset0:16 offset1:17
    v_mfma_f32_16x16x32_bf16 v[228:231], a[4:7], a[32:35], v[228:231]
    ds_read2_b32 a[202:203], v13 offset0:18 offset1:19
    v_mfma_f32_16x16x32_bf16 v[232:235], a[4:7], a[36:39], v[232:235]
    ds_read_b128 a[236:239], v5 offset:2112
    v_mfma_f32_16x16x32_bf16 v[236:239], a[4:7], a[40:43], v[236:239]
    ds_read2_b32 a[204:205], v13 offset0:144 offset1:145
    v_mfma_f32_16x16x32_bf16 v[240:243], a[4:7], a[44:47], v[240:243]
    ds_read2_b32 a[206:207], v13 offset0:146 offset1:147
    v_mfma_f32_16x16x32_bf16 v[244:247], a[4:7], a[48:51], v[244:247]
    ds_read_b128 a[240:243], v5 offset:1600
    v_mfma_f32_16x16x32_bf16 v[248:251], a[4:7], a[52:55], v[248:251]
    ds_read2_b32 a[208:209], v10 offset0:16 offset1:17
    v_mfma_f32_16x16x32_bf16 v[252:255], a[4:7], a[56:59], v[252:255]
    ds_read2_b32 a[210:211], v10 offset0:18 offset1:19
    v_mfma_f32_16x16x32_bf16 v[232:235], a[8:11], a[32:35], v[232:235]
    ds_read_b128 a[244:247], v5 offset:1088
    v_mfma_f32_16x16x32_bf16 v[236:239], a[8:11], a[36:39], v[236:239]
    ds_read2_b32 a[212:213], v10 offset0:144 offset1:145
    v_mfma_f32_16x16x32_bf16 v[240:243], a[8:11], a[40:43], v[240:243]
    ds_read2_b32 a[214:215], v10 offset0:146 offset1:147
    v_mfma_f32_16x16x32_bf16 v[244:247], a[8:11], a[44:47], v[244:247]
    ds_read_b128 a[248:251], v5 offset:576
    v_mfma_f32_16x16x32_bf16 v[248:251], a[8:11], a[48:51], v[248:251]
    ds_read2_b32 a[216:217], v9 offset0:16 offset1:17
    v_mfma_f32_16x16x32_bf16 v[252:255], a[8:11], a[52:55], v[252:255]
    ds_read2_b32 a[218:219], v9 offset0:18 offset1:19
    v_mfma_f32_16x16x32_bf16 v[236:239], a[12:15], a[32:35], v[236:239]
    ds_read_b128 a[252:255], v5 offset:64
    v_mfma_f32_16x16x32_bf16 v[240:243], a[12:15], a[36:39], v[240:243]
    ds_read2_b32 a[220:221], v9 offset0:144 offset1:145
    v_mfma_f32_16x16x32_bf16 v[244:247], a[12:15], a[40:43], v[244:247]
    ds_read2_b32 a[222:223], v9 offset0:146 offset1:147
    v_mfma_f32_16x16x32_bf16 v[248:251], a[12:15], a[44:47], v[248:251]
    s_load_dwordx2 s[10:11], s[0:1], 80
    s_load_dwordx2 s[4:5], s[0:1], 0
    v_mfma_f32_16x16x32_bf16 v[252:255], a[12:15], a[48:51], v[252:255]
    s_and_b32 s12, s2, 1
    s_mov_b32 s13, s24
    v_mfma_f32_16x16x32_bf16 v[240:243], a[16:19], a[32:35], v[240:243]
    s_lshr_b32 s14, s2, 3
    s_bfe_u32 s15, s2, 0x10001
    v_mfma_f32_16x16x32_bf16 v[244:247], a[16:19], a[36:39], v[244:247]
    s_lshl_b32 s15, s15, 3
    s_and_b32 s17, s14, 7
    v_mfma_f32_16x16x32_bf16 v[248:251], a[16:19], a[40:43], v[248:251]
    s_add_u32 s15, s15, s17
    s_bfe_u32 s16, s2, 0x10002
    v_mfma_f32_16x16x32_bf16 v[252:255], a[16:19], a[44:47], v[252:255]
    s_lshl_b32 s16, s16, 2
    s_lshr_b32 s17, s14, 3
    v_mfma_f32_16x16x32_bf16 v[244:247], a[20:23], a[32:35], v[244:247]
    s_add_u32 s16, s16, s17
    s_lshl_b32 s17, s12, 2
    v_mfma_f32_16x16x32_bf16 v[248:251], a[20:23], a[36:39], v[248:251]
    s_add_u32 s17, s17, s13
    s_mul_i32 s17, s17, 14
    v_mfma_f32_16x16x32_bf16 v[252:255], a[20:23], a[40:43], v[252:255]
    s_mul_i32 s44, s15, 112
    s_add_u32 s44, s44, s17
    v_mfma_f32_16x16x32_bf16 v[248:251], a[24:27], a[32:35], v[248:251]
    s_lshl_b32 s44, s44, 13
    s_mul_i32 s45, s16, 224
    v_mfma_f32_16x16x32_bf16 v[252:255], a[24:27], a[36:39], v[252:255]
    s_add_u32 s45, s45, s17
    s_lshl_b32 s45, s45, 12
    v_mfma_f32_16x16x32_bf16 v[252:255], a[28:31], a[32:35], v[252:255]
    v_lshlrev_b32 v11, 4, v1
    s_add_u32 s17, s13, 0
    s_waitcnt vmcnt(0)
    s_barrier
    s_add_u32 s68, s18, 589824
    s_addc_u32 s69, s19, 0
    s_mov_b32 s70, 32768
    s_mov_b32 s71, 0x00020000
    s_lshl_b32 s3, s2, 2
    s_lshl_b32 s81, s24, 6
    v_add_u32 v3, s81, v1
    v_lshlrev_b32 v3, 10, v3
    buffer_store_dword v29, v3, s[68:71], s3 offen sc1
    s_waitcnt lgkmcnt(0)
    v_mfma_f32_16x16x32_bf16 v[224:227], a[192:195], a[224:227], v[224:227]
    ds_read_b128 a[160:163], v5 offset:3712
    v_mfma_f32_16x16x32_bf16 v[228:231], a[192:195], a[228:231], v[228:231]
    ds_read2_b32 a[128:129], v4 offset0:32 offset1:33
    v_mfma_f32_16x16x32_bf16 v[232:235], a[192:195], a[232:235], v[232:235]
    ds_read2_b32 a[130:131], v4 offset0:34 offset1:35
    v_mfma_f32_16x16x32_bf16 v[236:239], a[192:195], a[236:239], v[236:239]
    ds_read_b128 a[164:167], v5 offset:3200
    v_mfma_f32_16x16x32_bf16 v[240:243], a[192:195], a[240:243], v[240:243]
    ds_read2_b32 a[132:133], v4 offset0:160 offset1:161
    v_mfma_f32_16x16x32_bf16 v[244:247], a[192:195], a[244:247], v[244:247]
    ds_read2_b32 a[134:135], v4 offset0:162 offset1:163
    v_mfma_f32_16x16x32_bf16 v[248:251], a[192:195], a[248:251], v[248:251]
    ds_read_b128 a[168:171], v5 offset:2688
    v_mfma_f32_16x16x32_bf16 v[252:255], a[192:195], a[252:255], v[252:255]
    ds_read2_b32 a[136:137], v13 offset0:32 offset1:33
    v_mfma_f32_16x16x32_bf16 v[228:231], a[196:199], a[224:227], v[228:231]
    ds_read2_b32 a[138:139], v13 offset0:34 offset1:35
    v_mfma_f32_16x16x32_bf16 v[232:235], a[196:199], a[228:231], v[232:235]
    ds_read_b128 a[172:175], v5 offset:2176
    v_mfma_f32_16x16x32_bf16 v[236:239], a[196:199], a[232:235], v[236:239]
    ds_read2_b32 a[140:141], v13 offset0:160 offset1:161
    v_mfma_f32_16x16x32_bf16 v[240:243], a[196:199], a[236:239], v[240:243]
    ds_read2_b32 a[142:143], v13 offset0:162 offset1:163
    v_mfma_f32_16x16x32_bf16 v[244:247], a[196:199], a[240:243], v[244:247]
    ds_read_b128 a[176:179], v5 offset:1664
    v_mfma_f32_16x16x32_bf16 v[248:251], a[196:199], a[244:247], v[248:251]
    ds_read2_b32 a[144:145], v10 offset0:32 offset1:33
    v_mfma_f32_16x16x32_bf16 v[252:255], a[196:199], a[248:251], v[252:255]
    ds_read2_b32 a[146:147], v10 offset0:34 offset1:35
    v_mfma_f32_16x16x32_bf16 v[232:235], a[200:203], a[224:227], v[232:235]
    ds_read_b128 a[180:183], v5 offset:1152
    v_mfma_f32_16x16x32_bf16 v[236:239], a[200:203], a[228:231], v[236:239]
    ds_read2_b32 a[148:149], v10 offset0:160 offset1:161
    v_mfma_f32_16x16x32_bf16 v[240:243], a[200:203], a[232:235], v[240:243]
    ds_read2_b32 a[150:151], v10 offset0:162 offset1:163
    v_mfma_f32_16x16x32_bf16 v[244:247], a[200:203], a[236:239], v[244:247]
    ds_read_b128 a[184:187], v5 offset:640
    v_mfma_f32_16x16x32_bf16 v[248:251], a[200:203], a[240:243], v[248:251]
    ds_read2_b32 a[152:153], v9 offset0:32 offset1:33
    v_mfma_f32_16x16x32_bf16 v[252:255], a[200:203], a[244:247], v[252:255]
    ds_read2_b32 a[154:155], v9 offset0:34 offset1:35
    v_mfma_f32_16x16x32_bf16 v[236:239], a[204:207], a[224:227], v[236:239]
    ds_read_b128 a[188:191], v5 offset:128
    v_mfma_f32_16x16x32_bf16 v[240:243], a[204:207], a[228:231], v[240:243]
    ds_read2_b32 a[156:157], v9 offset0:160 offset1:161
    v_mfma_f32_16x16x32_bf16 v[244:247], a[204:207], a[232:235], v[244:247]
    ds_read2_b32 a[158:159], v9 offset0:162 offset1:163
    v_mfma_f32_16x16x32_bf16 v[248:251], a[204:207], a[236:239], v[248:251]
    s_and_b32 s17, s17, 3
    s_lshl_b32 s17, s17, 11
    v_mfma_f32_16x16x32_bf16 v[252:255], a[204:207], a[240:243], v[252:255]
    v_add_u32 v14, s17, v11
    s_add_u32 s17, s13, 1
    v_mfma_f32_16x16x32_bf16 v[240:243], a[208:211], a[224:227], v[240:243]
    s_and_b32 s17, s17, 3
    s_lshl_b32 s17, s17, 11
    v_mfma_f32_16x16x32_bf16 v[244:247], a[208:211], a[228:231], v[244:247]
    v_add_u32 v15, s17, v11
    s_add_u32 s17, s13, 2
    v_mfma_f32_16x16x32_bf16 v[248:251], a[208:211], a[232:235], v[248:251]
    s_and_b32 s17, s17, 3
    s_lshl_b32 s17, s17, 11
    v_mfma_f32_16x16x32_bf16 v[252:255], a[208:211], a[236:239], v[252:255]
    v_add_u32 v16, s17, v11
    s_add_u32 s17, s13, 3
    v_mfma_f32_16x16x32_bf16 v[244:247], a[212:215], a[224:227], v[244:247]
    s_and_b32 s17, s17, 3
    s_lshl_b32 s17, s17, 11
    v_mfma_f32_16x16x32_bf16 v[248:251], a[212:215], a[228:231], v[248:251]
    v_add_u32 v17, s17, v11
    s_mul_i32 s17, s12, 458752
    v_mfma_f32_16x16x32_bf16 v[252:255], a[212:215], a[232:235], v[252:255]
    v_add_u32 v18, s17, v11
    s_sub_u32 s17, 458752, s17
    v_mfma_f32_16x16x32_bf16 v[248:251], a[216:219], a[224:227], v[248:251]
    v_add_u32 v19, s17, v11
    s_add_u32 s20, s18, 29360128
    v_mfma_f32_16x16x32_bf16 v[252:255], a[216:219], a[228:231], v[252:255]
    s_addc_u32 s21, s19, 0
    s_mov_b32 s22, 7340032
    v_mfma_f32_16x16x32_bf16 v[252:255], a[220:223], a[224:227], v[252:255]
    s_mov_b32 s23, 0x00020000
    s_lshl_b32 s48, s15, 7
    s_waitcnt lgkmcnt(0)
    v_mfma_f32_16x16x32_bf16 v[224:227], a[128:131], a[160:163], v[224:227]
    ds_read_b128 a[224:227], v5 offset:3776
    v_mfma_f32_16x16x32_bf16 v[228:231], a[128:131], a[164:167], v[228:231]
    ds_read2_b32 a[192:193], v4 offset0:48 offset1:49
    v_mfma_f32_16x16x32_bf16 v[232:235], a[128:131], a[168:171], v[232:235]
    ds_read2_b32 a[194:195], v4 offset0:50 offset1:51
    v_mfma_f32_16x16x32_bf16 v[236:239], a[128:131], a[172:175], v[236:239]
    ds_read_b128 a[228:231], v5 offset:3264
    v_mfma_f32_16x16x32_bf16 v[240:243], a[128:131], a[176:179], v[240:243]
    ds_read2_b32 a[196:197], v4 offset0:176 offset1:177
    v_mfma_f32_16x16x32_bf16 v[244:247], a[128:131], a[180:183], v[244:247]
    ds_read2_b32 a[198:199], v4 offset0:178 offset1:179
    v_mfma_f32_16x16x32_bf16 v[248:251], a[128:131], a[184:187], v[248:251]
    ds_read_b128 a[232:235], v5 offset:2752
    v_mfma_f32_16x16x32_bf16 v[252:255], a[128:131], a[188:191], v[252:255]
    ds_read2_b32 a[200:201], v13 offset0:48 offset1:49
    v_mfma_f32_16x16x32_bf16 v[228:231], a[132:135], a[160:163], v[228:231]
    ds_read2_b32 a[202:203], v13 offset0:50 offset1:51
    v_mfma_f32_16x16x32_bf16 v[232:235], a[132:135], a[164:167], v[232:235]
    ds_read_b128 a[236:239], v5 offset:2240
    v_mfma_f32_16x16x32_bf16 v[236:239], a[132:135], a[168:171], v[236:239]
    ds_read2_b32 a[204:205], v13 offset0:176 offset1:177
    v_mfma_f32_16x16x32_bf16 v[240:243], a[132:135], a[172:175], v[240:243]
    ds_read2_b32 a[206:207], v13 offset0:178 offset1:179
    v_mfma_f32_16x16x32_bf16 v[244:247], a[132:135], a[176:179], v[244:247]
    ds_read_b128 a[240:243], v5 offset:1728
    v_mfma_f32_16x16x32_bf16 v[248:251], a[132:135], a[180:183], v[248:251]
    ds_read2_b32 a[208:209], v10 offset0:48 offset1:49
    v_mfma_f32_16x16x32_bf16 v[252:255], a[132:135], a[184:187], v[252:255]
    ds_read2_b32 a[210:211], v10 offset0:50 offset1:51
    v_mfma_f32_16x16x32_bf16 v[232:235], a[136:139], a[160:163], v[232:235]
    ds_read_b128 a[244:247], v5 offset:1216
    v_mfma_f32_16x16x32_bf16 v[236:239], a[136:139], a[164:167], v[236:239]
    ds_read2_b32 a[212:213], v10 offset0:176 offset1:177
    v_mfma_f32_16x16x32_bf16 v[240:243], a[136:139], a[168:171], v[240:243]
    ds_read2_b32 a[214:215], v10 offset0:178 offset1:179
    v_mfma_f32_16x16x32_bf16 v[244:247], a[136:139], a[172:175], v[244:247]
    ds_read_b128 a[248:251], v5 offset:704
    v_mfma_f32_16x16x32_bf16 v[248:251], a[136:139], a[176:179], v[248:251]
    ds_read2_b32 a[216:217], v9 offset0:48 offset1:49
    v_mfma_f32_16x16x32_bf16 v[252:255], a[136:139], a[180:183], v[252:255]
    ds_read2_b32 a[218:219], v9 offset0:50 offset1:51
    v_mfma_f32_16x16x32_bf16 v[236:239], a[140:143], a[160:163], v[236:239]
    ds_read_b128 a[252:255], v5 offset:192
    v_mfma_f32_16x16x32_bf16 v[240:243], a[140:143], a[164:167], v[240:243]
    ds_read2_b32 a[220:221], v9 offset0:176 offset1:177
    v_mfma_f32_16x16x32_bf16 v[244:247], a[140:143], a[168:171], v[244:247]
    ds_read2_b32 a[222:223], v9 offset0:178 offset1:179
    v_mfma_f32_16x16x32_bf16 v[248:251], a[140:143], a[172:175], v[248:251]
    s_lshl_b32 s49, s13, 5
    s_add_u32 s48, s48, s49
    v_mfma_f32_16x16x32_bf16 v[252:255], a[140:143], a[176:179], v[252:255]
    s_lshl_b32 s49, s16, 1
    s_add_u32 s49, s49, s12
    v_mfma_f32_16x16x32_bf16 v[240:243], a[144:147], a[160:163], v[240:243]
    s_lshl_b32 s50, s48, 11
    s_lshl_b32 s51, s49, 7
    v_mfma_f32_16x16x32_bf16 v[244:247], a[144:147], a[164:167], v[244:247]
    s_add_u32 s50, s50, s51
    s_add_u32 s51, s50, 32768
    v_mfma_f32_16x16x32_bf16 v[248:251], a[144:147], a[168:171], v[248:251]
    s_lshl_b32 s52, s48, 4
    v_and_b32 v30, 15, v1
    v_mfma_f32_16x16x32_bf16 v[252:255], a[144:147], a[172:175], v[252:255]
    v_lshrrev_b32 v28, 4, v1
    v_lshlrev_b32 v28, 3, v28
    v_mfma_f32_16x16x32_bf16 v[244:247], a[148:151], a[160:163], v[244:247]
    v_lshl_add_u32 v28, v30, 11, v28
    v_lshlrev_b32 v30, 4, v30
    v_mfma_f32_16x16x32_bf16 v[248:251], a[148:151], a[164:167], v[248:251]
    s_mov_b32 s60, s4
    s_mov_b32 s61, s5
    v_mfma_f32_16x16x32_bf16 v[252:255], a[148:151], a[168:171], v[252:255]
    s_mov_b32 s62, 4194304
    s_mov_b32 s63, 0x00020000
    v_mfma_f32_16x16x32_bf16 v[248:251], a[152:155], a[160:163], v[248:251]
    buffer_load_dwordx2 v[184:185], v28, s[60:63], s50 offen offset:0
    v_mfma_f32_16x16x32_bf16 v[252:255], a[152:155], a[164:167], v[252:255]
    buffer_load_dwordx2 v[186:187], v28, s[60:63], s50 offen offset:32
    v_mfma_f32_16x16x32_bf16 v[252:255], a[156:159], a[160:163], v[252:255]
    buffer_load_dwordx2 v[188:189], v28, s[60:63], s50 offen offset:64
    s_waitcnt lgkmcnt(0)
    v_mfma_f32_16x16x32_bf16 v[224:227], a[192:195], a[224:227], v[224:227]
    ds_read_b128 a[160:163], v5 offset:3840
    v_mfma_f32_16x16x32_bf16 v[228:231], a[192:195], a[228:231], v[228:231]
    ds_read2_b32 a[128:129], v4 offset0:64 offset1:65
    v_mfma_f32_16x16x32_bf16 v[232:235], a[192:195], a[232:235], v[232:235]
    ds_read2_b32 a[130:131], v4 offset0:66 offset1:67
    v_mfma_f32_16x16x32_bf16 v[236:239], a[192:195], a[236:239], v[236:239]
    ds_read_b128 a[164:167], v5 offset:3328
    v_mfma_f32_16x16x32_bf16 v[240:243], a[192:195], a[240:243], v[240:243]
    ds_read2_b32 a[132:133], v4 offset0:192 offset1:193
    v_mfma_f32_16x16x32_bf16 v[244:247], a[192:195], a[244:247], v[244:247]
    ds_read2_b32 a[134:135], v4 offset0:194 offset1:195
    v_mfma_f32_16x16x32_bf16 v[248:251], a[192:195], a[248:251], v[248:251]
    ds_read_b128 a[168:171], v5 offset:2816
    v_mfma_f32_16x16x32_bf16 v[252:255], a[192:195], a[252:255], v[252:255]
    ds_read2_b32 a[136:137], v13 offset0:64 offset1:65
    v_mfma_f32_16x16x32_bf16 v[228:231], a[196:199], a[224:227], v[228:231]
    ds_read2_b32 a[138:139], v13 offset0:66 offset1:67
    v_mfma_f32_16x16x32_bf16 v[232:235], a[196:199], a[228:231], v[232:235]
    ds_read_b128 a[172:175], v5 offset:2304
    v_mfma_f32_16x16x32_bf16 v[236:239], a[196:199], a[232:235], v[236:239]
    ds_read2_b32 a[140:141], v13 offset0:192 offset1:193
    v_mfma_f32_16x16x32_bf16 v[240:243], a[196:199], a[236:239], v[240:243]
    ds_read2_b32 a[142:143], v13 offset0:194 offset1:195
    v_mfma_f32_16x16x32_bf16 v[244:247], a[196:199], a[240:243], v[244:247]
    ds_read_b128 a[176:179], v5 offset:1792
    v_mfma_f32_16x16x32_bf16 v[248:251], a[196:199], a[244:247], v[248:251]
    ds_read2_b32 a[144:145], v10 offset0:64 offset1:65
    v_mfma_f32_16x16x32_bf16 v[252:255], a[196:199], a[248:251], v[252:255]
    ds_read2_b32 a[146:147], v10 offset0:66 offset1:67
    v_mfma_f32_16x16x32_bf16 v[232:235], a[200:203], a[224:227], v[232:235]
    ds_read_b128 a[180:183], v5 offset:1280
    v_mfma_f32_16x16x32_bf16 v[236:239], a[200:203], a[228:231], v[236:239]
    ds_read2_b32 a[148:149], v10 offset0:192 offset1:193
    v_mfma_f32_16x16x32_bf16 v[240:243], a[200:203], a[232:235], v[240:243]
    ds_read2_b32 a[150:151], v10 offset0:194 offset1:195
    v_mfma_f32_16x16x32_bf16 v[244:247], a[200:203], a[236:239], v[244:247]
    ds_read_b128 a[184:187], v5 offset:768
    v_mfma_f32_16x16x32_bf16 v[248:251], a[200:203], a[240:243], v[248:251]
    ds_read2_b32 a[152:153], v9 offset0:64 offset1:65
    v_mfma_f32_16x16x32_bf16 v[252:255], a[200:203], a[244:247], v[252:255]
    ds_read2_b32 a[154:155], v9 offset0:66 offset1:67
    v_mfma_f32_16x16x32_bf16 v[236:239], a[204:207], a[224:227], v[236:239]
    ds_read_b128 a[188:191], v5 offset:256
    v_mfma_f32_16x16x32_bf16 v[240:243], a[204:207], a[228:231], v[240:243]
    ds_read2_b32 a[156:157], v9 offset0:192 offset1:193
    v_mfma_f32_16x16x32_bf16 v[244:247], a[204:207], a[232:235], v[244:247]
    ds_read2_b32 a[158:159], v9 offset0:194 offset1:195
    v_mfma_f32_16x16x32_bf16 v[248:251], a[204:207], a[236:239], v[248:251]
    buffer_load_dwordx2 v[190:191], v28, s[60:63], s50 offen offset:96
    v_mfma_f32_16x16x32_bf16 v[252:255], a[204:207], a[240:243], v[252:255]
    buffer_load_dwordx2 v[192:193], v28, s[60:63], s51 offen offset:0
    v_mfma_f32_16x16x32_bf16 v[240:243], a[208:211], a[224:227], v[240:243]
    buffer_load_dwordx2 v[194:195], v28, s[60:63], s51 offen offset:32
    v_mfma_f32_16x16x32_bf16 v[244:247], a[208:211], a[228:231], v[244:247]
    buffer_load_dwordx2 v[196:197], v28, s[60:63], s51 offen offset:64
    v_mfma_f32_16x16x32_bf16 v[248:251], a[208:211], a[232:235], v[248:251]
    buffer_load_dwordx2 v[198:199], v28, s[60:63], s51 offen offset:96
    v_mfma_f32_16x16x32_bf16 v[252:255], a[208:211], a[236:239], v[252:255]
    v_mfma_f32_16x16x32_bf16 v[244:247], a[212:215], a[224:227], v[244:247]
    v_mfma_f32_16x16x32_bf16 v[248:251], a[212:215], a[228:231], v[248:251]
    v_mfma_f32_16x16x32_bf16 v[252:255], a[212:215], a[232:235], v[252:255]
    v_mfma_f32_16x16x32_bf16 v[248:251], a[216:219], a[224:227], v[248:251]
    v_mfma_f32_16x16x32_bf16 v[252:255], a[216:219], a[228:231], v[252:255]
    v_mfma_f32_16x16x32_bf16 v[252:255], a[220:223], a[224:227], v[252:255]
    s_waitcnt lgkmcnt(0)
    v_mfma_f32_16x16x32_bf16 v[224:227], a[128:131], a[160:163], v[224:227]
    ds_read_b128 a[224:227], v5 offset:3904
    v_mfma_f32_16x16x32_bf16 v[228:231], a[128:131], a[164:167], v[228:231]
    ds_read2_b32 a[192:193], v4 offset0:80 offset1:81
    v_mfma_f32_16x16x32_bf16 v[232:235], a[128:131], a[168:171], v[232:235]
    ds_read2_b32 a[194:195], v4 offset0:82 offset1:83
    v_mfma_f32_16x16x32_bf16 v[236:239], a[128:131], a[172:175], v[236:239]
    ds_read_b128 a[228:231], v5 offset:3392
    v_mfma_f32_16x16x32_bf16 v[240:243], a[128:131], a[176:179], v[240:243]
    ds_read2_b32 a[196:197], v4 offset0:208 offset1:209
    v_mfma_f32_16x16x32_bf16 v[244:247], a[128:131], a[180:183], v[244:247]
    ds_read2_b32 a[198:199], v4 offset0:210 offset1:211
    v_mfma_f32_16x16x32_bf16 v[248:251], a[128:131], a[184:187], v[248:251]
    ds_read_b128 a[232:235], v5 offset:2880
    v_mfma_f32_16x16x32_bf16 v[252:255], a[128:131], a[188:191], v[252:255]
    ds_read2_b32 a[200:201], v13 offset0:80 offset1:81
    v_mfma_f32_16x16x32_bf16 v[228:231], a[132:135], a[160:163], v[228:231]
    ds_read2_b32 a[202:203], v13 offset0:82 offset1:83
    v_mfma_f32_16x16x32_bf16 v[232:235], a[132:135], a[164:167], v[232:235]
    ds_read_b128 a[236:239], v5 offset:2368
    v_mfma_f32_16x16x32_bf16 v[236:239], a[132:135], a[168:171], v[236:239]
    ds_read2_b32 a[204:205], v13 offset0:208 offset1:209
    v_mfma_f32_16x16x32_bf16 v[240:243], a[132:135], a[172:175], v[240:243]
    ds_read2_b32 a[206:207], v13 offset0:210 offset1:211
    v_mfma_f32_16x16x32_bf16 v[244:247], a[132:135], a[176:179], v[244:247]
    ds_read_b128 a[240:243], v5 offset:1856
    v_mfma_f32_16x16x32_bf16 v[248:251], a[132:135], a[180:183], v[248:251]
    ds_read2_b32 a[208:209], v10 offset0:80 offset1:81
    v_mfma_f32_16x16x32_bf16 v[252:255], a[132:135], a[184:187], v[252:255]
    ds_read2_b32 a[210:211], v10 offset0:82 offset1:83
    v_mfma_f32_16x16x32_bf16 v[232:235], a[136:139], a[160:163], v[232:235]
    ds_read_b128 a[244:247], v5 offset:1344
    v_mfma_f32_16x16x32_bf16 v[236:239], a[136:139], a[164:167], v[236:239]
    ds_read2_b32 a[212:213], v10 offset0:208 offset1:209
    v_mfma_f32_16x16x32_bf16 v[240:243], a[136:139], a[168:171], v[240:243]
    ds_read2_b32 a[214:215], v10 offset0:210 offset1:211
    v_mfma_f32_16x16x32_bf16 v[244:247], a[136:139], a[172:175], v[244:247]
    ds_read_b128 a[248:251], v5 offset:832
    v_mfma_f32_16x16x32_bf16 v[248:251], a[136:139], a[176:179], v[248:251]
    ds_read2_b32 a[216:217], v9 offset0:80 offset1:81
    v_mfma_f32_16x16x32_bf16 v[252:255], a[136:139], a[180:183], v[252:255]
    ds_read2_b32 a[218:219], v9 offset0:82 offset1:83
    v_mfma_f32_16x16x32_bf16 v[236:239], a[140:143], a[160:163], v[236:239]
    ds_read_b128 a[252:255], v5 offset:320
    v_mfma_f32_16x16x32_bf16 v[240:243], a[140:143], a[164:167], v[240:243]
    ds_read2_b32 a[220:221], v9 offset0:208 offset1:209
    v_mfma_f32_16x16x32_bf16 v[244:247], a[140:143], a[168:171], v[244:247]
    ds_read2_b32 a[222:223], v9 offset0:210 offset1:211
    v_mfma_f32_16x16x32_bf16 v[248:251], a[140:143], a[172:175], v[248:251]
    v_mfma_f32_16x16x32_bf16 v[252:255], a[140:143], a[176:179], v[252:255]
    v_mfma_f32_16x16x32_bf16 v[240:243], a[144:147], a[160:163], v[240:243]
    v_mfma_f32_16x16x32_bf16 v[244:247], a[144:147], a[164:167], v[244:247]
    v_mfma_f32_16x16x32_bf16 v[248:251], a[144:147], a[168:171], v[248:251]
    v_mfma_f32_16x16x32_bf16 v[252:255], a[144:147], a[172:175], v[252:255]
    v_mfma_f32_16x16x32_bf16 v[244:247], a[148:151], a[160:163], v[244:247]
    v_mfma_f32_16x16x32_bf16 v[248:251], a[148:151], a[164:167], v[248:251]
    v_mfma_f32_16x16x32_bf16 v[252:255], a[148:151], a[168:171], v[252:255]
    v_mfma_f32_16x16x32_bf16 v[248:251], a[152:155], a[160:163], v[248:251]
    v_mfma_f32_16x16x32_bf16 v[252:255], a[152:155], a[164:167], v[252:255]
    v_mfma_f32_16x16x32_bf16 v[252:255], a[156:159], a[160:163], v[252:255]
    s_waitcnt lgkmcnt(0)
    v_mfma_f32_16x16x32_bf16 v[224:227], a[192:195], a[224:227], v[224:227]
    ds_read_b128 a[160:163], v5 offset:3968
    v_mfma_f32_16x16x32_bf16 v[228:231], a[192:195], a[228:231], v[228:231]
    ds_read2_b32 a[128:129], v4 offset0:96 offset1:97
    v_mfma_f32_16x16x32_bf16 v[232:235], a[192:195], a[232:235], v[232:235]
    ds_read2_b32 a[130:131], v4 offset0:98 offset1:99
    v_mfma_f32_16x16x32_bf16 v[236:239], a[192:195], a[236:239], v[236:239]
    ds_read_b128 a[164:167], v5 offset:3456
    v_mfma_f32_16x16x32_bf16 v[240:243], a[192:195], a[240:243], v[240:243]
    ds_read2_b32 a[132:133], v4 offset0:224 offset1:225
    v_mfma_f32_16x16x32_bf16 v[244:247], a[192:195], a[244:247], v[244:247]
    ds_read2_b32 a[134:135], v4 offset0:226 offset1:227
    v_mfma_f32_16x16x32_bf16 v[248:251], a[192:195], a[248:251], v[248:251]
    ds_read_b128 a[168:171], v5 offset:2944
    v_mfma_f32_16x16x32_bf16 v[252:255], a[192:195], a[252:255], v[252:255]
    ds_read2_b32 a[136:137], v13 offset0:96 offset1:97
    v_mfma_f32_16x16x32_bf16 v[228:231], a[196:199], a[224:227], v[228:231]
    ds_read2_b32 a[138:139], v13 offset0:98 offset1:99
    v_mfma_f32_16x16x32_bf16 v[232:235], a[196:199], a[228:231], v[232:235]
    ds_read_b128 a[172:175], v5 offset:2432
    v_mfma_f32_16x16x32_bf16 v[236:239], a[196:199], a[232:235], v[236:239]
    ds_read2_b32 a[140:141], v13 offset0:224 offset1:225
    v_mfma_f32_16x16x32_bf16 v[240:243], a[196:199], a[236:239], v[240:243]
    ds_read2_b32 a[142:143], v13 offset0:226 offset1:227
    v_mfma_f32_16x16x32_bf16 v[244:247], a[196:199], a[240:243], v[244:247]
    ds_read_b128 a[176:179], v5 offset:1920
    v_mfma_f32_16x16x32_bf16 v[248:251], a[196:199], a[244:247], v[248:251]
    ds_read2_b32 a[144:145], v10 offset0:96 offset1:97
    v_mfma_f32_16x16x32_bf16 v[252:255], a[196:199], a[248:251], v[252:255]
    ds_read2_b32 a[146:147], v10 offset0:98 offset1:99
    v_mfma_f32_16x16x32_bf16 v[232:235], a[200:203], a[224:227], v[232:235]
    ds_read_b128 a[180:183], v5 offset:1408
    v_mfma_f32_16x16x32_bf16 v[236:239], a[200:203], a[228:231], v[236:239]
    ds_read2_b32 a[148:149], v10 offset0:224 offset1:225
    v_mfma_f32_16x16x32_bf16 v[240:243], a[200:203], a[232:235], v[240:243]
    ds_read2_b32 a[150:151], v10 offset0:226 offset1:227
    v_mfma_f32_16x16x32_bf16 v[244:247], a[200:203], a[236:239], v[244:247]
    ds_read_b128 a[184:187], v5 offset:896
    v_mfma_f32_16x16x32_bf16 v[248:251], a[200:203], a[240:243], v[248:251]
    ds_read2_b32 a[152:153], v9 offset0:96 offset1:97
    v_mfma_f32_16x16x32_bf16 v[252:255], a[200:203], a[244:247], v[252:255]
    ds_read2_b32 a[154:155], v9 offset0:98 offset1:99
    v_mfma_f32_16x16x32_bf16 v[236:239], a[204:207], a[224:227], v[236:239]
    ds_read_b128 a[188:191], v5 offset:384
    v_mfma_f32_16x16x32_bf16 v[240:243], a[204:207], a[228:231], v[240:243]
    ds_read2_b32 a[156:157], v9 offset0:224 offset1:225
    v_mfma_f32_16x16x32_bf16 v[244:247], a[204:207], a[232:235], v[244:247]
    ds_read2_b32 a[158:159], v9 offset0:226 offset1:227
    v_mfma_f32_16x16x32_bf16 v[248:251], a[204:207], a[236:239], v[248:251]
    v_mfma_f32_16x16x32_bf16 v[252:255], a[204:207], a[240:243], v[252:255]
    v_mfma_f32_16x16x32_bf16 v[240:243], a[208:211], a[224:227], v[240:243]
    v_mfma_f32_16x16x32_bf16 v[244:247], a[208:211], a[228:231], v[244:247]
    v_mfma_f32_16x16x32_bf16 v[248:251], a[208:211], a[232:235], v[248:251]
    v_mfma_f32_16x16x32_bf16 v[252:255], a[208:211], a[236:239], v[252:255]
    v_mfma_f32_16x16x32_bf16 v[244:247], a[212:215], a[224:227], v[244:247]
    v_mfma_f32_16x16x32_bf16 v[248:251], a[212:215], a[228:231], v[248:251]
    v_mfma_f32_16x16x32_bf16 v[252:255], a[212:215], a[232:235], v[252:255]
    v_mfma_f32_16x16x32_bf16 v[248:251], a[216:219], a[224:227], v[248:251]
    v_mfma_f32_16x16x32_bf16 v[252:255], a[216:219], a[228:231], v[252:255]
    v_mfma_f32_16x16x32_bf16 v[252:255], a[220:223], a[224:227], v[252:255]
    s_lshr_b32 s47, s2, 3
    s_lshl_b32 s47, s47, 10
    s_lshl_b32 s3, s24, 20
    s_add_u32 s47, s47, s3
    buffer_load_dwordx4 v[24:27], v11, s[68:71], s47 offen sc1
    s_waitcnt lgkmcnt(0)
    v_mfma_f32_16x16x32_bf16 v[224:227], a[128:131], a[160:163], v[224:227]
    ds_read_b128 a[224:227], v5 offset:4032
    v_mfma_f32_16x16x32_bf16 v[228:231], a[128:131], a[164:167], v[228:231]
    ds_read2_b32 a[192:193], v4 offset0:112 offset1:113
    v_mfma_f32_16x16x32_bf16 v[232:235], a[128:131], a[168:171], v[232:235]
    ds_read2_b32 a[194:195], v4 offset0:114 offset1:115
    v_mfma_f32_16x16x32_bf16 v[236:239], a[128:131], a[172:175], v[236:239]
    ds_read_b128 a[228:231], v5 offset:3520
    v_mfma_f32_16x16x32_bf16 v[240:243], a[128:131], a[176:179], v[240:243]
    ds_read2_b32 a[196:197], v4 offset0:240 offset1:241
    v_mfma_f32_16x16x32_bf16 v[244:247], a[128:131], a[180:183], v[244:247]
    ds_read2_b32 a[198:199], v4 offset0:242 offset1:243
    v_mfma_f32_16x16x32_bf16 v[248:251], a[128:131], a[184:187], v[248:251]
    ds_read_b128 a[232:235], v5 offset:3008
    v_mfma_f32_16x16x32_bf16 v[252:255], a[128:131], a[188:191], v[252:255]
    ds_read2_b32 a[200:201], v13 offset0:112 offset1:113
    v_mfma_f32_16x16x32_bf16 v[228:231], a[132:135], a[160:163], v[228:231]
    ds_read2_b32 a[202:203], v13 offset0:114 offset1:115
    v_mfma_f32_16x16x32_bf16 v[232:235], a[132:135], a[164:167], v[232:235]
    ds_read_b128 a[236:239], v5 offset:2496
    v_mfma_f32_16x16x32_bf16 v[236:239], a[132:135], a[168:171], v[236:239]
    ds_read2_b32 a[204:205], v13 offset0:240 offset1:241
    v_mfma_f32_16x16x32_bf16 v[240:243], a[132:135], a[172:175], v[240:243]
    ds_read2_b32 a[206:207], v13 offset0:242 offset1:243
    v_mfma_f32_16x16x32_bf16 v[244:247], a[132:135], a[176:179], v[244:247]
    ds_read_b128 a[240:243], v5 offset:1984
    v_mfma_f32_16x16x32_bf16 v[248:251], a[132:135], a[180:183], v[248:251]
    ds_read2_b32 a[208:209], v10 offset0:112 offset1:113
    v_mfma_f32_16x16x32_bf16 v[252:255], a[132:135], a[184:187], v[252:255]
    ds_read2_b32 a[210:211], v10 offset0:114 offset1:115
    v_mfma_f32_16x16x32_bf16 v[232:235], a[136:139], a[160:163], v[232:235]
    ds_read_b128 a[244:247], v5 offset:1472
    v_mfma_f32_16x16x32_bf16 v[236:239], a[136:139], a[164:167], v[236:239]
    ds_read2_b32 a[212:213], v10 offset0:240 offset1:241
    v_mfma_f32_16x16x32_bf16 v[240:243], a[136:139], a[168:171], v[240:243]
    ds_read2_b32 a[214:215], v10 offset0:242 offset1:243
    v_mfma_f32_16x16x32_bf16 v[244:247], a[136:139], a[172:175], v[244:247]
    ds_read_b128 a[248:251], v5 offset:960
    v_mfma_f32_16x16x32_bf16 v[248:251], a[136:139], a[176:179], v[248:251]
    ds_read2_b32 a[216:217], v9 offset0:112 offset1:113
    v_mfma_f32_16x16x32_bf16 v[252:255], a[136:139], a[180:183], v[252:255]
    ds_read2_b32 a[218:219], v9 offset0:114 offset1:115
    v_mfma_f32_16x16x32_bf16 v[236:239], a[140:143], a[160:163], v[236:239]
    ds_read_b128 a[252:255], v5 offset:448
    v_mfma_f32_16x16x32_bf16 v[240:243], a[140:143], a[164:167], v[240:243]
    ds_read2_b32 a[220:221], v9 offset0:240 offset1:241
    v_mfma_f32_16x16x32_bf16 v[244:247], a[140:143], a[168:171], v[244:247]
    ds_read2_b32 a[222:223], v9 offset0:242 offset1:243
    v_mfma_f32_16x16x32_bf16 v[248:251], a[140:143], a[172:175], v[248:251]
    v_mfma_f32_16x16x32_bf16 v[252:255], a[140:143], a[176:179], v[252:255]
    v_mfma_f32_16x16x32_bf16 v[240:243], a[144:147], a[160:163], v[240:243]
    v_mfma_f32_16x16x32_bf16 v[244:247], a[144:147], a[164:167], v[244:247]
    v_mfma_f32_16x16x32_bf16 v[248:251], a[144:147], a[168:171], v[248:251]
    v_mfma_f32_16x16x32_bf16 v[252:255], a[144:147], a[172:175], v[252:255]
    v_mfma_f32_16x16x32_bf16 v[244:247], a[148:151], a[160:163], v[244:247]
    v_mfma_f32_16x16x32_bf16 v[248:251], a[148:151], a[164:167], v[248:251]
    v_mfma_f32_16x16x32_bf16 v[252:255], a[148:151], a[168:171], v[252:255]
    v_mfma_f32_16x16x32_bf16 v[248:251], a[152:155], a[160:163], v[248:251]
    v_mfma_f32_16x16x32_bf16 v[252:255], a[152:155], a[164:167], v[252:255]
    v_mfma_f32_16x16x32_bf16 v[252:255], a[156:159], a[160:163], v[252:255]
    s_waitcnt lgkmcnt(0)
    v_mfma_f32_16x16x32_bf16 v[224:227], a[192:195], a[224:227], v[224:227]
    v_mfma_f32_16x16x32_bf16 v[228:231], a[192:195], a[228:231], v[228:231]
    v_mfma_f32_16x16x32_bf16 v[232:235], a[192:195], a[232:235], v[232:235]
    v_mfma_f32_16x16x32_bf16 v[236:239], a[192:195], a[236:239], v[236:239]
    v_mfma_f32_16x16x32_bf16 v[240:243], a[192:195], a[240:243], v[240:243]
    v_mfma_f32_16x16x32_bf16 v[244:247], a[192:195], a[244:247], v[244:247]
    v_mfma_f32_16x16x32_bf16 v[248:251], a[192:195], a[248:251], v[248:251]
    v_mfma_f32_16x16x32_bf16 v[252:255], a[192:195], a[252:255], v[252:255]
    v_mfma_f32_16x16x32_bf16 v[228:231], a[196:199], a[224:227], v[228:231]
    v_mfma_f32_16x16x32_bf16 v[232:235], a[196:199], a[228:231], v[232:235]
    v_mfma_f32_16x16x32_bf16 v[236:239], a[196:199], a[232:235], v[236:239]
    v_mfma_f32_16x16x32_bf16 v[240:243], a[196:199], a[236:239], v[240:243]
    v_mfma_f32_16x16x32_bf16 v[244:247], a[196:199], a[240:243], v[244:247]
    v_mfma_f32_16x16x32_bf16 v[248:251], a[196:199], a[244:247], v[248:251]
    v_mfma_f32_16x16x32_bf16 v[252:255], a[196:199], a[248:251], v[252:255]
    v_mfma_f32_16x16x32_bf16 v[232:235], a[200:203], a[224:227], v[232:235]
    v_mfma_f32_16x16x32_bf16 v[236:239], a[200:203], a[228:231], v[236:239]
    v_mfma_f32_16x16x32_bf16 v[240:243], a[200:203], a[232:235], v[240:243]
    v_mfma_f32_16x16x32_bf16 v[244:247], a[200:203], a[236:239], v[244:247]
    v_mfma_f32_16x16x32_bf16 v[248:251], a[200:203], a[240:243], v[248:251]
    v_mfma_f32_16x16x32_bf16 v[252:255], a[200:203], a[244:247], v[252:255]
    v_mfma_f32_16x16x32_bf16 v[236:239], a[204:207], a[224:227], v[236:239]
    v_mfma_f32_16x16x32_bf16 v[240:243], a[204:207], a[228:231], v[240:243]
    v_mfma_f32_16x16x32_bf16 v[244:247], a[204:207], a[232:235], v[244:247]
    v_mfma_f32_16x16x32_bf16 v[248:251], a[204:207], a[236:239], v[248:251]
    v_mfma_f32_16x16x32_bf16 v[252:255], a[204:207], a[240:243], v[252:255]
    v_mfma_f32_16x16x32_bf16 v[240:243], a[208:211], a[224:227], v[240:243]
    v_mfma_f32_16x16x32_bf16 v[244:247], a[208:211], a[228:231], v[244:247]
    v_mfma_f32_16x16x32_bf16 v[248:251], a[208:211], a[232:235], v[248:251]
    v_mfma_f32_16x16x32_bf16 v[252:255], a[208:211], a[236:239], v[252:255]
    v_mfma_f32_16x16x32_bf16 v[244:247], a[212:215], a[224:227], v[244:247]
    v_mfma_f32_16x16x32_bf16 v[248:251], a[212:215], a[228:231], v[248:251]
    v_mfma_f32_16x16x32_bf16 v[252:255], a[212:215], a[232:235], v[252:255]
    v_mfma_f32_16x16x32_bf16 v[248:251], a[216:219], a[224:227], v[248:251]
    v_mfma_f32_16x16x32_bf16 v[252:255], a[216:219], a[228:231], v[252:255]
    v_mfma_f32_16x16x32_bf16 v[252:255], a[220:223], a[224:227], v[252:255]
    s_cmp_lg_u32 s24, 0
    s_cbranch_scc1 Lf_go
    s_mov_b32 s90, 0
    s_waitcnt vmcnt(0)
Lf_chk:
    v_xor_b32 v24, v24, v29
    v_xor_b32 v25, v25, v29
    v_xor_b32 v26, v26, v29
    v_xor_b32 v27, v27, v29
    v_or3_b32 v24, v24, v25, v26
    v_or_b32 v24, v24, v27
    v_cmp_ne_u32 vcc, 0, v24
    s_cbranch_vccnz Lf_spin
Lf_go:
    s_barrier
    buffer_load_dwordx4 a[32:35], v18, s[20:23], s45 offen offset:0
    buffer_load_dwordx4 a[36:39], v18, s[20:23], s45 offen offset:1024
    buffer_load_dwordx4 a[40:43], v18, s[20:23], s45 offen offset:2048
    buffer_load_dwordx4 a[44:47], v18, s[20:23], s45 offen offset:3072
    buffer_load_dwordx4 a[0:3], v14, s[92:95], s44 offen offset:0
    buffer_load_dwordx4 a[4:7], v14, s[92:95], s44 offen offset:1024
    buffer_load_dwordx4 a[8:11], v15, s[92:95], s44 offen offset:0
    buffer_load_dwordx4 a[12:15], v15, s[92:95], s44 offen offset:1024
    buffer_load_dwordx4 a[16:19], v16, s[92:95], s44 offen offset:0
    buffer_load_dwordx4 a[20:23], v16, s[92:95], s44 offen offset:1024
    buffer_load_dwordx4 a[24:27], v17, s[92:95], s44 offen offset:0
    buffer_load_dwordx4 a[28:31], v17, s[92:95], s44 offen offset:1024
    s_add_u32 s44, s44, 8192
    buffer_load_dwordx4 a[48:51], v19, s[20:23], s45 offen offset:0
    buffer_load_dwordx4 a[52:55], v19, s[20:23], s45 offen offset:1024
    buffer_load_dwordx4 a[56:59], v19, s[20:23], s45 offen offset:2048
    buffer_load_dwordx4 a[60:63], v19, s[20:23], s45 offen offset:3072
    s_add_u32 s45, s45, 4096
    buffer_load_dwordx4 v[200:203], v30, s[56:59], s52 offen offset:0
    buffer_load_dwordx4 v[204:207], v30, s[56:59], s52 offen offset:256
    ds_read_b64 v[160:161], v7 offset:3584
    ds_read_b64 v[162:163], v7 offset:3072
    ds_read_b64 v[164:165], v7 offset:2560
    ds_read_b64 v[166:167], v7 offset:2048
    ds_read_b64 v[168:169], v7 offset:1536
    ds_read_b64 v[170:171], v7 offset:1024
    ds_read_b64 v[172:173], v7 offset:512
    ds_read_b64 v[174:175], v7 offset:0
    s_waitcnt vmcnt(10)
    v_mfma_f32_16x16x32_bf16 v[32:35], a[32:35], a[0:3], 0
    buffer_load_dwordx4 a[96:99], v18, s[20:23], s45 offen offset:0
    v_mfma_f32_16x16x32_bf16 v[36:39], a[36:39], a[0:3], 0
    v_mfma_f32_16x16x32_bf16 v[40:43], a[40:43], a[0:3], 0
    buffer_load_dwordx4 a[100:103], v18, s[20:23], s45 offen offset:1024
    v_mfma_f32_16x16x32_bf16 v[44:47], a[44:47], a[0:3], 0
    s_waitcnt lgkmcnt(0)
    v_lshlrev_b32 v179, 16, v160
    v_mfma_f32_16x16x32_bf16 v[48:51], a[32:35], a[4:7], 0
    buffer_load_dwordx4 a[104:107], v18, s[20:23], s45 offen offset:2048
    v_and_b32 v178, 0xffff0000, v160
    v_lshlrev_b32 v177, 16, v161
    v_mfma_f32_16x16x32_bf16 v[52:55], a[36:39], a[4:7], 0
    v_and_b32 v176, 0xffff0000, v161
    v_fmac_f32 v224, v176, v8
    v_mfma_f32_16x16x32_bf16 v[56:59], a[40:43], a[4:7], 0
    buffer_load_dwordx4 a[108:111], v18, s[20:23], s45 offen offset:3072
    v_fmac_f32 v225, v177, v8
    v_fmac_f32 v226, v178, v8
    v_mfma_f32_16x16x32_bf16 v[60:63], a[44:47], a[4:7], 0
    v_fmac_f32 v227, v179, v8
    v_cvt_pk_bf16_f32 v224, v224, v225
    v_mfma_f32_16x16x32_bf16 v[64:67], a[32:35], a[8:11], 0
    buffer_load_dwordx4 a[64:67], v14, s[92:95], s44 offen offset:0
    v_cvt_pk_bf16_f32 v225, v226, v227
    v_lshlrev_b32 v179, 16, v162
    v_mfma_f32_16x16x32_bf16 v[68:71], a[36:39], a[8:11], 0
    v_and_b32 v178, 0xffff0000, v162
    v_lshlrev_b32 v177, 16, v163
    v_mfma_f32_16x16x32_bf16 v[72:75], a[40:43], a[8:11], 0
    buffer_load_dwordx4 a[68:71], v14, s[92:95], s44 offen offset:1024
    v_and_b32 v176, 0xffff0000, v163
    v_fmac_f32 v228, v176, v8
    v_mfma_f32_16x16x32_bf16 v[76:79], a[44:47], a[8:11], 0
    v_fmac_f32 v229, v177, v8
    v_fmac_f32 v230, v178, v8
    v_mfma_f32_16x16x32_bf16 v[80:83], a[32:35], a[12:15], 0
    buffer_load_dwordx4 a[72:75], v15, s[92:95], s44 offen offset:0
    v_fmac_f32 v231, v179, v8
    v_cvt_pk_bf16_f32 v226, v228, v229
    v_mfma_f32_16x16x32_bf16 v[84:87], a[36:39], a[12:15], 0
    v_cvt_pk_bf16_f32 v227, v230, v231
    s_nop 0
    v_mfma_f32_16x16x32_bf16 v[88:91], a[40:43], a[12:15], 0
    buffer_load_dwordx4 a[76:79], v15, s[92:95], s44 offen offset:1024
    v_permlane16_swap_b32 v224, v226
    v_permlane16_swap_b32 v225, v227
    v_mfma_f32_16x16x32_bf16 v[92:95], a[44:47], a[12:15], 0
    buffer_store_dwordx4 v[224:227], v6, s[64:67], s80 offen offset:0 sc1
    v_lshlrev_b32 v179, 16, v164
    s_waitcnt vmcnt(15)
    v_mfma_f32_16x16x32_bf16 v[96:99], a[32:35], a[16:19], 0
    buffer_load_dwordx4 a[80:83], v16, s[92:95], s44 offen offset:0
    v_and_b32 v178, 0xffff0000, v164
    v_lshlrev_b32 v177, 16, v165
    v_mfma_f32_16x16x32_bf16 v[100:103], a[36:39], a[16:19], 0
    v_and_b32 v176, 0xffff0000, v165
    v_fmac_f32 v232, v176, v8
    v_mfma_f32_16x16x32_bf16 v[104:107], a[40:43], a[16:19], 0
    buffer_load_dwordx4 a[84:87], v16, s[92:95], s44 offen offset:1024
    v_fmac_f32 v233, v177, v8
    v_fmac_f32 v234, v178, v8
    v_mfma_f32_16x16x32_bf16 v[108:111], a[44:47], a[16:19], 0
    v_fmac_f32 v235, v179, v8
    v_cvt_pk_bf16_f32 v232, v232, v233
    v_mfma_f32_16x16x32_bf16 v[112:115], a[32:35], a[20:23], 0
    v_cvt_pk_bf16_f32 v233, v234, v235
    v_lshlrev_b32 v179, 16, v166
    v_mfma_f32_16x16x32_bf16 v[116:119], a[36:39], a[20:23], 0
    buffer_load_dwordx4 a[88:91], v17, s[92:95], s44 offen offset:0
    v_and_b32 v178, 0xffff0000, v166
    v_lshlrev_b32 v177, 16, v167
    v_mfma_f32_16x16x32_bf16 v[120:123], a[40:43], a[20:23], 0
    v_and_b32 v176, 0xffff0000, v167
    v_fmac_f32 v236, v176, v8
    v_mfma_f32_16x16x32_bf16 v[124:127], a[44:47], a[20:23], 0
    v_fmac_f32 v237, v177, v8
    v_fmac_f32 v238, v178, v8
    v_mfma_f32_16x16x32_bf16 v[128:131], a[32:35], a[24:27], 0
    buffer_load_dwordx4 a[92:95], v17, s[92:95], s44 offen offset:1024
    s_add_u32 s44, s44, 8192
    v_fmac_f32 v239, v179, v8
    v_cvt_pk_bf16_f32 v234, v236, v237
    v_mfma_f32_16x16x32_bf16 v[132:135], a[36:39], a[24:27], 0
    v_cvt_pk_bf16_f32 v235, v238, v239
    s_nop 0
    v_mfma_f32_16x16x32_bf16 v[136:139], a[40:43], a[24:27], 0
    v_permlane16_swap_b32 v232, v234
    v_permlane16_swap_b32 v233, v235
    v_mfma_f32_16x16x32_bf16 v[140:143], a[44:47], a[24:27], 0
    buffer_load_dwordx4 a[112:115], v19, s[20:23], s45 offen offset:0
    buffer_store_dwordx4 v[232:235], v6, s[64:67], s80 offen offset:1024 sc1
    v_lshlrev_b32 v179, 16, v168
    v_mfma_f32_16x16x32_bf16 v[144:147], a[32:35], a[28:31], 0
    v_and_b32 v178, 0xffff0000, v168
    v_lshlrev_b32 v177, 16, v169
    v_mfma_f32_16x16x32_bf16 v[148:151], a[36:39], a[28:31], 0
    v_and_b32 v176, 0xffff0000, v169
    v_fmac_f32 v240, v176, v8
    v_mfma_f32_16x16x32_bf16 v[152:155], a[40:43], a[28:31], 0
    buffer_load_dwordx4 a[116:119], v19, s[20:23], s45 offen offset:1024
    v_fmac_f32 v241, v177, v8
    v_fmac_f32 v242, v178, v8
    v_mfma_f32_16x16x32_bf16 v[156:159], a[44:47], a[28:31], 0
    v_fmac_f32 v243, v179, v8
    v_cvt_pk_bf16_f32 v240, v240, v241
    s_waitcnt vmcnt(18)
    v_mfma_f32_16x16x32_bf16 a[192:195], a[48:51], a[16:19], 0
    v_cvt_pk_bf16_f32 v241, v242, v243
    v_lshlrev_b32 v179, 16, v170
    v_mfma_f32_16x16x32_bf16 a[196:199], a[52:55], a[16:19], 0
    buffer_load_dwordx4 a[120:123], v19, s[20:23], s45 offen offset:2048
    v_and_b32 v178, 0xffff0000, v170
    v_lshlrev_b32 v177, 16, v171
    v_mfma_f32_16x16x32_bf16 a[200:203], a[56:59], a[16:19], 0
    v_and_b32 v176, 0xffff0000, v171
    v_fmac_f32 v244, v176, v8
    v_mfma_f32_16x16x32_bf16 a[204:207], a[60:63], a[16:19], 0
    v_fmac_f32 v245, v177, v8
    v_fmac_f32 v246, v178, v8
    v_mfma_f32_16x16x32_bf16 a[208:211], a[48:51], a[20:23], 0
    buffer_load_dwordx4 a[124:127], v19, s[20:23], s45 offen offset:3072
    s_add_u32 s45, s45, 4096
    v_fmac_f32 v247, v179, v8
    v_cvt_pk_bf16_f32 v242, v244, v245
    v_mfma_f32_16x16x32_bf16 a[212:215], a[52:55], a[20:23], 0
    v_cvt_pk_bf16_f32 v243, v246, v247
    s_nop 0
    v_mfma_f32_16x16x32_bf16 a[216:219], a[56:59], a[20:23], 0
    v_permlane16_swap_b32 v240, v242
    v_permlane16_swap_b32 v241, v243
    v_mfma_f32_16x16x32_bf16 a[220:223], a[60:63], a[20:23], 0
    buffer_load_dwordx4 a[32:35], v18, s[20:23], s45 offen offset:0
    buffer_store_dwordx4 v[240:243], v6, s[64:67], s80 offen offset:2048 sc1
    v_lshlrev_b32 v179, 16, v172
    v_mfma_f32_16x16x32_bf16 a[224:227], a[48:51], a[24:27], 0
    v_and_b32 v178, 0xffff0000, v172
    v_lshlrev_b32 v177, 16, v173
    v_mfma_f32_16x16x32_bf16 a[228:231], a[52:55], a[24:27], 0
    v_and_b32 v176, 0xffff0000, v173
    v_fmac_f32 v248, v176, v8
    v_mfma_f32_16x16x32_bf16 a[232:235], a[56:59], a[24:27], 0
    buffer_load_dwordx4 a[36:39], v18, s[20:23], s45 offen offset:1024
    v_fmac_f32 v249, v177, v8
    v_fmac_f32 v250, v178, v8
    v_mfma_f32_16x16x32_bf16 a[236:239], a[60:63], a[24:27], 0
    v_fmac_f32 v251, v179, v8
    v_cvt_pk_bf16_f32 v248, v248, v249
    v_mfma_f32_16x16x32_bf16 a[240:243], a[48:51], a[28:31], 0
    v_cvt_pk_bf16_f32 v249, v250, v251
    v_lshlrev_b32 v179, 16, v174
    v_mfma_f32_16x16x32_bf16 a[244:247], a[52:55], a[28:31], 0
    buffer_load_dwordx4 a[40:43], v18, s[20:23], s45 offen offset:2048
    v_and_b32 v178, 0xffff0000, v174
    v_lshlrev_b32 v177, 16, v175
    v_mfma_f32_16x16x32_bf16 a[248:251], a[56:59], a[28:31], 0
    v_and_b32 v176, 0xffff0000, v175
    v_fmac_f32 v252, v176, v8
    v_mfma_f32_16x16x32_bf16 a[252:255], a[60:63], a[28:31], 0
    v_fmac_f32 v253, v177, v8
    v_fmac_f32 v254, v178, v8
    v_mfma_f32_16x16x32_bf16 a[128:131], a[48:51], a[0:3], 0
    buffer_load_dwordx4 a[44:47], v18, s[20:23], s45 offen offset:3072
    v_fmac_f32 v255, v179, v8
    v_cvt_pk_bf16_f32 v250, v252, v253
    v_mfma_f32_16x16x32_bf16 a[132:135], a[52:55], a[0:3], 0
    v_cvt_pk_bf16_f32 v251, v254, v255
    s_nop 0
    v_mfma_f32_16x16x32_bf16 a[136:139], a[56:59], a[0:3], 0
    v_permlane16_swap_b32 v248, v250
    v_permlane16_swap_b32 v249, v251
    v_mfma_f32_16x16x32_bf16 a[140:143], a[60:63], a[0:3], 0
    buffer_store_dwordx4 v[248:251], v6, s[64:67], s80 offen offset:3072 sc1
    s_mov_b32 s64, s18
    v_mfma_f32_16x16x32_bf16 a[144:147], a[48:51], a[4:7], 0
    buffer_load_dwordx4 a[0:3], v14, s[92:95], s44 offen offset:0
    s_mov_b32 s65, s19
    s_mov_b32 s66, 1048576
    v_mfma_f32_16x16x32_bf16 a[148:151], a[52:55], a[4:7], 0
    s_mov_b32 s67, 0x00020000
    s_mov_b32 s60, s4
    v_mfma_f32_16x16x32_bf16 a[152:155], a[56:59], a[4:7], 0
    s_mov_b32 s61, s5
    s_mov_b32 s62, 4194304
    v_mfma_f32_16x16x32_bf16 a[156:159], a[60:63], a[4:7], 0
    s_mov_b32 s63, 0x00020000
    s_add_u32 s36, s18, 8388608
    v_mfma_f32_16x16x32_bf16 a[160:163], a[48:51], a[8:11], 0
    buffer_load_dwordx4 a[4:7], v14, s[92:95], s44 offen offset:1024
    s_addc_u32 s37, s19, 0
    s_mov_b32 s38, 4194304
    v_mfma_f32_16x16x32_bf16 a[164:167], a[52:55], a[8:11], 0
    s_mov_b32 s39, 0x00020000
    s_mov_b32 s40, s10
    v_mfma_f32_16x16x32_bf16 a[168:171], a[56:59], a[8:11], 0
    s_mov_b32 s41, s11
    s_mov_b32 s42, 4194304
    v_mfma_f32_16x16x32_bf16 a[172:175], a[60:63], a[8:11], 0
    s_mov_b32 s43, 0x00020000
    s_add_u32 s28, s18, 41943040
    v_mfma_f32_16x16x32_bf16 a[176:179], a[48:51], a[12:15], 0
    buffer_load_dwordx4 a[8:11], v15, s[92:95], s44 offen offset:0
    s_addc_u32 s29, s19, 0
    s_mov_b32 s30, 8388608
    v_mfma_f32_16x16x32_bf16 a[180:183], a[52:55], a[12:15], 0
    s_mov_b32 s31, 0x00020000
    v_and_b32 v26, 15, v1
    v_mfma_f32_16x16x32_bf16 a[184:187], a[56:59], a[12:15], 0
    v_lshrrev_b32 v13, 4, v1
    s_lshl_b32 s48, s15, 7
    v_mfma_f32_16x16x32_bf16 a[188:191], a[60:63], a[12:15], 0
    s_lshl_b32 s49, s13, 5
    s_add_u32 s48, s48, s49
    s_waitcnt vmcnt(19)
    v_mfma_f32_16x16x32_bf16 v[32:35], a[96:99], a[64:67], v[32:35]
    buffer_load_dwordx4 a[12:15], v15, s[92:95], s44 offen offset:1024
    s_lshl_b32 s49, s16, 1
    s_add_u32 s49, s49, s12
    v_mfma_f32_16x16x32_bf16 v[36:39], a[100:103], a[64:67], v[36:39]
    s_lshl_b32 s49, s49, 6
    v_lshlrev_b32 v9, 11, v26
    v_mfma_f32_16x16x32_bf16 v[40:43], a[104:107], a[64:67], v[40:43]
    buffer_load_dwordx4 a[16:19], v16, s[92:95], s44 offen offset:0
    v_lshl_add_u32 v8, v13, 3, v9
    s_lshl_b32 s50, s48, 11
    v_mfma_f32_16x16x32_bf16 v[44:47], a[108:111], a[64:67], v[44:47]
    s_lshl_b32 s51, s49, 1
    s_add_u32 s50, s50, s51
    v_mfma_f32_16x16x32_bf16 v[48:51], a[96:99], a[68:71], v[48:51]
    buffer_load_dwordx4 a[20:23], v16, s[92:95], s44 offen offset:1024
    s_add_u32 s51, s50, 32768
    v_lshlrev_b32 v4, 4, v26
    v_mfma_f32_16x16x32_bf16 v[52:55], a[100:103], a[68:71], v[52:55]
    s_lshl_b32 s52, s48, 4
    v_lshrrev_b32 v6, 2, v1
    v_mfma_f32_16x16x32_bf16 v[56:59], a[104:107], a[68:71], v[56:59]
    v_lshlrev_b32 v5, 12, v6
    v_and_b32 v7, 3, v1
    v_mfma_f32_16x16x32_bf16 v[60:63], a[108:111], a[68:71], v[60:63]
    buffer_load_dwordx4 a[24:27], v17, s[92:95], s44 offen offset:0
    v_lshl_add_u32 v5, v7, 4, v5
    v_lshlrev_b32 v7, 3, v7
    v_mfma_f32_16x16x32_bf16 v[64:67], a[96:99], a[72:75], v[64:67]
    v_lshl_add_u32 v7, v6, 6, v7
    s_lshl_b32 s46, s13, 12
    v_mfma_f32_16x16x32_bf16 v[68:71], a[100:103], a[72:75], v[68:71]
    s_add_u32 s46, s46, 131072
    v_add_u32 v7, s46, v7
    v_mfma_f32_16x16x32_bf16 v[72:75], a[104:107], a[72:75], v[72:75]
    buffer_load_dwordx4 a[28:31], v17, s[92:95], s44 offen offset:1024
    s_add_u32 s44, s44, 8192
    s_lshl_b32 s54, s49, 12
    s_lshl_b32 s55, s48, 1
    v_mfma_f32_16x16x32_bf16 v[76:79], a[108:111], a[72:75], v[76:79]
    s_add_u32 s54, s54, s55
    v_and_b32 v6, 1, v13
    v_mfma_f32_16x16x32_bf16 v[80:83], a[96:99], a[76:79], v[80:83]
    v_lshl_add_u32 v3, v6, 5, v9
    v_lshrrev_b32 v12, 5, v1
    v_mfma_f32_16x16x32_bf16 v[84:87], a[100:103], a[76:79], v[84:87]
    buffer_load_dwordx4 a[48:51], v19, s[20:23], s45 offen offset:0
    v_lshl_add_u32 v3, v12, 4, v3
    s_lshl_b32 s56, s2, 2
    v_mfma_f32_16x16x32_bf16 v[88:91], a[104:107], a[76:79], v[88:91]
    s_add_u32 s56, s56, s13
    s_xor_b32 s57, s56, 4
    v_mfma_f32_16x16x32_bf16 v[92:95], a[108:111], a[76:79], v[92:95]
    s_lshl_b32 s58, s49, 2
    s_add_u32 s58, s58, 544768
    s_waitcnt vmcnt(20)
    v_mfma_f32_16x16x32_bf16 v[96:99], a[96:99], a[80:83], v[96:99]
    buffer_load_dwordx4 a[52:55], v19, s[20:23], s45 offen offset:1024
    s_lshl_b32 s59, s56, 2
    s_add_u32 s59, s59, 544768
    v_mfma_f32_16x16x32_bf16 v[100:103], a[100:103], a[80:83], v[100:103]
    v_lshlrev_b32 v25, 2, v1
    v_lshlrev_b32 v27, 25, v1
    v_mfma_f32_16x16x32_bf16 v[104:107], a[104:107], a[80:83], v[104:107]
    s_lshl_b32 s56, s56, 13
    s_lshl_b32 s57, s57, 13
    v_mfma_f32_16x16x32_bf16 v[108:111], a[108:111], a[80:83], v[108:111]
    buffer_load_dwordx4 a[56:59], v19, s[20:23], s45 offen offset:2048
    v_add_u32 v10, 4096, v11
    v_mov_b32 v12, 0
    v_mfma_f32_16x16x32_bf16 v[112:115], a[96:99], a[84:87], v[112:115]
    s_add_u32 s17, s13, 1
    s_and_b32 s17, s17, 3
    v_mfma_f32_16x16x32_bf16 v[116:119], a[100:103], a[84:87], v[116:119]
    s_mul_i32 s17, s17, 24576
    v_add_u32 v21, s17, v11
    v_mfma_f32_16x16x32_bf16 v[120:123], a[104:107], a[84:87], v[120:123]
    buffer_load_dwordx4 a[60:63], v19, s[20:23], s45 offen offset:3072
    s_add_u32 s45, s45, 4096
    s_add_u32 s17, s13, 2
    s_and_b32 s17, s17, 3
    v_mfma_f32_16x16x32_bf16 v[124:127], a[108:111], a[84:87], v[124:127]
    s_mul_i32 s17, s17, 24576
    v_add_u32 v22, s17, v11
    v_mfma_f32_16x16x32_bf16 v[128:131], a[96:99], a[88:91], v[128:131]
    s_add_u32 s17, s13, 3
    s_and_b32 s17, s17, 3
    v_mfma_f32_16x16x32_bf16 v[132:135], a[100:103], a[88:91], v[132:135]
    s_mul_i32 s17, s17, 24576
    v_add_u32 v23, s17, v11
    v_mfma_f32_16x16x32_bf16 v[136:139], a[104:107], a[88:91], v[136:139]
    s_mul_i32 s17, s13, 24576
    v_add_u32 v20, s17, v11
    v_mfma_f32_16x16x32_bf16 v[140:143], a[108:111], a[88:91], v[140:143]
    v_mfma_f32_16x16x32_bf16 v[144:147], a[96:99], a[92:95], v[144:147]
    v_mfma_f32_16x16x32_bf16 v[148:151], a[100:103], a[92:95], v[148:151]
    v_mfma_f32_16x16x32_bf16 v[152:155], a[104:107], a[92:95], v[152:155]
    v_mfma_f32_16x16x32_bf16 v[156:159], a[108:111], a[92:95], v[156:159]
    s_waitcnt vmcnt(18)
    v_mfma_f32_16x16x32_bf16 a[192:195], a[112:115], a[80:83], a[192:195]
    buffer_load_dwordx4 a[96:99], v18, s[20:23], s45 offen offset:0
    v_mfma_f32_16x16x32_bf16 a[196:199], a[116:119], a[80:83], a[196:199]
    v_mfma_f32_16x16x32_bf16 a[200:203], a[120:123], a[80:83], a[200:203]
    v_mfma_f32_16x16x32_bf16 a[204:207], a[124:127], a[80:83], a[204:207]
    buffer_load_dwordx4 a[100:103], v18, s[20:23], s45 offen offset:1024
    v_mfma_f32_16x16x32_bf16 a[208:211], a[112:115], a[84:87], a[208:211]
    v_mfma_f32_16x16x32_bf16 a[212:215], a[116:119], a[84:87], a[212:215]
    v_mfma_f32_16x16x32_bf16 a[216:219], a[120:123], a[84:87], a[216:219]
    buffer_load_dwordx4 a[104:107], v18, s[20:23], s45 offen offset:2048
    v_mfma_f32_16x16x32_bf16 a[220:223], a[124:127], a[84:87], a[220:223]
    v_mfma_f32_16x16x32_bf16 a[224:227], a[112:115], a[88:91], a[224:227]
    v_mfma_f32_16x16x32_bf16 a[228:231], a[116:119], a[88:91], a[228:231]
    buffer_load_dwordx4 a[108:111], v18, s[20:23], s45 offen offset:3072
    v_mfma_f32_16x16x32_bf16 a[232:235], a[120:123], a[88:91], a[232:235]
    v_mfma_f32_16x16x32_bf16 a[236:239], a[124:127], a[88:91], a[236:239]
    v_mfma_f32_16x16x32_bf16 a[240:243], a[112:115], a[92:95], a[240:243]
    v_mfma_f32_16x16x32_bf16 a[244:247], a[116:119], a[92:95], a[244:247]
    v_mfma_f32_16x16x32_bf16 a[248:251], a[120:123], a[92:95], a[248:251]
    v_mfma_f32_16x16x32_bf16 a[252:255], a[124:127], a[92:95], a[252:255]
    v_mfma_f32_16x16x32_bf16 a[128:131], a[112:115], a[64:67], a[128:131]
    v_mfma_f32_16x16x32_bf16 a[132:135], a[116:119], a[64:67], a[132:135]
    v_mfma_f32_16x16x32_bf16 a[136:139], a[120:123], a[64:67], a[136:139]
    v_mfma_f32_16x16x32_bf16 a[140:143], a[124:127], a[64:67], a[140:143]
    v_mfma_f32_16x16x32_bf16 a[144:147], a[112:115], a[68:71], a[144:147]
    buffer_load_dwordx4 a[64:67], v14, s[92:95], s44 offen offset:0
    v_mfma_f32_16x16x32_bf16 a[148:151], a[116:119], a[68:71], a[148:151]
    v_mfma_f32_16x16x32_bf16 a[152:155], a[120:123], a[68:71], a[152:155]
    v_mfma_f32_16x16x32_bf16 a[156:159], a[124:127], a[68:71], a[156:159]
    v_mfma_f32_16x16x32_bf16 a[160:163], a[112:115], a[72:75], a[160:163]
    buffer_load_dwordx4 a[68:71], v14, s[92:95], s44 offen offset:1024
    v_mfma_f32_16x16x32_bf16 a[164:167], a[116:119], a[72:75], a[164:167]
    v_mfma_f32_16x16x32_bf16 a[168:171], a[120:123], a[72:75], a[168:171]
    v_mfma_f32_16x16x32_bf16 a[172:175], a[124:127], a[72:75], a[172:175]
    v_mfma_f32_16x16x32_bf16 a[176:179], a[112:115], a[76:79], a[176:179]
    buffer_load_dwordx4 a[72:75], v15, s[92:95], s44 offen offset:0
    v_mfma_f32_16x16x32_bf16 a[180:183], a[116:119], a[76:79], a[180:183]
    v_mfma_f32_16x16x32_bf16 a[184:187], a[120:123], a[76:79], a[184:187]
    v_mfma_f32_16x16x32_bf16 a[188:191], a[124:127], a[76:79], a[188:191]
    s_waitcnt vmcnt(15)
    v_mfma_f32_16x16x32_bf16 v[32:35], a[32:35], a[0:3], v[32:35]
    buffer_load_dwordx4 a[76:79], v15, s[92:95], s44 offen offset:1024
    v_mfma_f32_16x16x32_bf16 v[36:39], a[36:39], a[0:3], v[36:39]
    v_mfma_f32_16x16x32_bf16 v[40:43], a[40:43], a[0:3], v[40:43]
    buffer_load_dwordx4 a[80:83], v16, s[92:95], s44 offen offset:0
    v_mfma_f32_16x16x32_bf16 v[44:47], a[44:47], a[0:3], v[44:47]
    v_mfma_f32_16x16x32_bf16 v[48:51], a[32:35], a[4:7], v[48:51]
    buffer_load_dwordx4 a[84:87], v16, s[92:95], s44 offen offset:1024
    v_mfma_f32_16x16x32_bf16 v[52:55], a[36:39], a[4:7], v[52:55]
    v_mfma_f32_16x16x32_bf16 v[56:59], a[40:43], a[4:7], v[56:59]
    v_mfma_f32_16x16x32_bf16 v[60:63], a[44:47], a[4:7], v[60:63]
    buffer_load_dwordx4 a[88:91], v17, s[92:95], s44 offen offset:0
    v_mfma_f32_16x16x32_bf16 v[64:67], a[32:35], a[8:11], v[64:67]
    v_mfma_f32_16x16x32_bf16 v[68:71], a[36:39], a[8:11], v[68:71]
    v_mfma_f32_16x16x32_bf16 v[72:75], a[40:43], a[8:11], v[72:75]
    buffer_load_dwordx4 a[92:95], v17, s[92:95], s44 offen offset:1024
    s_add_u32 s44, s44, 8192
    v_mfma_f32_16x16x32_bf16 v[76:79], a[44:47], a[8:11], v[76:79]
    v_mfma_f32_16x16x32_bf16 v[80:83], a[32:35], a[12:15], v[80:83]
    v_mfma_f32_16x16x32_bf16 v[84:87], a[36:39], a[12:15], v[84:87]
    buffer_load_dwordx4 a[112:115], v19, s[20:23], s45 offen offset:0
    v_mfma_f32_16x16x32_bf16 v[88:91], a[40:43], a[12:15], v[88:91]
    v_mfma_f32_16x16x32_bf16 v[92:95], a[44:47], a[12:15], v[92:95]
    s_waitcnt vmcnt(17)
    v_mfma_f32_16x16x32_bf16 v[96:99], a[32:35], a[16:19], v[96:99]
    buffer_load_dwordx4 a[116:119], v19, s[20:23], s45 offen offset:1024
    v_mfma_f32_16x16x32_bf16 v[100:103], a[36:39], a[16:19], v[100:103]
    v_mfma_f32_16x16x32_bf16 v[104:107], a[40:43], a[16:19], v[104:107]
    v_mfma_f32_16x16x32_bf16 v[108:111], a[44:47], a[16:19], v[108:111]
    buffer_load_dwordx4 a[120:123], v19, s[20:23], s45 offen offset:2048
    v_mfma_f32_16x16x32_bf16 v[112:115], a[32:35], a[20:23], v[112:115]
    v_mfma_f32_16x16x32_bf16 v[116:119], a[36:39], a[20:23], v[116:119]
    v_mfma_f32_16x16x32_bf16 v[120:123], a[40:43], a[20:23], v[120:123]
    buffer_load_dwordx4 a[124:127], v19, s[20:23], s45 offen offset:3072
    s_add_u32 s45, s45, 4096
    v_mfma_f32_16x16x32_bf16 v[124:127], a[44:47], a[20:23], v[124:127]
    v_mfma_f32_16x16x32_bf16 v[128:131], a[32:35], a[24:27], v[128:131]
    v_mfma_f32_16x16x32_bf16 v[132:135], a[36:39], a[24:27], v[132:135]
    v_mfma_f32_16x16x32_bf16 v[136:139], a[40:43], a[24:27], v[136:139]
    v_mfma_f32_16x16x32_bf16 v[140:143], a[44:47], a[24:27], v[140:143]
    v_mfma_f32_16x16x32_bf16 v[144:147], a[32:35], a[28:31], v[144:147]
    v_mfma_f32_16x16x32_bf16 v[148:151], a[36:39], a[28:31], v[148:151]
    v_mfma_f32_16x16x32_bf16 v[152:155], a[40:43], a[28:31], v[152:155]
    v_mfma_f32_16x16x32_bf16 v[156:159], a[44:47], a[28:31], v[156:159]
    s_waitcnt vmcnt(16)
    v_mfma_f32_16x16x32_bf16 a[192:195], a[48:51], a[16:19], a[192:195]
    buffer_load_dwordx4 a[32:35], v18, s[20:23], s45 offen offset:0
    v_mfma_f32_16x16x32_bf16 a[196:199], a[52:55], a[16:19], a[196:199]
    v_mfma_f32_16x16x32_bf16 a[200:203], a[56:59], a[16:19], a[200:203]
    v_mfma_f32_16x16x32_bf16 a[204:207], a[60:63], a[16:19], a[204:207]
    buffer_load_dwordx4 a[36:39], v18, s[20:23], s45 offen offset:1024
    v_mfma_f32_16x16x32_bf16 a[208:211], a[48:51], a[20:23], a[208:211]
    v_mfma_f32_16x16x32_bf16 a[212:215], a[52:55], a[20:23], a[212:215]
    v_mfma_f32_16x16x32_bf16 a[216:219], a[56:59], a[20:23], a[216:219]
    buffer_load_dwordx4 a[40:43], v18, s[20:23], s45 offen offset:2048
    v_mfma_f32_16x16x32_bf16 a[220:223], a[60:63], a[20:23], a[220:223]
    v_mfma_f32_16x16x32_bf16 a[224:227], a[48:51], a[24:27], a[224:227]
    v_mfma_f32_16x16x32_bf16 a[228:231], a[52:55], a[24:27], a[228:231]
    buffer_load_dwordx4 a[44:47], v18, s[20:23], s45 offen offset:3072
    v_mfma_f32_16x16x32_bf16 a[232:235], a[56:59], a[24:27], a[232:235]
    v_mfma_f32_16x16x32_bf16 a[236:239], a[60:63], a[24:27], a[236:239]
    v_mfma_f32_16x16x32_bf16 a[240:243], a[48:51], a[28:31], a[240:243]
    v_mfma_f32_16x16x32_bf16 a[244:247], a[52:55], a[28:31], a[244:247]
    v_mfma_f32_16x16x32_bf16 a[248:251], a[56:59], a[28:31], a[248:251]
    v_mfma_f32_16x16x32_bf16 a[252:255], a[60:63], a[28:31], a[252:255]
    v_mfma_f32_16x16x32_bf16 a[128:131], a[48:51], a[0:3], a[128:131]
    v_mfma_f32_16x16x32_bf16 a[132:135], a[52:55], a[0:3], a[132:135]
    v_mfma_f32_16x16x32_bf16 a[136:139], a[56:59], a[0:3], a[136:139]
    v_mfma_f32_16x16x32_bf16 a[140:143], a[60:63], a[0:3], a[140:143]
    v_mfma_f32_16x16x32_bf16 a[144:147], a[48:51], a[4:7], a[144:147]
    buffer_load_dwordx4 a[0:3], v14, s[92:95], s44 offen offset:0
    v_mfma_f32_16x16x32_bf16 a[148:151], a[52:55], a[4:7], a[148:151]
    v_mfma_f32_16x16x32_bf16 a[152:155], a[56:59], a[4:7], a[152:155]
    v_mfma_f32_16x16x32_bf16 a[156:159], a[60:63], a[4:7], a[156:159]
    v_mfma_f32_16x16x32_bf16 a[160:163], a[48:51], a[8:11], a[160:163]
    buffer_load_dwordx4 a[4:7], v14, s[92:95], s44 offen offset:1024
    v_mfma_f32_16x16x32_bf16 a[164:167], a[52:55], a[8:11], a[164:167]
    v_mfma_f32_16x16x32_bf16 a[168:171], a[56:59], a[8:11], a[168:171]
    v_mfma_f32_16x16x32_bf16 a[172:175], a[60:63], a[8:11], a[172:175]
    v_mfma_f32_16x16x32_bf16 a[176:179], a[48:51], a[12:15], a[176:179]
    buffer_load_dwordx4 a[8:11], v15, s[92:95], s44 offen offset:0
    v_mfma_f32_16x16x32_bf16 a[180:183], a[52:55], a[12:15], a[180:183]
    v_mfma_f32_16x16x32_bf16 a[184:187], a[56:59], a[12:15], a[184:187]
    v_mfma_f32_16x16x32_bf16 a[188:191], a[60:63], a[12:15], a[188:191]
    s_waitcnt vmcnt(15)
    v_mfma_f32_16x16x32_bf16 v[32:35], a[96:99], a[64:67], v[32:35]
    buffer_store_dword v29, v27, s[64:67], s59 offen sc1
    v_mfma_f32_16x16x32_bf16 v[36:39], a[100:103], a[64:67], v[36:39]
    v_mfma_f32_16x16x32_bf16 v[40:43], a[104:107], a[64:67], v[40:43]
    buffer_load_dwordx4 a[12:15], v15, s[92:95], s44 offen offset:1024
    v_mfma_f32_16x16x32_bf16 v[44:47], a[108:111], a[64:67], v[44:47]
    v_mfma_f32_16x16x32_bf16 v[48:51], a[96:99], a[68:71], v[48:51]
    buffer_load_dwordx4 a[16:19], v16, s[92:95], s44 offen offset:0
    v_mfma_f32_16x16x32_bf16 v[52:55], a[100:103], a[68:71], v[52:55]
    v_mfma_f32_16x16x32_bf16 v[56:59], a[104:107], a[68:71], v[56:59]
    buffer_load_dwordx4 a[20:23], v16, s[92:95], s44 offen offset:1024
    v_mfma_f32_16x16x32_bf16 v[60:63], a[108:111], a[68:71], v[60:63]
    v_mfma_f32_16x16x32_bf16 v[64:67], a[96:99], a[72:75], v[64:67]
    v_mfma_f32_16x16x32_bf16 v[68:71], a[100:103], a[72:75], v[68:71]
    buffer_load_dwordx4 a[24:27], v17, s[92:95], s44 offen offset:0
    v_mfma_f32_16x16x32_bf16 v[72:75], a[104:107], a[72:75], v[72:75]
    v_mfma_f32_16x16x32_bf16 v[76:79], a[108:111], a[72:75], v[76:79]
    v_mfma_f32_16x16x32_bf16 v[80:83], a[96:99], a[76:79], v[80:83]
    buffer_load_dwordx4 a[28:31], v17, s[92:95], s44 offen offset:1024
    s_add_u32 s44, s44, 8192
    v_mfma_f32_16x16x32_bf16 v[84:87], a[100:103], a[76:79], v[84:87]
    v_mfma_f32_16x16x32_bf16 v[88:91], a[104:107], a[76:79], v[88:91]
    v_mfma_f32_16x16x32_bf16 v[92:95], a[108:111], a[76:79], v[92:95]
    buffer_load_dwordx4 a[48:51], v19, s[20:23], s45 offen offset:0
    s_waitcnt vmcnt(18)
    v_mfma_f32_16x16x32_bf16 v[96:99], a[96:99], a[80:83], v[96:99]
    v_mfma_f32_16x16x32_bf16 v[100:103], a[100:103], a[80:83], v[100:103]
    v_mfma_f32_16x16x32_bf16 v[104:107], a[104:107], a[80:83], v[104:107]
    buffer_load_dwordx4 a[52:55], v19, s[20:23], s45 offen offset:1024
    v_mfma_f32_16x16x32_bf16 v[108:111], a[108:111], a[80:83], v[108:111]
    v_mfma_f32_16x16x32_bf16 v[112:115], a[96:99], a[84:87], v[112:115]
    v_mfma_f32_16x16x32_bf16 v[116:119], a[100:103], a[84:87], v[116:119]
    buffer_load_dwordx4 a[56:59], v19, s[20:23], s45 offen offset:2048
    v_mfma_f32_16x16x32_bf16 v[120:123], a[104:107], a[84:87], v[120:123]
    v_mfma_f32_16x16x32_bf16 v[124:127], a[108:111], a[84:87], v[124:127]
    v_mfma_f32_16x16x32_bf16 v[128:131], a[96:99], a[88:91], v[128:131]
    buffer_load_dwordx4 a[60:63], v19, s[20:23], s45 offen offset:3072
    s_add_u32 s45, s45, 4096
    v_mfma_f32_16x16x32_bf16 v[132:135], a[100:103], a[88:91], v[132:135]
    v_mfma_f32_16x16x32_bf16 v[136:139], a[104:107], a[88:91], v[136:139]
    v_mfma_f32_16x16x32_bf16 v[140:143], a[108:111], a[88:91], v[140:143]
    v_mfma_f32_16x16x32_bf16 v[144:147], a[96:99], a[92:95], v[144:147]
    v_mfma_f32_16x16x32_bf16 v[148:151], a[100:103], a[92:95], v[148:151]
    v_mfma_f32_16x16x32_bf16 v[152:155], a[104:107], a[92:95], v[152:155]
    v_mfma_f32_16x16x32_bf16 v[156:159], a[108:111], a[92:95], v[156:159]
    s_waitcnt vmcnt(17)
    v_mfma_f32_16x16x32_bf16 a[192:195], a[112:115], a[80:83], a[192:195]
    buffer_load_dwordx4 a[96:99], v18, s[20:23], s45 offen offset:0
    v_mfma_f32_16x16x32_bf16 a[196:199], a[116:119], a[80:83], a[196:199]
    v_mfma_f32_16x16x32_bf16 a[200:203], a[120:123], a[80:83], a[200:203]
    v_mfma_f32_16x16x32_bf16 a[204:207], a[124:127], a[80:83], a[204:207]
    buffer_load_dwordx4 a[100:103], v18, s[20:23], s45 offen offset:1024
    v_mfma_f32_16x16x32_bf16 a[208:211], a[112:115], a[84:87], a[208:211]
    v_mfma_f32_16x16x32_bf16 a[212:215], a[116:119], a[84:87], a[212:215]
    v_mfma_f32_16x16x32_bf16 a[216:219], a[120:123], a[84:87], a[216:219]
    buffer_load_dwordx4 a[104:107], v18, s[20:23], s45 offen offset:2048
    v_mfma_f32_16x16x32_bf16 a[220:223], a[124:127], a[84:87], a[220:223]
    v_mfma_f32_16x16x32_bf16 a[224:227], a[112:115], a[88:91], a[224:227]
    v_mfma_f32_16x16x32_bf16 a[228:231], a[116:119], a[88:91], a[228:231]
    buffer_load_dwordx4 a[108:111], v18, s[20:23], s45 offen offset:3072
    v_mfma_f32_16x16x32_bf16 a[232:235], a[120:123], a[88:91], a[232:235]
    v_mfma_f32_16x16x32_bf16 a[236:239], a[124:127], a[88:91], a[236:239]
    v_mfma_f32_16x16x32_bf16 a[240:243], a[112:115], a[92:95], a[240:243]
    v_mfma_f32_16x16x32_bf16 a[244:247], a[116:119], a[92:95], a[244:247]
    v_mfma_f32_16x16x32_bf16 a[248:251], a[120:123], a[92:95], a[248:251]
    v_mfma_f32_16x16x32_bf16 a[252:255], a[124:127], a[92:95], a[252:255]
    v_mfma_f32_16x16x32_bf16 a[128:131], a[112:115], a[64:67], a[128:131]
    v_mfma_f32_16x16x32_bf16 a[132:135], a[116:119], a[64:67], a[132:135]
    v_mfma_f32_16x16x32_bf16 a[136:139], a[120:123], a[64:67], a[136:139]
    v_mfma_f32_16x16x32_bf16 a[140:143], a[124:127], a[64:67], a[140:143]
    v_mfma_f32_16x16x32_bf16 a[144:147], a[112:115], a[68:71], a[144:147]
    buffer_load_dwordx4 a[64:67], v14, s[92:95], s44 offen offset:0
    v_mfma_f32_16x16x32_bf16 a[148:151], a[116:119], a[68:71], a[148:151]
    v_mfma_f32_16x16x32_bf16 a[152:155], a[120:123], a[68:71], a[152:155]
    v_mfma_f32_16x16x32_bf16 a[156:159], a[124:127], a[68:71], a[156:159]
    v_mfma_f32_16x16x32_bf16 a[160:163], a[112:115], a[72:75], a[160:163]
    buffer_load_dwordx4 a[68:71], v14, s[92:95], s44 offen offset:1024
    v_mfma_f32_16x16x32_bf16 a[164:167], a[116:119], a[72:75], a[164:167]
    v_mfma_f32_16x16x32_bf16 a[168:171], a[120:123], a[72:75], a[168:171]
    v_mfma_f32_16x16x32_bf16 a[172:175], a[124:127], a[72:75], a[172:175]
    v_mfma_f32_16x16x32_bf16 a[176:179], a[112:115], a[76:79], a[176:179]
    buffer_load_dwordx4 a[72:75], v15, s[92:95], s44 offen offset:0
    v_mfma_f32_16x16x32_bf16 a[180:183], a[116:119], a[76:79], a[180:183]
    v_mfma_f32_16x16x32_bf16 a[184:187], a[120:123], a[76:79], a[184:187]
    v_mfma_f32_16x16x32_bf16 a[188:191], a[124:127], a[76:79], a[188:191]
    s_waitcnt vmcnt(15)
    v_mfma_f32_16x16x32_bf16 v[32:35], a[32:35], a[0:3], v[32:35]
    buffer_load_dwordx4 a[76:79], v15, s[92:95], s44 offen offset:1024
    v_mfma_f32_16x16x32_bf16 v[36:39], a[36:39], a[0:3], v[36:39]
    v_mfma_f32_16x16x32_bf16 v[40:43], a[40:43], a[0:3], v[40:43]
    buffer_load_dwordx4 a[80:83], v16, s[92:95], s44 offen offset:0
    v_mfma_f32_16x16x32_bf16 v[44:47], a[44:47], a[0:3], v[44:47]
    v_mfma_f32_16x16x32_bf16 v[48:51], a[32:35], a[4:7], v[48:51]
    buffer_load_dwordx4 a[84:87], v16, s[92:95], s44 offen offset:1024
    v_mfma_f32_16x16x32_bf16 v[52:55], a[36:39], a[4:7], v[52:55]
    v_mfma_f32_16x16x32_bf16 v[56:59], a[40:43], a[4:7], v[56:59]
    v_mfma_f32_16x16x32_bf16 v[60:63], a[44:47], a[4:7], v[60:63]
    buffer_load_dwordx4 a[88:91], v17, s[92:95], s44 offen offset:0
    v_mfma_f32_16x16x32_bf16 v[64:67], a[32:35], a[8:11], v[64:67]
    v_mfma_f32_16x16x32_bf16 v[68:71], a[36:39], a[8:11], v[68:71]
    v_mfma_f32_16x16x32_bf16 v[72:75], a[40:43], a[8:11], v[72:75]
    buffer_load_dwordx4 a[92:95], v17, s[92:95], s44 offen offset:1024
    s_add_u32 s44, s44, 8192
    v_mfma_f32_16x16x32_bf16 v[76:79], a[44:47], a[8:11], v[76:79]
    v_mfma_f32_16x16x32_bf16 v[80:83], a[32:35], a[12:15], v[80:83]
    v_mfma_f32_16x16x32_bf16 v[84:87], a[36:39], a[12:15], v[84:87]
    buffer_load_dwordx4 a[112:115], v19, s[20:23], s45 offen offset:0
    v_mfma_f32_16x16x32_bf16 v[88:91], a[40:43], a[12:15], v[88:91]
    v_mfma_f32_16x16x32_bf16 v[92:95], a[44:47], a[12:15], v[92:95]
    s_waitcnt vmcnt(17)
    v_mfma_f32_16x16x32_bf16 v[96:99], a[32:35], a[16:19], v[96:99]
    buffer_load_dwordx4 a[116:119], v19, s[20:23], s45 offen offset:1024
    v_mfma_f32_16x16x32_bf16 v[100:103], a[36:39], a[16:19], v[100:103]
    v_mfma_f32_16x16x32_bf16 v[104:107], a[40:43], a[16:19], v[104:107]
    v_mfma_f32_16x16x32_bf16 v[108:111], a[44:47], a[16:19], v[108:111]
    buffer_load_dwordx4 a[120:123], v19, s[20:23], s45 offen offset:2048
    v_mfma_f32_16x16x32_bf16 v[112:115], a[32:35], a[20:23], v[112:115]
    v_mfma_f32_16x16x32_bf16 v[116:119], a[36:39], a[20:23], v[116:119]
    v_mfma_f32_16x16x32_bf16 v[120:123], a[40:43], a[20:23], v[120:123]
    buffer_load_dwordx4 a[124:127], v19, s[20:23], s45 offen offset:3072
    s_add_u32 s45, s45, 4096
    v_mfma_f32_16x16x32_bf16 v[124:127], a[44:47], a[20:23], v[124:127]
    v_mfma_f32_16x16x32_bf16 v[128:131], a[32:35], a[24:27], v[128:131]
    v_mfma_f32_16x16x32_bf16 v[132:135], a[36:39], a[24:27], v[132:135]
    v_mfma_f32_16x16x32_bf16 v[136:139], a[40:43], a[24:27], v[136:139]
    v_mfma_f32_16x16x32_bf16 v[140:143], a[44:47], a[24:27], v[140:143]
    v_mfma_f32_16x16x32_bf16 v[144:147], a[32:35], a[28:31], v[144:147]
    v_mfma_f32_16x16x32_bf16 v[148:151], a[36:39], a[28:31], v[148:151]
    v_mfma_f32_16x16x32_bf16 v[152:155], a[40:43], a[28:31], v[152:155]
    v_mfma_f32_16x16x32_bf16 v[156:159], a[44:47], a[28:31], v[156:159]
    s_waitcnt vmcnt(16)
    v_mfma_f32_16x16x32_bf16 a[192:195], a[48:51], a[16:19], a[192:195]
    buffer_load_dwordx4 a[32:35], v18, s[20:23], s45 offen offset:0
    v_mfma_f32_16x16x32_bf16 a[196:199], a[52:55], a[16:19], a[196:199]
    v_mfma_f32_16x16x32_bf16 a[200:203], a[56:59], a[16:19], a[200:203]
    v_mfma_f32_16x16x32_bf16 a[204:207], a[60:63], a[16:19], a[204:207]
    buffer_load_dwordx4 a[36:39], v18, s[20:23], s45 offen offset:1024
    v_mfma_f32_16x16x32_bf16 a[208:211], a[48:51], a[20:23], a[208:211]
    v_mfma_f32_16x16x32_bf16 a[212:215], a[52:55], a[20:23], a[212:215]
    v_mfma_f32_16x16x32_bf16 a[216:219], a[56:59], a[20:23], a[216:219]
    buffer_load_dwordx4 a[40:43], v18, s[20:23], s45 offen offset:2048
    v_mfma_f32_16x16x32_bf16 a[220:223], a[60:63], a[20:23], a[220:223]
    v_mfma_f32_16x16x32_bf16 a[224:227], a[48:51], a[24:27], a[224:227]
    v_mfma_f32_16x16x32_bf16 a[228:231], a[52:55], a[24:27], a[228:231]
    buffer_load_dwordx4 a[44:47], v18, s[20:23], s45 offen offset:3072
    v_mfma_f32_16x16x32_bf16 a[232:235], a[56:59], a[24:27], a[232:235]
    v_mfma_f32_16x16x32_bf16 a[236:239], a[60:63], a[24:27], a[236:239]
    v_mfma_f32_16x16x32_bf16 a[240:243], a[48:51], a[28:31], a[240:243]
    v_mfma_f32_16x16x32_bf16 a[244:247], a[52:55], a[28:31], a[244:247]
    v_mfma_f32_16x16x32_bf16 a[248:251], a[56:59], a[28:31], a[248:251]
    v_mfma_f32_16x16x32_bf16 a[252:255], a[60:63], a[28:31], a[252:255]
    v_mfma_f32_16x16x32_bf16 a[128:131], a[48:51], a[0:3], a[128:131]
    v_mfma_f32_16x16x32_bf16 a[132:135], a[52:55], a[0:3], a[132:135]
    v_mfma_f32_16x16x32_bf16 a[136:139], a[56:59], a[0:3], a[136:139]
    v_mfma_f32_16x16x32_bf16 a[140:143], a[60:63], a[0:3], a[140:143]
    v_mfma_f32_16x16x32_bf16 a[144:147], a[48:51], a[4:7], a[144:147]
    buffer_load_dwordx4 a[0:3], v14, s[92:95], s44 offen offset:0
    v_mfma_f32_16x16x32_bf16 a[148:151], a[52:55], a[4:7], a[148:151]
    v_mfma_f32_16x16x32_bf16 a[152:155], a[56:59], a[4:7], a[152:155]
    v_mfma_f32_16x16x32_bf16 a[156:159], a[60:63], a[4:7], a[156:159]
    v_mfma_f32_16x16x32_bf16 a[160:163], a[48:51], a[8:11], a[160:163]
    buffer_load_dwordx4 a[4:7], v14, s[92:95], s44 offen offset:1024
    v_mfma_f32_16x16x32_bf16 a[164:167], a[52:55], a[8:11], a[164:167]
    v_mfma_f32_16x16x32_bf16 a[168:171], a[56:59], a[8:11], a[168:171]
    v_mfma_f32_16x16x32_bf16 a[172:175], a[60:63], a[8:11], a[172:175]
    v_mfma_f32_16x16x32_bf16 a[176:179], a[48:51], a[12:15], a[176:179]
    buffer_load_dwordx4 a[8:11], v15, s[92:95], s44 offen offset:0
    v_mfma_f32_16x16x32_bf16 a[180:183], a[52:55], a[12:15], a[180:183]
    v_mfma_f32_16x16x32_bf16 a[184:187], a[56:59], a[12:15], a[184:187]
    v_mfma_f32_16x16x32_bf16 a[188:191], a[60:63], a[12:15], a[188:191]
    s_waitcnt vmcnt(15)
    v_mfma_f32_16x16x32_bf16 v[32:35], a[96:99], a[64:67], v[32:35]
    buffer_load_dword v24, v25, s[64:67], s58 offen sc1
    v_mfma_f32_16x16x32_bf16 v[36:39], a[100:103], a[64:67], v[36:39]
    v_mfma_f32_16x16x32_bf16 v[40:43], a[104:107], a[64:67], v[40:43]
    buffer_load_dwordx4 a[12:15], v15, s[92:95], s44 offen offset:1024
    v_mfma_f32_16x16x32_bf16 v[44:47], a[108:111], a[64:67], v[44:47]
    v_mfma_f32_16x16x32_bf16 v[48:51], a[96:99], a[68:71], v[48:51]
    buffer_load_dwordx4 a[16:19], v16, s[92:95], s44 offen offset:0
    v_mfma_f32_16x16x32_bf16 v[52:55], a[100:103], a[68:71], v[52:55]
    v_mfma_f32_16x16x32_bf16 v[56:59], a[104:107], a[68:71], v[56:59]
    buffer_load_dwordx4 a[20:23], v16, s[92:95], s44 offen offset:1024
    v_mfma_f32_16x16x32_bf16 v[60:63], a[108:111], a[68:71], v[60:63]
    v_mfma_f32_16x16x32_bf16 v[64:67], a[96:99], a[72:75], v[64:67]
    v_mfma_f32_16x16x32_bf16 v[68:71], a[100:103], a[72:75], v[68:71]
    buffer_load_dwordx4 a[24:27], v17, s[92:95], s44 offen offset:0
    v_mfma_f32_16x16x32_bf16 v[72:75], a[104:107], a[72:75], v[72:75]
    v_mfma_f32_16x16x32_bf16 v[76:79], a[108:111], a[72:75], v[76:79]
    v_mfma_f32_16x16x32_bf16 v[80:83], a[96:99], a[76:79], v[80:83]
    buffer_load_dwordx4 a[28:31], v17, s[92:95], s44 offen offset:1024
    s_add_u32 s44, s44, 8192
    v_mfma_f32_16x16x32_bf16 v[84:87], a[100:103], a[76:79], v[84:87]
    v_mfma_f32_16x16x32_bf16 v[88:91], a[104:107], a[76:79], v[88:91]
    v_mfma_f32_16x16x32_bf16 v[92:95], a[108:111], a[76:79], v[92:95]
    buffer_load_dwordx4 a[48:51], v19, s[20:23], s45 offen offset:0
    s_waitcnt vmcnt(18)
    v_mfma_f32_16x16x32_bf16 v[96:99], a[96:99], a[80:83], v[96:99]
    v_mfma_f32_16x16x32_bf16 v[100:103], a[100:103], a[80:83], v[100:103]
    v_mfma_f32_16x16x32_bf16 v[104:107], a[104:107], a[80:83], v[104:107]
    buffer_load_dwordx4 a[52:55], v19, s[20:23], s45 offen offset:1024
    v_mfma_f32_16x16x32_bf16 v[108:111], a[108:111], a[80:83], v[108:111]
    v_mfma_f32_16x16x32_bf16 v[112:115], a[96:99], a[84:87], v[112:115]
    v_mfma_f32_16x16x32_bf16 v[116:119], a[100:103], a[84:87], v[116:119]
    buffer_load_dwordx4 a[56:59], v19, s[20:23], s45 offen offset:2048
    v_mfma_f32_16x16x32_bf16 v[120:123], a[104:107], a[84:87], v[120:123]
    v_mfma_f32_16x16x32_bf16 v[124:127], a[108:111], a[84:87], v[124:127]
    v_mfma_f32_16x16x32_bf16 v[128:131], a[96:99], a[88:91], v[128:131]
    buffer_load_dwordx4 a[60:63], v19, s[20:23], s45 offen offset:3072
    s_add_u32 s45, s45, 4096
    v_mfma_f32_16x16x32_bf16 v[132:135], a[100:103], a[88:91], v[132:135]
    v_mfma_f32_16x16x32_bf16 v[136:139], a[104:107], a[88:91], v[136:139]
    v_mfma_f32_16x16x32_bf16 v[140:143], a[108:111], a[88:91], v[140:143]
    v_mfma_f32_16x16x32_bf16 v[144:147], a[96:99], a[92:95], v[144:147]
    v_mfma_f32_16x16x32_bf16 v[148:151], a[100:103], a[92:95], v[148:151]
    v_mfma_f32_16x16x32_bf16 v[152:155], a[104:107], a[92:95], v[152:155]
    v_mfma_f32_16x16x32_bf16 v[156:159], a[108:111], a[92:95], v[156:159]
    s_waitcnt vmcnt(17)
    v_mfma_f32_16x16x32_bf16 a[192:195], a[112:115], a[80:83], a[192:195]
    buffer_load_dwordx4 a[96:99], v18, s[20:23], s45 offen offset:0
    v_mfma_f32_16x16x32_bf16 a[196:199], a[116:119], a[80:83], a[196:199]
    v_mfma_f32_16x16x32_bf16 a[200:203], a[120:123], a[80:83], a[200:203]
    v_mfma_f32_16x16x32_bf16 a[204:207], a[124:127], a[80:83], a[204:207]
    buffer_load_dwordx4 a[100:103], v18, s[20:23], s45 offen offset:1024
    v_mfma_f32_16x16x32_bf16 a[208:211], a[112:115], a[84:87], a[208:211]
    v_mfma_f32_16x16x32_bf16 a[212:215], a[116:119], a[84:87], a[212:215]
    v_mfma_f32_16x16x32_bf16 a[216:219], a[120:123], a[84:87], a[216:219]
    buffer_load_dwordx4 a[104:107], v18, s[20:23], s45 offen offset:2048
    v_mfma_f32_16x16x32_bf16 a[220:223], a[124:127], a[84:87], a[220:223]
    v_mfma_f32_16x16x32_bf16 a[224:227], a[112:115], a[88:91], a[224:227]
    v_mfma_f32_16x16x32_bf16 a[228:231], a[116:119], a[88:91], a[228:231]
    buffer_load_dwordx4 a[108:111], v18, s[20:23], s45 offen offset:3072
    v_mfma_f32_16x16x32_bf16 a[232:235], a[120:123], a[88:91], a[232:235]
    v_mfma_f32_16x16x32_bf16 a[236:239], a[124:127], a[88:91], a[236:239]
    v_mfma_f32_16x16x32_bf16 a[240:243], a[112:115], a[92:95], a[240:243]
    v_mfma_f32_16x16x32_bf16 a[244:247], a[116:119], a[92:95], a[244:247]
    v_mfma_f32_16x16x32_bf16 a[248:251], a[120:123], a[92:95], a[248:251]
    v_mfma_f32_16x16x32_bf16 a[252:255], a[124:127], a[92:95], a[252:255]
    v_mfma_f32_16x16x32_bf16 a[128:131], a[112:115], a[64:67], a[128:131]
    v_mfma_f32_16x16x32_bf16 a[132:135], a[116:119], a[64:67], a[132:135]
    v_mfma_f32_16x16x32_bf16 a[136:139], a[120:123], a[64:67], a[136:139]
    v_mfma_f32_16x16x32_bf16 a[140:143], a[124:127], a[64:67], a[140:143]
    v_mfma_f32_16x16x32_bf16 a[144:147], a[112:115], a[68:71], a[144:147]
    buffer_load_dwordx4 a[64:67], v14, s[92:95], s44 offen offset:0
    v_mfma_f32_16x16x32_bf16 a[148:151], a[116:119], a[68:71], a[148:151]
    v_mfma_f32_16x16x32_bf16 a[152:155], a[120:123], a[68:71], a[152:155]
    v_mfma_f32_16x16x32_bf16 a[156:159], a[124:127], a[68:71], a[156:159]
    v_mfma_f32_16x16x32_bf16 a[160:163], a[112:115], a[72:75], a[160:163]
    buffer_load_dwordx4 a[68:71], v14, s[92:95], s44 offen offset:1024
    v_mfma_f32_16x16x32_bf16 a[164:167], a[116:119], a[72:75], a[164:167]
    v_mfma_f32_16x16x32_bf16 a[168:171], a[120:123], a[72:75], a[168:171]
    v_mfma_f32_16x16x32_bf16 a[172:175], a[124:127], a[72:75], a[172:175]
    v_mfma_f32_16x16x32_bf16 a[176:179], a[112:115], a[76:79], a[176:179]
    buffer_load_dwordx4 a[72:75], v15, s[92:95], s44 offen offset:0
    v_mfma_f32_16x16x32_bf16 a[180:183], a[116:119], a[76:79], a[180:183]
    v_mfma_f32_16x16x32_bf16 a[184:187], a[120:123], a[76:79], a[184:187]
    v_mfma_f32_16x16x32_bf16 a[188:191], a[124:127], a[76:79], a[188:191]
    s_waitcnt vmcnt(15)
    v_mfma_f32_16x16x32_bf16 v[32:35], a[32:35], a[0:3], v[32:35]
    buffer_load_dwordx4 a[76:79], v15, s[92:95], s44 offen offset:1024
    v_mfma_f32_16x16x32_bf16 v[36:39], a[36:39], a[0:3], v[36:39]
    v_mfma_f32_16x16x32_bf16 v[40:43], a[40:43], a[0:3], v[40:43]
    buffer_load_dwordx4 a[80:83], v16, s[92:95], s44 offen offset:0
    v_mfma_f32_16x16x32_bf16 v[44:47], a[44:47], a[0:3], v[44:47]
    v_mfma_f32_16x16x32_bf16 v[48:51], a[32:35], a[4:7], v[48:51]
    buffer_load_dwordx4 a[84:87], v16, s[92:95], s44 offen offset:1024
    v_mfma_f32_16x16x32_bf16 v[52:55], a[36:39], a[4:7], v[52:55]
    v_mfma_f32_16x16x32_bf16 v[56:59], a[40:43], a[4:7], v[56:59]
    v_mfma_f32_16x16x32_bf16 v[60:63], a[44:47], a[4:7], v[60:63]
    buffer_load_dwordx4 a[88:91], v17, s[92:95], s44 offen offset:0
    v_mfma_f32_16x16x32_bf16 v[64:67], a[32:35], a[8:11], v[64:67]
    v_mfma_f32_16x16x32_bf16 v[68:71], a[36:39], a[8:11], v[68:71]
    v_mfma_f32_16x16x32_bf16 v[72:75], a[40:43], a[8:11], v[72:75]
    buffer_load_dwordx4 a[92:95], v17, s[92:95], s44 offen offset:1024
    s_add_u32 s44, s44, 8192
    v_mfma_f32_16x16x32_bf16 v[76:79], a[44:47], a[8:11], v[76:79]
    v_mfma_f32_16x16x32_bf16 v[80:83], a[32:35], a[12:15], v[80:83]
    v_mfma_f32_16x16x32_bf16 v[84:87], a[36:39], a[12:15], v[84:87]
    buffer_load_dwordx4 a[112:115], v19, s[20:23], s45 offen offset:0
    v_mfma_f32_16x16x32_bf16 v[88:91], a[40:43], a[12:15], v[88:91]
    v_mfma_f32_16x16x32_bf16 v[92:95], a[44:47], a[12:15], v[92:95]
    s_waitcnt vmcnt(17)
    v_mfma_f32_16x16x32_bf16 v[96:99], a[32:35], a[16:19], v[96:99]
    buffer_load_dwordx4 a[116:119], v19, s[20:23], s45 offen offset:1024
    v_mfma_f32_16x16x32_bf16 v[100:103], a[36:39], a[16:19], v[100:103]
    v_mfma_f32_16x16x32_bf16 v[104:107], a[40:43], a[16:19], v[104:107]
    v_mfma_f32_16x16x32_bf16 v[108:111], a[44:47], a[16:19], v[108:111]
    buffer_load_dwordx4 a[120:123], v19, s[20:23], s45 offen offset:2048
    v_mfma_f32_16x16x32_bf16 v[112:115], a[32:35], a[20:23], v[112:115]
    v_mfma_f32_16x16x32_bf16 v[116:119], a[36:39], a[20:23], v[116:119]
    v_mfma_f32_16x16x32_bf16 v[120:123], a[40:43], a[20:23], v[120:123]
    buffer_load_dwordx4 a[124:127], v19, s[20:23], s45 offen offset:3072
    s_add_u32 s45, s45, 4096
    v_mfma_f32_16x16x32_bf16 v[124:127], a[44:47], a[20:23], v[124:127]
    v_mfma_f32_16x16x32_bf16 v[128:131], a[32:35], a[24:27], v[128:131]
    v_mfma_f32_16x16x32_bf16 v[132:135], a[36:39], a[24:27], v[132:135]
    v_mfma_f32_16x16x32_bf16 v[136:139], a[40:43], a[24:27], v[136:139]
    v_mfma_f32_16x16x32_bf16 v[140:143], a[44:47], a[24:27], v[140:143]
    v_mfma_f32_16x16x32_bf16 v[144:147], a[32:35], a[28:31], v[144:147]
    v_mfma_f32_16x16x32_bf16 v[148:151], a[36:39], a[28:31], v[148:151]
    v_mfma_f32_16x16x32_bf16 v[152:155], a[40:43], a[28:31], v[152:155]
    v_mfma_f32_16x16x32_bf16 v[156:159], a[44:47], a[28:31], v[156:159]
    s_waitcnt vmcnt(16)
    v_mfma_f32_16x16x32_bf16 a[192:195], a[48:51], a[16:19], a[192:195]
    buffer_load_dwordx4 a[32:35], v18, s[20:23], s45 offen offset:0
    v_mfma_f32_16x16x32_bf16 a[196:199], a[52:55], a[16:19], a[196:199]
    v_mfma_f32_16x16x32_bf16 a[200:203], a[56:59], a[16:19], a[200:203]
    v_mfma_f32_16x16x32_bf16 a[204:207], a[60:63], a[16:19], a[204:207]
    buffer_load_dwordx4 a[36:39], v18, s[20:23], s45 offen offset:1024
    v_mfma_f32_16x16x32_bf16 a[208:211], a[48:51], a[20:23], a[208:211]
    v_mfma_f32_16x16x32_bf16 a[212:215], a[52:55], a[20:23], a[212:215]
    v_mfma_f32_16x16x32_bf16 a[216:219], a[56:59], a[20:23], a[216:219]
    buffer_load_dwordx4 a[40:43], v18, s[20:23], s45 offen offset:2048
    v_mfma_f32_16x16x32_bf16 a[220:223], a[60:63], a[20:23], a[220:223]
    v_mfma_f32_16x16x32_bf16 a[224:227], a[48:51], a[24:27], a[224:227]
    v_mfma_f32_16x16x32_bf16 a[228:231], a[52:55], a[24:27], a[228:231]
    buffer_load_dwordx4 a[44:47], v18, s[20:23], s45 offen offset:3072
    v_mfma_f32_16x16x32_bf16 a[232:235], a[56:59], a[24:27], a[232:235]
    v_mfma_f32_16x16x32_bf16 a[236:239], a[60:63], a[24:27], a[236:239]
    v_mfma_f32_16x16x32_bf16 a[240:243], a[48:51], a[28:31], a[240:243]
    v_mfma_f32_16x16x32_bf16 a[244:247], a[52:55], a[28:31], a[244:247]
    v_mfma_f32_16x16x32_bf16 a[248:251], a[56:59], a[28:31], a[248:251]
    v_mfma_f32_16x16x32_bf16 a[252:255], a[60:63], a[28:31], a[252:255]
    v_mfma_f32_16x16x32_bf16 a[128:131], a[48:51], a[0:3], a[128:131]
    v_mfma_f32_16x16x32_bf16 a[132:135], a[52:55], a[0:3], a[132:135]
    v_mfma_f32_16x16x32_bf16 a[136:139], a[56:59], a[0:3], a[136:139]
    v_mfma_f32_16x16x32_bf16 a[140:143], a[60:63], a[0:3], a[140:143]
    v_mfma_f32_16x16x32_bf16 a[144:147], a[48:51], a[4:7], a[144:147]
    buffer_load_dwordx4 a[0:3], v14, s[92:95], s44 offen offset:0
    v_mfma_f32_16x16x32_bf16 a[148:151], a[52:55], a[4:7], a[148:151]
    v_mfma_f32_16x16x32_bf16 a[152:155], a[56:59], a[4:7], a[152:155]
    v_mfma_f32_16x16x32_bf16 a[156:159], a[60:63], a[4:7], a[156:159]
    v_mfma_f32_16x16x32_bf16 a[160:163], a[48:51], a[8:11], a[160:163]
    buffer_load_dwordx4 a[4:7], v14, s[92:95], s44 offen offset:1024
    v_mfma_f32_16x16x32_bf16 a[164:167], a[52:55], a[8:11], a[164:167]
    v_mfma_f32_16x16x32_bf16 a[168:171], a[56:59], a[8:11], a[168:171]
    v_mfma_f32_16x16x32_bf16 a[172:175], a[60:63], a[8:11], a[172:175]
    v_mfma_f32_16x16x32_bf16 a[176:179], a[48:51], a[12:15], a[176:179]
    buffer_load_dwordx4 a[8:11], v15, s[92:95], s44 offen offset:0
    v_mfma_f32_16x16x32_bf16 a[180:183], a[52:55], a[12:15], a[180:183]
    v_mfma_f32_16x16x32_bf16 a[184:187], a[56:59], a[12:15], a[184:187]
    v_mfma_f32_16x16x32_bf16 a[188:191], a[60:63], a[12:15], a[188:191]
    s_waitcnt vmcnt(15)
    s_mov_b32 s90, 0
Lz_chk:
    v_cmp_ne_u32 vcc, v24, v29
    s_cbranch_vccnz Lz_spin
Lz_go:
    v_mfma_f32_16x16x32_bf16 v[32:35], a[96:99], a[64:67], v[32:35]
    buffer_load_dwordx4 a[12:15], v15, s[92:95], s44 offen offset:1024
    v_mfma_f32_16x16x32_bf16 v[36:39], a[100:103], a[64:67], v[36:39]
    v_mfma_f32_16x16x32_bf16 v[40:43], a[104:107], a[64:67], v[40:43]
    buffer_load_dwordx4 a[16:19], v16, s[92:95], s44 offen offset:0
    v_mfma_f32_16x16x32_bf16 v[44:47], a[108:111], a[64:67], v[44:47]
    v_mfma_f32_16x16x32_bf16 v[48:51], a[96:99], a[68:71], v[48:51]
    buffer_load_dwordx4 a[20:23], v16, s[92:95], s44 offen offset:1024
    v_mfma_f32_16x16x32_bf16 v[52:55], a[100:103], a[68:71], v[52:55]
    v_mfma_f32_16x16x32_bf16 v[56:59], a[104:107], a[68:71], v[56:59]
    v_mfma_f32_16x16x32_bf16 v[60:63], a[108:111], a[68:71], v[60:63]
    buffer_load_dwordx4 a[24:27], v17, s[92:95], s44 offen offset:0
    v_mfma_f32_16x16x32_bf16 v[64:67], a[96:99], a[72:75], v[64:67]
    v_mfma_f32_16x16x32_bf16 v[68:71], a[100:103], a[72:75], v[68:71]
    v_mfma_f32_16x16x32_bf16 v[72:75], a[104:107], a[72:75], v[72:75]
    buffer_load_dwordx4 a[28:31], v17, s[92:95], s44 offen offset:1024
    s_add_u32 s44, s44, 8192
    v_mfma_f32_16x16x32_bf16 v[76:79], a[108:111], a[72:75], v[76:79]
    v_mfma_f32_16x16x32_bf16 v[80:83], a[96:99], a[76:79], v[80:83]
    v_mfma_f32_16x16x32_bf16 v[84:87], a[100:103], a[76:79], v[84:87]
    buffer_load_dwordx4 a[48:51], v19, s[20:23], s45 offen offset:0
    v_mfma_f32_16x16x32_bf16 v[88:91], a[104:107], a[76:79], v[88:91]
    v_mfma_f32_16x16x32_bf16 v[92:95], a[108:111], a[76:79], v[92:95]
    s_waitcnt vmcnt(17)
    v_mfma_f32_16x16x32_bf16 v[96:99], a[96:99], a[80:83], v[96:99]
    buffer_load_dwordx4 a[52:55], v19, s[20:23], s45 offen offset:1024
    v_mfma_f32_16x16x32_bf16 v[100:103], a[100:103], a[80:83], v[100:103]
    v_mfma_f32_16x16x32_bf16 v[104:107], a[104:107], a[80:83], v[104:107]
    v_mfma_f32_16x16x32_bf16 v[108:111], a[108:111], a[80:83], v[108:111]
    buffer_load_dwordx4 a[56:59], v19, s[20:23], s45 offen offset:2048
    v_mfma_f32_16x16x32_bf16 v[112:115], a[96:99], a[84:87], v[112:115]
    v_mfma_f32_16x16x32_bf16 v[116:119], a[100:103], a[84:87], v[116:119]
    v_mfma_f32_16x16x32_bf16 v[120:123], a[104:107], a[84:87], v[120:123]
    buffer_load_dwordx4 a[60:63], v19, s[20:23], s45 offen offset:3072
    s_add_u32 s45, s45, 4096
    v_mfma_f32_16x16x32_bf16 v[124:127], a[108:111], a[84:87], v[124:127]
    v_mfma_f32_16x16x32_bf16 v[128:131], a[96:99], a[88:91], v[128:131]
    v_mfma_f32_16x16x32_bf16 v[132:135], a[100:103], a[88:91], v[132:135]
    s_add_u32 m0, s46, 0
    s_add_u32 s55, s54, 0
    buffer_load_dwordx4 v5, s[36:39], s55 offen sc1 lds
    v_mfma_f32_16x16x32_bf16 v[136:139], a[104:107], a[88:91], v[136:139]
    v_mfma_f32_16x16x32_bf16 v[140:143], a[108:111], a[88:91], v[140:143]
    v_mfma_f32_16x16x32_bf16 v[144:147], a[96:99], a[92:95], v[144:147]
    s_add_u32 m0, s46, 1024
    s_add_u32 s55, s54, 65536
    buffer_load_dwordx4 v5, s[36:39], s55 offen sc1 lds
    v_mfma_f32_16x16x32_bf16 v[148:151], a[100:103], a[92:95], v[148:151]
    v_mfma_f32_16x16x32_bf16 v[152:155], a[104:107], a[92:95], v[152:155]
    v_mfma_f32_16x16x32_bf16 v[156:159], a[108:111], a[92:95], v[156:159]
    s_waitcnt vmcnt(18)
    v_mfma_f32_16x16x32_bf16 a[192:195], a[112:115], a[80:83], a[192:195]
    buffer_load_dwordx4 a[96:99], v18, s[20:23], s45 offen offset:0
    v_mfma_f32_16x16x32_bf16 a[196:199], a[116:119], a[80:83], a[196:199]
    v_mfma_f32_16x16x32_bf16 a[200:203], a[120:123], a[80:83], a[200:203]
    v_mfma_f32_16x16x32_bf16 a[204:207], a[124:127], a[80:83], a[204:207]
    buffer_load_dwordx4 a[100:103], v18, s[20:23], s45 offen offset:1024
    v_mfma_f32_16x16x32_bf16 a[208:211], a[112:115], a[84:87], a[208:211]
    v_mfma_f32_16x16x32_bf16 a[212:215], a[116:119], a[84:87], a[212:215]
    v_mfma_f32_16x16x32_bf16 a[216:219], a[120:123], a[84:87], a[216:219]
    buffer_load_dwordx4 a[104:107], v18, s[20:23], s45 offen offset:2048
    v_mfma_f32_16x16x32_bf16 a[220:223], a[124:127], a[84:87], a[220:223]
    v_mfma_f32_16x16x32_bf16 a[224:227], a[112:115], a[88:91], a[224:227]
    v_mfma_f32_16x16x32_bf16 a[228:231], a[116:119], a[88:91], a[228:231]
    buffer_load_dwordx4 a[108:111], v18, s[20:23], s45 offen offset:3072
    v_mfma_f32_16x16x32_bf16 a[232:235], a[120:123], a[88:91], a[232:235]
    v_mfma_f32_16x16x32_bf16 a[236:239], a[124:127], a[88:91], a[236:239]
    v_mfma_f32_16x16x32_bf16 a[240:243], a[112:115], a[92:95], a[240:243]
    v_mfma_f32_16x16x32_bf16 a[244:247], a[116:119], a[92:95], a[244:247]
    v_mfma_f32_16x16x32_bf16 a[248:251], a[120:123], a[92:95], a[248:251]
    v_mfma_f32_16x16x32_bf16 a[252:255], a[124:127], a[92:95], a[252:255]
    v_mfma_f32_16x16x32_bf16 a[128:131], a[112:115], a[64:67], a[128:131]
    v_mfma_f32_16x16x32_bf16 a[132:135], a[116:119], a[64:67], a[132:135]
    v_mfma_f32_16x16x32_bf16 a[136:139], a[120:123], a[64:67], a[136:139]
    v_mfma_f32_16x16x32_bf16 a[140:143], a[124:127], a[64:67], a[140:143]
    v_mfma_f32_16x16x32_bf16 a[144:147], a[112:115], a[68:71], a[144:147]
    buffer_load_dwordx4 a[64:67], v14, s[92:95], s44 offen offset:0
    v_mfma_f32_16x16x32_bf16 a[148:151], a[116:119], a[68:71], a[148:151]
    v_mfma_f32_16x16x32_bf16 a[152:155], a[120:123], a[68:71], a[152:155]
    v_mfma_f32_16x16x32_bf16 a[156:159], a[124:127], a[68:71], a[156:159]
    v_mfma_f32_16x16x32_bf16 a[160:163], a[112:115], a[72:75], a[160:163]
    buffer_load_dwordx4 a[68:71], v14, s[92:95], s44 offen offset:1024
    v_mfma_f32_16x16x32_bf16 a[164:167], a[116:119], a[72:75], a[164:167]
    v_mfma_f32_16x16x32_bf16 a[168:171], a[120:123], a[72:75], a[168:171]
    v_mfma_f32_16x16x32_bf16 a[172:175], a[124:127], a[72:75], a[172:175]
    v_mfma_f32_16x16x32_bf16 a[176:179], a[112:115], a[76:79], a[176:179]
    buffer_load_dwordx4 a[72:75], v15, s[92:95], s44 offen offset:0
    v_mfma_f32_16x16x32_bf16 a[180:183], a[116:119], a[76:79], a[180:183]
    v_mfma_f32_16x16x32_bf16 a[184:187], a[120:123], a[76:79], a[184:187]
    v_mfma_f32_16x16x32_bf16 a[188:191], a[124:127], a[76:79], a[188:191]
    s_waitcnt vmcnt(17)
    v_mfma_f32_16x16x32_bf16 v[32:35], a[32:35], a[0:3], v[32:35]
    buffer_load_dwordx4 a[76:79], v15, s[92:95], s44 offen offset:1024
    v_mfma_f32_16x16x32_bf16 v[36:39], a[36:39], a[0:3], v[36:39]
    v_mfma_f32_16x16x32_bf16 v[40:43], a[40:43], a[0:3], v[40:43]
    buffer_load_dwordx4 a[80:83], v16, s[92:95], s44 offen offset:0
    v_mfma_f32_16x16x32_bf16 v[44:47], a[44:47], a[0:3], v[44:47]
    v_mfma_f32_16x16x32_bf16 v[48:51], a[32:35], a[4:7], v[48:51]
    buffer_load_dwordx4 a[84:87], v16, s[92:95], s44 offen offset:1024
    v_mfma_f32_16x16x32_bf16 v[52:55], a[36:39], a[4:7], v[52:55]
    v_mfma_f32_16x16x32_bf16 v[56:59], a[40:43], a[4:7], v[56:59]
    v_mfma_f32_16x16x32_bf16 v[60:63], a[44:47], a[4:7], v[60:63]
    buffer_load_dwordx4 a[88:91], v17, s[92:95], s44 offen offset:0
    v_mfma_f32_16x16x32_bf16 v[64:67], a[32:35], a[8:11], v[64:67]
    v_mfma_f32_16x16x32_bf16 v[68:71], a[36:39], a[8:11], v[68:71]
    v_mfma_f32_16x16x32_bf16 v[72:75], a[40:43], a[8:11], v[72:75]
    buffer_load_dwordx4 a[92:95], v17, s[92:95], s44 offen offset:1024
    s_add_u32 s44, s44, 8192
    v_mfma_f32_16x16x32_bf16 v[76:79], a[44:47], a[8:11], v[76:79]
    v_mfma_f32_16x16x32_bf16 v[80:83], a[32:35], a[12:15], v[80:83]
    v_mfma_f32_16x16x32_bf16 v[84:87], a[36:39], a[12:15], v[84:87]
    buffer_load_dwordx4 a[112:115], v19, s[20:23], s45 offen offset:0
    v_mfma_f32_16x16x32_bf16 v[88:91], a[40:43], a[12:15], v[88:91]
    v_mfma_f32_16x16x32_bf16 v[92:95], a[44:47], a[12:15], v[92:95]
    s_waitcnt vmcnt(19)
    v_mfma_f32_16x16x32_bf16 v[96:99], a[32:35], a[16:19], v[96:99]
    buffer_load_dwordx4 a[116:119], v19, s[20:23], s45 offen offset:1024
    v_mfma_f32_16x16x32_bf16 v[100:103], a[36:39], a[16:19], v[100:103]
    v_mfma_f32_16x16x32_bf16 v[104:107], a[40:43], a[16:19], v[104:107]
    v_mfma_f32_16x16x32_bf16 v[108:111], a[44:47], a[16:19], v[108:111]
    buffer_load_dwordx4 a[120:123], v19, s[20:23], s45 offen offset:2048
    v_mfma_f32_16x16x32_bf16 v[112:115], a[32:35], a[20:23], v[112:115]
    v_mfma_f32_16x16x32_bf16 v[116:119], a[36:39], a[20:23], v[116:119]
    v_mfma_f32_16x16x32_bf16 v[120:123], a[40:43], a[20:23], v[120:123]
    buffer_load_dwordx4 a[124:127], v19, s[20:23], s45 offen offset:3072
    s_add_u32 s45, s45, 4096
    v_mfma_f32_16x16x32_bf16 v[124:127], a[44:47], a[20:23], v[124:127]
    v_mfma_f32_16x16x32_bf16 v[128:131], a[32:35], a[24:27], v[128:131]
    v_mfma_f32_16x16x32_bf16 v[132:135], a[36:39], a[24:27], v[132:135]
    s_add_u32 m0, s46, 2048
    s_add_u32 s55, s54, 131072
    buffer_load_dwordx4 v5, s[36:39], s55 offen sc1 lds
    v_mfma_f32_16x16x32_bf16 v[136:139], a[40:43], a[24:27], v[136:139]
    v_mfma_f32_16x16x32_bf16 v[140:143], a[44:47], a[24:27], v[140:143]
    v_mfma_f32_16x16x32_bf16 v[144:147], a[32:35], a[28:31], v[144:147]
    s_add_u32 m0, s46, 3072
    s_add_u32 s55, s54, 196608
    buffer_load_dwordx4 v5, s[36:39], s55 offen sc1 lds
    v_mfma_f32_16x16x32_bf16 v[148:151], a[36:39], a[28:31], v[148:151]
    v_mfma_f32_16x16x32_bf16 v[152:155], a[40:43], a[28:31], v[152:155]
    v_mfma_f32_16x16x32_bf16 v[156:159], a[44:47], a[28:31], v[156:159]
    s_waitcnt vmcnt(20)
    v_mfma_f32_16x16x32_bf16 a[192:195], a[48:51], a[16:19], a[192:195]
    buffer_load_dwordx4 a[32:35], v18, s[20:23], s45 offen offset:0
    v_mfma_f32_16x16x32_bf16 a[196:199], a[52:55], a[16:19], a[196:199]
    v_mfma_f32_16x16x32_bf16 a[200:203], a[56:59], a[16:19], a[200:203]
    v_mfma_f32_16x16x32_bf16 a[204:207], a[60:63], a[16:19], a[204:207]
    buffer_load_dwordx4 a[36:39], v18, s[20:23], s45 offen offset:1024
    v_mfma_f32_16x16x32_bf16 a[208:211], a[48:51], a[20:23], a[208:211]
    v_mfma_f32_16x16x32_bf16 a[212:215], a[52:55], a[20:23], a[212:215]
    v_mfma_f32_16x16x32_bf16 a[216:219], a[56:59], a[20:23], a[216:219]
    buffer_load_dwordx4 a[40:43], v18, s[20:23], s45 offen offset:2048
    v_mfma_f32_16x16x32_bf16 a[220:223], a[60:63], a[20:23], a[220:223]
    v_mfma_f32_16x16x32_bf16 a[224:227], a[48:51], a[24:27], a[224:227]
    v_mfma_f32_16x16x32_bf16 a[228:231], a[52:55], a[24:27], a[228:231]
    buffer_load_dwordx4 a[44:47], v18, s[20:23], s45 offen offset:3072
    v_mfma_f32_16x16x32_bf16 a[232:235], a[56:59], a[24:27], a[232:235]
    v_mfma_f32_16x16x32_bf16 a[236:239], a[60:63], a[24:27], a[236:239]
    v_mfma_f32_16x16x32_bf16 a[240:243], a[48:51], a[28:31], a[240:243]
    v_mfma_f32_16x16x32_bf16 a[244:247], a[52:55], a[28:31], a[244:247]
    v_mfma_f32_16x16x32_bf16 a[248:251], a[56:59], a[28:31], a[248:251]
    v_mfma_f32_16x16x32_bf16 a[252:255], a[60:63], a[28:31], a[252:255]
    v_mfma_f32_16x16x32_bf16 a[128:131], a[48:51], a[0:3], a[128:131]
    v_mfma_f32_16x16x32_bf16 a[132:135], a[52:55], a[0:3], a[132:135]
    v_mfma_f32_16x16x32_bf16 a[136:139], a[56:59], a[0:3], a[136:139]
    v_mfma_f32_16x16x32_bf16 a[140:143], a[60:63], a[0:3], a[140:143]
    v_mfma_f32_16x16x32_bf16 a[144:147], a[48:51], a[4:7], a[144:147]
    buffer_load_dwordx4 a[0:3], v14, s[92:95], s44 offen offset:0
    v_mfma_f32_16x16x32_bf16 a[148:151], a[52:55], a[4:7], a[148:151]
    v_mfma_f32_16x16x32_bf16 a[152:155], a[56:59], a[4:7], a[152:155]
    v_mfma_f32_16x16x32_bf16 a[156:159], a[60:63], a[4:7], a[156:159]
    v_mfma_f32_16x16x32_bf16 a[160:163], a[48:51], a[8:11], a[160:163]
    buffer_load_dwordx4 a[4:7], v14, s[92:95], s44 offen offset:1024
    v_mfma_f32_16x16x32_bf16 a[164:167], a[52:55], a[8:11], a[164:167]
    v_mfma_f32_16x16x32_bf16 a[168:171], a[56:59], a[8:11], a[168:171]
    v_mfma_f32_16x16x32_bf16 a[172:175], a[60:63], a[8:11], a[172:175]
    v_mfma_f32_16x16x32_bf16 a[176:179], a[48:51], a[12:15], a[176:179]
    buffer_load_dwordx4 a[8:11], v15, s[92:95], s44 offen offset:0
    v_mfma_f32_16x16x32_bf16 a[180:183], a[52:55], a[12:15], a[180:183]
    v_mfma_f32_16x16x32_bf16 a[184:187], a[56:59], a[12:15], a[184:187]
    v_mfma_f32_16x16x32_bf16 a[188:191], a[60:63], a[12:15], a[188:191]
    s_waitcnt vmcnt(17)
    v_mfma_f32_16x16x32_bf16 v[32:35], a[96:99], a[64:67], v[32:35]
    buffer_load_dwordx4 a[12:15], v15, s[92:95], s44 offen offset:1024
    v_mfma_f32_16x16x32_bf16 v[36:39], a[100:103], a[64:67], v[36:39]
    v_mfma_f32_16x16x32_bf16 v[40:43], a[104:107], a[64:67], v[40:43]
    buffer_load_dwordx4 a[16:19], v16, s[92:95], s44 offen offset:0
    v_mfma_f32_16x16x32_bf16 v[44:47], a[108:111], a[64:67], v[44:47]
    v_mfma_f32_16x16x32_bf16 v[48:51], a[96:99], a[68:71], v[48:51]
    buffer_load_dwordx4 a[20:23], v16, s[92:95], s44 offen offset:1024
    v_mfma_f32_16x16x32_bf16 v[52:55], a[100:103], a[68:71], v[52:55]
    v_mfma_f32_16x16x32_bf16 v[56:59], a[104:107], a[68:71], v[56:59]
    v_mfma_f32_16x16x32_bf16 v[60:63], a[108:111], a[68:71], v[60:63]
    buffer_load_dwordx4 a[24:27], v17, s[92:95], s44 offen offset:0
    v_mfma_f32_16x16x32_bf16 v[64:67], a[96:99], a[72:75], v[64:67]
    v_mfma_f32_16x16x32_bf16 v[68:71], a[100:103], a[72:75], v[68:71]
    v_mfma_f32_16x16x32_bf16 v[72:75], a[104:107], a[72:75], v[72:75]
    buffer_load_dwordx4 a[28:31], v17, s[92:95], s44 offen offset:1024
    s_add_u32 s44, s44, 8192
    v_mfma_f32_16x16x32_bf16 v[76:79], a[108:111], a[72:75], v[76:79]
    v_mfma_f32_16x16x32_bf16 v[80:83], a[96:99], a[76:79], v[80:83]
    v_mfma_f32_16x16x32_bf16 v[84:87], a[100:103], a[76:79], v[84:87]
    buffer_load_dwordx4 a[48:51], v19, s[20:23], s45 offen offset:0
    v_mfma_f32_16x16x32_bf16 v[88:91], a[104:107], a[76:79], v[88:91]
    v_mfma_f32_16x16x32_bf16 v[92:95], a[108:111], a[76:79], v[92:95]
    s_waitcnt vmcnt(19)
    v_mfma_f32_16x16x32_bf16 v[96:99], a[96:99], a[80:83], v[96:99]
    buffer_load_dwordx4 a[52:55], v19, s[20:23], s45 offen offset:1024
    v_mfma_f32_16x16x32_bf16 v[100:103], a[100:103], a[80:83], v[100:103]
    v_mfma_f32_16x16x32_bf16 v[104:107], a[104:107], a[80:83], v[104:107]
    v_mfma_f32_16x16x32_bf16 v[108:111], a[108:111], a[80:83], v[108:111]
    buffer_load_dwordx4 a[56:59], v19, s[20:23], s45 offen offset:2048
    v_mfma_f32_16x16x32_bf16 v[112:115], a[96:99], a[84:87], v[112:115]
    v_mfma_f32_16x16x32_bf16 v[116:119], a[100:103], a[84:87], v[116:119]
    v_mfma_f32_16x16x32_bf16 v[120:123], a[104:107], a[84:87], v[120:123]
    buffer_load_dwordx4 a[60:63], v19, s[20:23], s45 offen offset:3072
    s_add_u32 s45, s45, 4096
    v_mfma_f32_16x16x32_bf16 v[124:127], a[108:111], a[84:87], v[124:127]
    v_mfma_f32_16x16x32_bf16 v[128:131], a[96:99], a[88:91], v[128:131]
    v_mfma_f32_16x16x32_bf16 v[132:135], a[100:103], a[88:91], v[132:135]
    v_mfma_f32_16x16x32_bf16 v[136:139], a[104:107], a[88:91], v[136:139]
    v_mfma_f32_16x16x32_bf16 v[140:143], a[108:111], a[88:91], v[140:143]
    v_mfma_f32_16x16x32_bf16 v[144:147], a[96:99], a[92:95], v[144:147]
    v_mfma_f32_16x16x32_bf16 v[148:151], a[100:103], a[92:95], v[148:151]
    v_mfma_f32_16x16x32_bf16 v[152:155], a[104:107], a[92:95], v[152:155]
    v_mfma_f32_16x16x32_bf16 v[156:159], a[108:111], a[92:95], v[156:159]
    s_waitcnt vmcnt(18)
    v_mfma_f32_16x16x32_bf16 a[192:195], a[112:115], a[80:83], a[192:195]
    buffer_load_dwordx4 a[96:99], v18, s[20:23], s45 offen offset:0
    v_mfma_f32_16x16x32_bf16 a[196:199], a[116:119], a[80:83], a[196:199]
    s_waitcnt vmcnt(17)
    v_mfma_f32_16x16x32_bf16 a[200:203], a[120:123], a[80:83], a[200:203]
    ds_read_b64_tr_b16 v[208:209], v7 offset:0
    v_mfma_f32_16x16x32_bf16 a[204:207], a[124:127], a[80:83], a[204:207]
    buffer_load_dwordx4 a[100:103], v18, s[20:23], s45 offen offset:1024
    ds_read_b64_tr_b16 v[210:211], v7 offset:1024
    v_mfma_f32_16x16x32_bf16 a[208:211], a[112:115], a[84:87], a[208:211]
    ds_read_b64_tr_b16 v[212:213], v7 offset:2048
    v_mfma_f32_16x16x32_bf16 a[212:215], a[116:119], a[84:87], a[212:215]
    ds_read_b64_tr_b16 v[214:215], v7 offset:3072
    v_mfma_f32_16x16x32_bf16 a[216:219], a[120:123], a[84:87], a[216:219]
    buffer_load_dwordx4 a[104:107], v18, s[20:23], s45 offen offset:2048
    ds_read_b64_tr_b16 v[216:217], v7 offset:32
    v_mfma_f32_16x16x32_bf16 a[220:223], a[124:127], a[84:87], a[220:223]
    ds_read_b64_tr_b16 v[218:219], v7 offset:1056
    v_mfma_f32_16x16x32_bf16 a[224:227], a[112:115], a[88:91], a[224:227]
    ds_read_b64_tr_b16 v[220:221], v7 offset:2080
    v_mfma_f32_16x16x32_bf16 a[228:231], a[116:119], a[88:91], a[228:231]
    buffer_load_dwordx4 a[108:111], v18, s[20:23], s45 offen offset:3072
    ds_read_b64_tr_b16 v[222:223], v7 offset:3104
    v_mfma_f32_16x16x32_bf16 a[232:235], a[120:123], a[88:91], a[232:235]
    v_mfma_f32_16x16x32_bf16 a[236:239], a[124:127], a[88:91], a[236:239]
    v_mfma_f32_16x16x32_bf16 a[240:243], a[112:115], a[92:95], a[240:243]
    v_mfma_f32_16x16x32_bf16 a[244:247], a[116:119], a[92:95], a[244:247]
    v_mfma_f32_16x16x32_bf16 a[248:251], a[120:123], a[92:95], a[248:251]
    v_mfma_f32_16x16x32_bf16 a[252:255], a[124:127], a[92:95], a[252:255]
    v_mfma_f32_16x16x32_bf16 a[128:131], a[112:115], a[64:67], a[128:131]
    v_mfma_f32_16x16x32_bf16 a[132:135], a[116:119], a[64:67], a[132:135]
    v_mfma_f32_16x16x32_bf16 a[136:139], a[120:123], a[64:67], a[136:139]
    v_mfma_f32_16x16x32_bf16 a[140:143], a[124:127], a[64:67], a[140:143]
    v_mfma_f32_16x16x32_bf16 a[144:147], a[112:115], a[68:71], a[144:147]
    buffer_load_dwordx4 a[64:67], v14, s[92:95], s44 offen offset:0
    v_mfma_f32_16x16x32_bf16 a[148:151], a[116:119], a[68:71], a[148:151]
    v_mfma_f32_16x16x32_bf16 a[152:155], a[120:123], a[68:71], a[152:155]
    v_mfma_f32_16x16x32_bf16 a[156:159], a[124:127], a[68:71], a[156:159]
    v_mfma_f32_16x16x32_bf16 a[160:163], a[112:115], a[72:75], a[160:163]
    buffer_load_dwordx4 a[68:71], v14, s[92:95], s44 offen offset:1024
    v_mfma_f32_16x16x32_bf16 a[164:167], a[116:119], a[72:75], a[164:167]
    v_mfma_f32_16x16x32_bf16 a[168:171], a[120:123], a[72:75], a[168:171]
    v_mfma_f32_16x16x32_bf16 a[172:175], a[124:127], a[72:75], a[172:175]
    v_mfma_f32_16x16x32_bf16 a[176:179], a[112:115], a[76:79], a[176:179]
    buffer_load_dwordx4 a[72:75], v15, s[92:95], s44 offen offset:0
    v_mfma_f32_16x16x32_bf16 a[180:183], a[116:119], a[76:79], a[180:183]
    v_mfma_f32_16x16x32_bf16 a[184:187], a[120:123], a[76:79], a[184:187]
    v_mfma_f32_16x16x32_bf16 a[188:191], a[124:127], a[76:79], a[188:191]
    s_waitcnt vmcnt(15)
    v_mfma_f32_16x16x32_bf16 v[32:35], a[32:35], a[0:3], v[32:35]
    buffer_load_dwordx4 a[76:79], v15, s[92:95], s44 offen offset:1024
    v_mfma_f32_16x16x32_bf16 v[36:39], a[36:39], a[0:3], v[36:39]
    v_mfma_f32_16x16x32_bf16 v[40:43], a[40:43], a[0:3], v[40:43]
    buffer_load_dwordx4 a[80:83], v16, s[92:95], s44 offen offset:0
    v_mfma_f32_16x16x32_bf16 v[44:47], a[44:47], a[0:3], v[44:47]
    v_mfma_f32_16x16x32_bf16 v[48:51], a[32:35], a[4:7], v[48:51]
    buffer_load_dwordx4 a[84:87], v16, s[92:95], s44 offen offset:1024
    v_mfma_f32_16x16x32_bf16 v[52:55], a[36:39], a[4:7], v[52:55]
    v_mfma_f32_16x16x32_bf16 v[56:59], a[40:43], a[4:7], v[56:59]
    v_mfma_f32_16x16x32_bf16 v[60:63], a[44:47], a[4:7], v[60:63]
    buffer_load_dwordx4 a[88:91], v17, s[92:95], s44 offen offset:0
    v_mfma_f32_16x16x32_bf16 v[64:67], a[32:35], a[8:11], v[64:67]
    v_mfma_f32_16x16x32_bf16 v[68:71], a[36:39], a[8:11], v[68:71]
    v_mfma_f32_16x16x32_bf16 v[72:75], a[40:43], a[8:11], v[72:75]
    buffer_load_dwordx4 a[92:95], v17, s[92:95], s44 offen offset:1024
    s_add_u32 s44, s44, 8192
    v_mfma_f32_16x16x32_bf16 v[76:79], a[44:47], a[8:11], v[76:79]
    v_mfma_f32_16x16x32_bf16 v[80:83], a[32:35], a[12:15], v[80:83]
    v_mfma_f32_16x16x32_bf16 v[84:87], a[36:39], a[12:15], v[84:87]
    buffer_load_dwordx4 a[112:115], v19, s[20:23], s45 offen offset:0
    s_waitcnt lgkmcnt(0)
    v_mfma_f32_16x16x32_bf16 v[88:91], a[40:43], a[12:15], v[88:91]
    v_and_b32 v200, 0xffff0000, v200
    v_rcp_f32 v201, v202
    v_mfma_f32_16x16x32_bf16 v[92:95], a[44:47], a[12:15], v[92:95]
    v_and_b32 v204, 0xffff0000, v204
    v_rcp_f32 v205, v206
    s_waitcnt vmcnt(17)
    v_mfma_f32_16x16x32_bf16 v[96:99], a[32:35], a[16:19], v[96:99]
    buffer_load_dwordx4 a[116:119], v19, s[20:23], s45 offen offset:1024
    v_lshlrev_b32 v178, 16, v184
    v_and_b32 v179, 0xffff0000, v184
    v_mfma_f32_16x16x32_bf16 v[100:103], a[36:39], a[16:19], v[100:103]
    v_lshlrev_b32 v176, 16, v208
    v_and_b32 v177, 0xffff0000, v208
    v_mfma_f32_16x16x32_bf16 v[104:107], a[40:43], a[16:19], v[104:107]
    v_add_f32 v32, v32, v178
    v_add_f32 v33, v33, v179
    v_mfma_f32_16x16x32_bf16 v[108:111], a[44:47], a[16:19], v[108:111]
    buffer_load_dwordx4 a[120:123], v19, s[20:23], s45 offen offset:2048
    v_add_f32 v178, v178, v200
    v_add_f32 v179, v179, v200
    v_mfma_f32_16x16x32_bf16 v[112:115], a[32:35], a[20:23], v[112:115]
    v_mul_f32 v176, v176, v201
    v_mul_f32 v177, v177, v201
    v_mfma_f32_16x16x32_bf16 v[116:119], a[36:39], a[20:23], v[116:119]
    v_fmac_f32 v32, v178, v176
    v_fmac_f32 v33, v179, v177
    v_mfma_f32_16x16x32_bf16 v[120:123], a[40:43], a[20:23], v[120:123]
    buffer_load_dwordx4 a[124:127], v19, s[20:23], s45 offen offset:3072
    s_add_u32 s45, s45, 4096
    v_lshlrev_b32 v178, 16, v185
    v_and_b32 v179, 0xffff0000, v185
    v_mfma_f32_16x16x32_bf16 v[124:127], a[44:47], a[20:23], v[124:127]
    v_lshlrev_b32 v176, 16, v209
    v_and_b32 v177, 0xffff0000, v209
    v_mfma_f32_16x16x32_bf16 v[128:131], a[32:35], a[24:27], v[128:131]
    v_add_f32 v34, v34, v178
    v_add_f32 v35, v35, v179
    v_mfma_f32_16x16x32_bf16 v[132:135], a[36:39], a[24:27], v[132:135]
    v_add_f32 v178, v178, v200
    v_add_f32 v179, v179, v200
    v_mfma_f32_16x16x32_bf16 v[136:139], a[40:43], a[24:27], v[136:139]
    v_mul_f32 v176, v176, v201
    v_mul_f32 v177, v177, v201
    v_mfma_f32_16x16x32_bf16 v[140:143], a[44:47], a[24:27], v[140:143]
    v_fmac_f32 v34, v178, v176
    v_fmac_f32 v35, v179, v177
    v_mfma_f32_16x16x32_bf16 v[144:147], a[32:35], a[28:31], v[144:147]
    v_lshlrev_b32 v178, 16, v186
    v_and_b32 v179, 0xffff0000, v186
    v_mfma_f32_16x16x32_bf16 v[148:151], a[36:39], a[28:31], v[148:151]
    v_lshlrev_b32 v176, 16, v210
    v_and_b32 v177, 0xffff0000, v210
    v_mfma_f32_16x16x32_bf16 v[152:155], a[40:43], a[28:31], v[152:155]
    v_add_f32 v36, v36, v178
    v_add_f32 v37, v37, v179
    v_mfma_f32_16x16x32_bf16 v[156:159], a[44:47], a[28:31], v[156:159]
    v_add_f32 v178, v178, v200
    v_add_f32 v179, v179, v200
    s_waitcnt vmcnt(16)
    v_mfma_f32_16x16x32_bf16 a[192:195], a[48:51], a[16:19], a[192:195]
    buffer_load_dwordx4 a[32:35], v18, s[20:23], s45 offen offset:0
    v_mul_f32 v176, v176, v201
    v_mul_f32 v177, v177, v201
    v_mfma_f32_16x16x32_bf16 a[196:199], a[52:55], a[16:19], a[196:199]
    v_fmac_f32 v36, v178, v176
    v_fmac_f32 v37, v179, v177
    v_mfma_f32_16x16x32_bf16 a[200:203], a[56:59], a[16:19], a[200:203]
    v_lshlrev_b32 v178, 16, v187
    v_and_b32 v179, 0xffff0000, v187
    v_mfma_f32_16x16x32_bf16 a[204:207], a[60:63], a[16:19], a[204:207]
    buffer_load_dwordx4 a[36:39], v18, s[20:23], s45 offen offset:1024
    v_lshlrev_b32 v176, 16, v211
    v_and_b32 v177, 0xffff0000, v211
    v_mfma_f32_16x16x32_bf16 a[208:211], a[48:51], a[20:23], a[208:211]
    v_add_f32 v38, v38, v178
    v_add_f32 v39, v39, v179
    v_mfma_f32_16x16x32_bf16 a[212:215], a[52:55], a[20:23], a[212:215]
    v_add_f32 v178, v178, v200
    v_add_f32 v179, v179, v200
    v_mfma_f32_16x16x32_bf16 a[216:219], a[56:59], a[20:23], a[216:219]
    buffer_load_dwordx4 a[40:43], v18, s[20:23], s45 offen offset:2048
    v_mul_f32 v176, v176, v201
    v_mul_f32 v177, v177, v201
    v_mfma_f32_16x16x32_bf16 a[220:223], a[60:63], a[20:23], a[220:223]
    v_fmac_f32 v38, v178, v176
    v_fmac_f32 v39, v179, v177
    v_mfma_f32_16x16x32_bf16 a[224:227], a[48:51], a[24:27], a[224:227]
    v_lshlrev_b32 v178, 16, v188
    v_and_b32 v179, 0xffff0000, v188
    v_mfma_f32_16x16x32_bf16 a[228:231], a[52:55], a[24:27], a[228:231]
    buffer_load_dwordx4 a[44:47], v18, s[20:23], s45 offen offset:3072
    v_lshlrev_b32 v176, 16, v212
    v_and_b32 v177, 0xffff0000, v212
    v_mfma_f32_16x16x32_bf16 a[232:235], a[56:59], a[24:27], a[232:235]
    v_add_f32 v40, v40, v178
    v_add_f32 v41, v41, v179
    v_mfma_f32_16x16x32_bf16 a[236:239], a[60:63], a[24:27], a[236:239]
    v_add_f32 v178, v178, v200
    v_add_f32 v179, v179, v200
    v_mfma_f32_16x16x32_bf16 a[240:243], a[48:51], a[28:31], a[240:243]
    v_mul_f32 v176, v176, v201
    v_mul_f32 v177, v177, v201
    v_mfma_f32_16x16x32_bf16 a[244:247], a[52:55], a[28:31], a[244:247]
    v_fmac_f32 v40, v178, v176
    v_fmac_f32 v41, v179, v177
    v_mfma_f32_16x16x32_bf16 a[248:251], a[56:59], a[28:31], a[248:251]
    v_lshlrev_b32 v178, 16, v189
    v_and_b32 v179, 0xffff0000, v189
    v_mfma_f32_16x16x32_bf16 a[252:255], a[60:63], a[28:31], a[252:255]
    v_lshlrev_b32 v176, 16, v213
    v_and_b32 v177, 0xffff0000, v213
    v_mfma_f32_16x16x32_bf16 a[128:131], a[48:51], a[0:3], a[128:131]
    v_add_f32 v42, v42, v178
    v_add_f32 v43, v43, v179
    v_mfma_f32_16x16x32_bf16 a[132:135], a[52:55], a[0:3], a[132:135]
    v_add_f32 v178, v178, v200
    v_add_f32 v179, v179, v200
    v_mfma_f32_16x16x32_bf16 a[136:139], a[56:59], a[0:3], a[136:139]
    v_mul_f32 v176, v176, v201
    v_mul_f32 v177, v177, v201
    v_mfma_f32_16x16x32_bf16 a[140:143], a[60:63], a[0:3], a[140:143]
    v_fmac_f32 v42, v178, v176
    v_fmac_f32 v43, v179, v177
    v_mfma_f32_16x16x32_bf16 a[144:147], a[48:51], a[4:7], a[144:147]
    buffer_load_dwordx4 a[0:3], v14, s[92:95], s44 offen offset:0
    v_lshlrev_b32 v178, 16, v190
    v_and_b32 v179, 0xffff0000, v190
    v_mfma_f32_16x16x32_bf16 a[148:151], a[52:55], a[4:7], a[148:151]
    v_lshlrev_b32 v176, 16, v214
    v_and_b32 v177, 0xffff0000, v214
    v_mfma_f32_16x16x32_bf16 a[152:155], a[56:59], a[4:7], a[152:155]
    v_add_f32 v44, v44, v178
    v_add_f32 v45, v45, v179
    v_mfma_f32_16x16x32_bf16 a[156:159], a[60:63], a[4:7], a[156:159]
    v_add_f32 v178, v178, v200
    v_add_f32 v179, v179, v200
    v_mfma_f32_16x16x32_bf16 a[160:163], a[48:51], a[8:11], a[160:163]
    buffer_load_dwordx4 a[4:7], v14, s[92:95], s44 offen offset:1024
    v_mul_f32 v176, v176, v201
    v_mul_f32 v177, v177, v201
    v_mfma_f32_16x16x32_bf16 a[164:167], a[52:55], a[8:11], a[164:167]
    v_fmac_f32 v44, v178, v176
    v_fmac_f32 v45, v179, v177
    v_mfma_f32_16x16x32_bf16 a[168:171], a[56:59], a[8:11], a[168:171]
    v_lshlrev_b32 v178, 16, v191
    v_and_b32 v179, 0xffff0000, v191
    v_mfma_f32_16x16x32_bf16 a[172:175], a[60:63], a[8:11], a[172:175]
    v_lshlrev_b32 v176, 16, v215
    v_and_b32 v177, 0xffff0000, v215
    v_mfma_f32_16x16x32_bf16 a[176:179], a[48:51], a[12:15], a[176:179]
    buffer_load_dwordx4 a[8:11], v15, s[92:95], s44 offen offset:0
    v_add_f32 v46, v46, v178
    v_add_f32 v47, v47, v179
    v_mfma_f32_16x16x32_bf16 a[180:183], a[52:55], a[12:15], a[180:183]
    v_add_f32 v178, v178, v200
    v_add_f32 v179, v179, v200
    v_mfma_f32_16x16x32_bf16 a[184:187], a[56:59], a[12:15], a[184:187]
    v_mul_f32 v176, v176, v201
    v_mul_f32 v177, v177, v201
    v_mfma_f32_16x16x32_bf16 a[188:191], a[60:63], a[12:15], a[188:191]
    v_fmac_f32 v46, v178, v176
    v_fmac_f32 v47, v179, v177
    s_waitcnt vmcnt(15)
    v_mfma_f32_16x16x32_bf16 v[32:35], a[96:99], a[64:67], v[32:35]
    buffer_load_dwordx4 a[12:15], v15, s[92:95], s44 offen offset:1024
    v_mfma_f32_16x16x32_bf16 v[36:39], a[100:103], a[64:67], v[36:39]
    v_mfma_f32_16x16x32_bf16 v[40:43], a[104:107], a[64:67], v[40:43]
    buffer_load_dwordx4 a[16:19], v16, s[92:95], s44 offen offset:0
    v_mfma_f32_16x16x32_bf16 v[44:47], a[108:111], a[64:67], v[44:47]
    v_mfma_f32_16x16x32_bf16 v[48:51], a[96:99], a[68:71], v[48:51]
    buffer_load_dwordx4 a[20:23], v16, s[92:95], s44 offen offset:1024
    v_mfma_f32_16x16x32_bf16 v[52:55], a[100:103], a[68:71], v[52:55]
    v_mfma_f32_16x16x32_bf16 v[56:59], a[104:107], a[68:71], v[56:59]
    v_mfma_f32_16x16x32_bf16 v[60:63], a[108:111], a[68:71], v[60:63]
    buffer_load_dwordx4 a[24:27], v17, s[92:95], s44 offen offset:0
    v_mfma_f32_16x16x32_bf16 v[64:67], a[96:99], a[72:75], v[64:67]
    v_mfma_f32_16x16x32_bf16 v[68:71], a[100:103], a[72:75], v[68:71]
    v_mfma_f32_16x16x32_bf16 v[72:75], a[104:107], a[72:75], v[72:75]
    buffer_load_dwordx4 a[28:31], v17, s[92:95], s44 offen offset:1024
    s_add_u32 s44, s44, 8192
    v_mfma_f32_16x16x32_bf16 v[76:79], a[108:111], a[72:75], v[76:79]
    v_mfma_f32_16x16x32_bf16 v[80:83], a[96:99], a[76:79], v[80:83]
    v_mfma_f32_16x16x32_bf16 v[84:87], a[100:103], a[76:79], v[84:87]
    buffer_load_dwordx4 a[48:51], v19, s[20:23], s45 offen offset:0
    v_lshlrev_b32 v178, 16, v192
    v_and_b32 v179, 0xffff0000, v192
    v_mfma_f32_16x16x32_bf16 v[88:91], a[104:107], a[76:79], v[88:91]
    v_lshlrev_b32 v176, 16, v216
    v_and_b32 v177, 0xffff0000, v216
    v_mfma_f32_16x16x32_bf16 v[92:95], a[108:111], a[76:79], v[92:95]
    v_add_f32 v48, v48, v178
    v_add_f32 v49, v49, v179
    s_waitcnt vmcnt(17)
    v_mfma_f32_16x16x32_bf16 v[96:99], a[96:99], a[80:83], v[96:99]
    buffer_load_dwordx4 a[52:55], v19, s[20:23], s45 offen offset:1024
    v_add_f32 v178, v178, v204
    v_add_f32 v179, v179, v204
    v_mfma_f32_16x16x32_bf16 v[100:103], a[100:103], a[80:83], v[100:103]
    v_mul_f32 v176, v176, v205
    v_mul_f32 v177, v177, v205
    v_mfma_f32_16x16x32_bf16 v[104:107], a[104:107], a[80:83], v[104:107]
    v_fmac_f32 v48, v178, v176
    v_fmac_f32 v49, v179, v177
    v_mfma_f32_16x16x32_bf16 v[108:111], a[108:111], a[80:83], v[108:111]
    buffer_load_dwordx4 a[56:59], v19, s[20:23], s45 offen offset:2048
    v_lshlrev_b32 v178, 16, v193
    v_and_b32 v179, 0xffff0000, v193
    v_mfma_f32_16x16x32_bf16 v[112:115], a[96:99], a[84:87], v[112:115]
    v_lshlrev_b32 v176, 16, v217
    v_and_b32 v177, 0xffff0000, v217
    v_mfma_f32_16x16x32_bf16 v[116:119], a[100:103], a[84:87], v[116:119]
    v_add_f32 v50, v50, v178
    v_add_f32 v51, v51, v179
    v_mfma_f32_16x16x32_bf16 v[120:123], a[104:107], a[84:87], v[120:123]
    buffer_load_dwordx4 a[60:63], v19, s[20:23], s45 offen offset:3072
    s_add_u32 s45, s45, 4096
    v_add_f32 v178, v178, v204
    v_add_f32 v179, v179, v204
    v_mfma_f32_16x16x32_bf16 v[124:127], a[108:111], a[84:87], v[124:127]
    v_mul_f32 v176, v176, v205
    v_mul_f32 v177, v177, v205
    v_mfma_f32_16x16x32_bf16 v[128:131], a[96:99], a[88:91], v[128:131]
    v_fmac_f32 v50, v178, v176
    v_fmac_f32 v51, v179, v177
    v_mfma_f32_16x16x32_bf16 v[132:135], a[100:103], a[88:91], v[132:135]
    v_lshlrev_b32 v178, 16, v194
    v_and_b32 v179, 0xffff0000, v194
    v_mfma_f32_16x16x32_bf16 v[136:139], a[104:107], a[88:91], v[136:139]
    v_lshlrev_b32 v176, 16, v218
    v_and_b32 v177, 0xffff0000, v218
    v_mfma_f32_16x16x32_bf16 v[140:143], a[108:111], a[88:91], v[140:143]
    v_add_f32 v52, v52, v178
    v_add_f32 v53, v53, v179
    v_mfma_f32_16x16x32_bf16 v[144:147], a[96:99], a[92:95], v[144:147]
    v_add_f32 v178, v178, v204
    v_add_f32 v179, v179, v204
    v_mfma_f32_16x16x32_bf16 v[148:151], a[100:103], a[92:95], v[148:151]
    v_mul_f32 v176, v176, v205
    v_mul_f32 v177, v177, v205
    v_mfma_f32_16x16x32_bf16 v[152:155], a[104:107], a[92:95], v[152:155]
    v_fmac_f32 v52, v178, v176
    v_fmac_f32 v53, v179, v177
    v_mfma_f32_16x16x32_bf16 v[156:159], a[108:111], a[92:95], v[156:159]
    v_lshlrev_b32 v178, 16, v195
    v_and_b32 v179, 0xffff0000, v195
    s_waitcnt vmcnt(16)
    v_mfma_f32_16x16x32_bf16 a[192:195], a[112:115], a[80:83], a[192:195]
    buffer_load_dwordx4 a[96:99], v18, s[20:23], s45 offen offset:0
    v_lshlrev_b32 v176, 16, v219
    v_and_b32 v177, 0xffff0000, v219
    v_mfma_f32_16x16x32_bf16 a[196:199], a[116:119], a[80:83], a[196:199]
    v_add_f32 v54, v54, v178
    v_add_f32 v55, v55, v179
    v_mfma_f32_16x16x32_bf16 a[200:203], a[120:123], a[80:83], a[200:203]
    v_add_f32 v178, v178, v204
    v_add_f32 v179, v179, v204
    v_mfma_f32_16x16x32_bf16 a[204:207], a[124:127], a[80:83], a[204:207]
    buffer_load_dwordx4 a[100:103], v18, s[20:23], s45 offen offset:1024
    v_mul_f32 v176, v176, v205
    v_mul_f32 v177, v177, v205
    v_mfma_f32_16x16x32_bf16 a[208:211], a[112:115], a[84:87], a[208:211]
    v_fmac_f32 v54, v178, v176
    v_fmac_f32 v55, v179, v177
    v_mfma_f32_16x16x32_bf16 a[212:215], a[116:119], a[84:87], a[212:215]
    v_lshlrev_b32 v178, 16, v196
    v_and_b32 v179, 0xffff0000, v196
    v_mfma_f32_16x16x32_bf16 a[216:219], a[120:123], a[84:87], a[216:219]
    buffer_load_dwordx4 a[104:107], v18, s[20:23], s45 offen offset:2048
    v_lshlrev_b32 v176, 16, v220
    v_and_b32 v177, 0xffff0000, v220
    v_mfma_f32_16x16x32_bf16 a[220:223], a[124:127], a[84:87], a[220:223]
    v_add_f32 v56, v56, v178
    v_add_f32 v57, v57, v179
    v_mfma_f32_16x16x32_bf16 a[224:227], a[112:115], a[88:91], a[224:227]
    v_add_f32 v178, v178, v204
    v_add_f32 v179, v179, v204
    v_mfma_f32_16x16x32_bf16 a[228:231], a[116:119], a[88:91], a[228:231]
    buffer_load_dwordx4 a[108:111], v18, s[20:23], s45 offen offset:3072
    v_mul_f32 v176, v176, v205
    v_mul_f32 v177, v177, v205
    v_mfma_f32_16x16x32_bf16 a[232:235], a[120:123], a[88:91], a[232:235]
    v_fmac_f32 v56, v178, v176
    v_fmac_f32 v57, v179, v177
    v_mfma_f32_16x16x32_bf16 a[236:239], a[124:127], a[88:91], a[236:239]
    v_lshlrev_b32 v178, 16, v197
    v_and_b32 v179, 0xffff0000, v197
    v_mfma_f32_16x16x32_bf16 a[240:243], a[112:115], a[92:95], a[240:243]
    v_lshlrev_b32 v176, 16, v221
    v_and_b32 v177, 0xffff0000, v221
    v_mfma_f32_16x16x32_bf16 a[244:247], a[116:119], a[92:95], a[244:247]
    v_add_f32 v58, v58, v178
    v_add_f32 v59, v59, v179
    v_mfma_f32_16x16x32_bf16 a[248:251], a[120:123], a[92:95], a[248:251]
    v_add_f32 v178, v178, v204
    v_add_f32 v179, v179, v204
    v_mfma_f32_16x16x32_bf16 a[252:255], a[124:127], a[92:95], a[252:255]
    v_mul_f32 v176, v176, v205
    v_mul_f32 v177, v177, v205
    v_mfma_f32_16x16x32_bf16 a[128:131], a[112:115], a[64:67], a[128:131]
    v_fmac_f32 v58, v178, v176
    v_fmac_f32 v59, v179, v177
    v_mfma_f32_16x16x32_bf16 a[132:135], a[116:119], a[64:67], a[132:135]
    v_lshlrev_b32 v178, 16, v198
    v_and_b32 v179, 0xffff0000, v198
    v_mfma_f32_16x16x32_bf16 a[136:139], a[120:123], a[64:67], a[136:139]
    v_lshlrev_b32 v176, 16, v222
    v_and_b32 v177, 0xffff0000, v222
    v_mfma_f32_16x16x32_bf16 a[140:143], a[124:127], a[64:67], a[140:143]
    v_add_f32 v60, v60, v178
    v_add_f32 v61, v61, v179
    v_mfma_f32_16x16x32_bf16 a[144:147], a[112:115], a[68:71], a[144:147]
    buffer_load_dwordx4 a[64:67], v14, s[92:95], s44 offen offset:0
    v_add_f32 v178, v178, v204
    v_add_f32 v179, v179, v204
    v_mfma_f32_16x16x32_bf16 a[148:151], a[116:119], a[68:71], a[148:151]
    v_mul_f32 v176, v176, v205
    v_mul_f32 v177, v177, v205
    v_mfma_f32_16x16x32_bf16 a[152:155], a[120:123], a[68:71], a[152:155]
    v_fmac_f32 v60, v178, v176
    v_fmac_f32 v61, v179, v177
    v_mfma_f32_16x16x32_bf16 a[156:159], a[124:127], a[68:71], a[156:159]
    v_lshlrev_b32 v178, 16, v199
    v_and_b32 v179, 0xffff0000, v199
    v_mfma_f32_16x16x32_bf16 a[160:163], a[112:115], a[72:75], a[160:163]
    buffer_load_dwordx4 a[68:71], v14, s[92:95], s44 offen offset:1024
    v_lshlrev_b32 v176, 16, v223
    v_and_b32 v177, 0xffff0000, v223
    v_mfma_f32_16x16x32_bf16 a[164:167], a[116:119], a[72:75], a[164:167]
    v_add_f32 v62, v62, v178
    v_add_f32 v63, v63, v179
    v_mfma_f32_16x16x32_bf16 a[168:171], a[120:123], a[72:75], a[168:171]
    v_add_f32 v178, v178, v204
    v_add_f32 v179, v179, v204
    v_mfma_f32_16x16x32_bf16 a[172:175], a[124:127], a[72:75], a[172:175]
    v_mul_f32 v176, v176, v205
    v_mul_f32 v177, v177, v205
    v_mfma_f32_16x16x32_bf16 a[176:179], a[112:115], a[76:79], a[176:179]
    buffer_load_dwordx4 a[72:75], v15, s[92:95], s44 offen offset:0
    v_fmac_f32 v62, v178, v176
    v_fmac_f32 v63, v179, v177
    v_mfma_f32_16x16x32_bf16 a[180:183], a[116:119], a[76:79], a[180:183]
    v_mfma_f32_16x16x32_bf16 a[184:187], a[120:123], a[76:79], a[184:187]
    v_mfma_f32_16x16x32_bf16 a[188:191], a[124:127], a[76:79], a[188:191]
    s_waitcnt vmcnt(7)
    v_mfma_f32_16x16x32_bf16 a[128:131], a[48:51], a[0:3], a[128:131]
    buffer_load_dwordx4 a[76:79], v15, s[92:95], s44 offen offset:1024
    v_mfma_f32_16x16x32_bf16 a[132:135], a[52:55], a[0:3], a[132:135]
    v_mfma_f32_16x16x32_bf16 a[136:139], a[56:59], a[0:3], a[136:139]
    buffer_load_dwordx4 a[80:83], v16, s[92:95], s44 offen offset:0
    v_mfma_f32_16x16x32_bf16 a[140:143], a[60:63], a[0:3], a[140:143]
    v_mfma_f32_16x16x32_bf16 a[144:147], a[48:51], a[4:7], a[144:147]
    buffer_load_dwordx4 a[84:87], v16, s[92:95], s44 offen offset:1024
    v_mfma_f32_16x16x32_bf16 a[148:151], a[52:55], a[4:7], a[148:151]
    v_mfma_f32_16x16x32_bf16 a[152:155], a[56:59], a[4:7], a[152:155]
    buffer_load_dwordx4 a[88:91], v17, s[92:95], s44 offen offset:0
    v_mfma_f32_16x16x32_bf16 a[156:159], a[60:63], a[4:7], a[156:159]
    v_mfma_f32_16x16x32_bf16 a[160:163], a[48:51], a[8:11], a[160:163]
    buffer_load_dwordx4 a[92:95], v17, s[92:95], s44 offen offset:1024
    s_add_u32 s44, s44, 8192
    v_mfma_f32_16x16x32_bf16 a[164:167], a[52:55], a[8:11], a[164:167]
    v_mfma_f32_16x16x32_bf16 a[168:171], a[56:59], a[8:11], a[168:171]
    buffer_load_dwordx4 a[112:115], v19, s[20:23], s45 offen offset:0
    v_mfma_f32_16x16x32_bf16 a[172:175], a[60:63], a[8:11], a[172:175]
    v_mfma_f32_16x16x32_bf16 a[176:179], a[48:51], a[12:15], a[176:179]
    buffer_load_dwordx4 a[116:119], v19, s[20:23], s45 offen offset:1024
    v_mfma_f32_16x16x32_bf16 a[180:183], a[52:55], a[12:15], a[180:183]
    v_mfma_f32_16x16x32_bf16 a[184:187], a[56:59], a[12:15], a[184:187]
    buffer_load_dwordx4 a[120:123], v19, s[20:23], s45 offen offset:2048
    v_mfma_f32_16x16x32_bf16 a[188:191], a[60:63], a[12:15], a[188:191]
    v_mfma_f32_16x16x32_bf16 a[192:195], a[48:51], a[16:19], a[192:195]
    buffer_load_dwordx4 a[124:127], v19, s[20:23], s45 offen offset:3072
    s_add_u32 s45, s45, 4096
    v_mfma_f32_16x16x32_bf16 a[196:199], a[52:55], a[16:19], a[196:199]
    v_mfma_f32_16x16x32_bf16 a[200:203], a[56:59], a[16:19], a[200:203]
    v_mfma_f32_16x16x32_bf16 a[204:207], a[60:63], a[16:19], a[204:207]
    v_mfma_f32_16x16x32_bf16 a[208:211], a[48:51], a[20:23], a[208:211]
    v_mfma_f32_16x16x32_bf16 a[212:215], a[52:55], a[20:23], a[212:215]
    v_mfma_f32_16x16x32_bf16 a[216:219], a[56:59], a[20:23], a[216:219]
    v_mfma_f32_16x16x32_bf16 a[220:223], a[60:63], a[20:23], a[220:223]
    v_mfma_f32_16x16x32_bf16 a[224:227], a[48:51], a[24:27], a[224:227]
    v_mfma_f32_16x16x32_bf16 a[228:231], a[52:55], a[24:27], a[228:231]
    v_mfma_f32_16x16x32_bf16 a[232:235], a[56:59], a[24:27], a[232:235]
    v_mfma_f32_16x16x32_bf16 a[236:239], a[60:63], a[24:27], a[236:239]
    v_mfma_f32_16x16x32_bf16 a[240:243], a[48:51], a[28:31], a[240:243]
    v_mfma_f32_16x16x32_bf16 a[244:247], a[52:55], a[28:31], a[244:247]
    v_mfma_f32_16x16x32_bf16 a[248:251], a[56:59], a[28:31], a[248:251]
    v_mfma_f32_16x16x32_bf16 a[252:255], a[60:63], a[28:31], a[252:255]
    s_waitcnt vmcnt(0)
    s_barrier
    v_mfma_f32_16x16x32_bf16 a[160:163], a[112:115], a[72:75], a[160:163]
    v_mfma_f32_16x16x32_bf16 a[164:167], a[116:119], a[72:75], a[164:167]
    v_mfma_f32_16x16x32_bf16 a[168:171], a[120:123], a[72:75], a[168:171]
    v_mfma_f32_16x16x32_bf16 a[172:175], a[124:127], a[72:75], a[172:175]
    v_mfma_f32_16x16x32_bf16 a[176:179], a[112:115], a[76:79], a[176:179]
    v_mfma_f32_16x16x32_bf16 a[180:183], a[116:119], a[76:79], a[180:183]
    v_mfma_f32_16x16x32_bf16 a[184:187], a[120:123], a[76:79], a[184:187]
    v_mfma_f32_16x16x32_bf16 a[188:191], a[124:127], a[76:79], a[188:191]
    v_mfma_f32_16x16x32_bf16 a[192:195], a[112:115], a[80:83], a[192:195]
    v_mfma_f32_16x16x32_bf16 a[196:199], a[116:119], a[80:83], a[196:199]
    ds_write_b128 v21, a[160:163] offset:0
    v_mfma_f32_16x16x32_bf16 a[200:203], a[120:123], a[80:83], a[200:203]
    ds_write_b128 v21, a[164:167] offset:1024
    v_mfma_f32_16x16x32_bf16 a[204:207], a[124:127], a[80:83], a[204:207]
    ds_write_b128 v21, a[168:171] offset:2048
    v_mfma_f32_16x16x32_bf16 a[208:211], a[112:115], a[84:87], a[208:211]
    ds_write_b128 v21, a[172:175] offset:3072
    v_mfma_f32_16x16x32_bf16 a[212:215], a[116:119], a[84:87], a[212:215]
    ds_write_b128 v21, a[176:179] offset:4096
    v_mfma_f32_16x16x32_bf16 a[216:219], a[120:123], a[84:87], a[216:219]
    ds_write_b128 v21, a[180:183] offset:5120
    v_mfma_f32_16x16x32_bf16 a[220:223], a[124:127], a[84:87], a[220:223]
    ds_write_b128 v21, a[184:187] offset:6144
    v_mfma_f32_16x16x32_bf16 a[224:227], a[112:115], a[88:91], a[224:227]
    ds_write_b128 v21, a[188:191] offset:7168
    v_mfma_f32_16x16x32_bf16 a[228:231], a[116:119], a[88:91], a[228:231]
    ds_write_b128 v22, a[192:195] offset:8192
    v_mfma_f32_16x16x32_bf16 a[232:235], a[120:123], a[88:91], a[232:235]
    ds_write_b128 v22, a[196:199] offset:9216
    v_mfma_f32_16x16x32_bf16 a[236:239], a[124:127], a[88:91], a[236:239]
    ds_write_b128 v22, a[200:203] offset:10240
    v_mfma_f32_16x16x32_bf16 a[240:243], a[112:115], a[92:95], a[240:243]
    ds_write_b128 v22, a[204:207] offset:11264
    v_mfma_f32_16x16x32_bf16 a[244:247], a[116:119], a[92:95], a[244:247]
    ds_write_b128 v22, a[208:211] offset:12288
    v_mfma_f32_16x16x32_bf16 a[248:251], a[120:123], a[92:95], a[248:251]
    ds_write_b128 v22, a[212:215] offset:13312
    v_mfma_f32_16x16x32_bf16 a[252:255], a[124:127], a[92:95], a[252:255]
    ds_write_b128 v22, a[216:219] offset:14336
    v_mfma_f32_16x16x32_bf16 a[128:131], a[112:115], a[64:67], a[128:131]
    ds_write_b128 v22, a[220:223] offset:15360
    v_mfma_f32_16x16x32_bf16 a[132:135], a[116:119], a[64:67], a[132:135]
    ds_write_b128 v23, a[224:227] offset:16384
    v_mfma_f32_16x16x32_bf16 a[136:139], a[120:123], a[64:67], a[136:139]
    ds_write_b128 v23, a[228:231] offset:17408
    v_mfma_f32_16x16x32_bf16 a[140:143], a[124:127], a[64:67], a[140:143]
    ds_write_b128 v23, a[232:235] offset:18432
    v_mfma_f32_16x16x32_bf16 a[144:147], a[112:115], a[68:71], a[144:147]
    ds_write_b128 v23, a[236:239] offset:19456
    v_mfma_f32_16x16x32_bf16 a[148:151], a[116:119], a[68:71], a[148:151]
    ds_write_b128 v23, a[240:243] offset:20480
    v_mfma_f32_16x16x32_bf16 a[152:155], a[120:123], a[68:71], a[152:155]
    ds_write_b128 v23, a[244:247] offset:21504
    v_mfma_f32_16x16x32_bf16 a[156:159], a[124:127], a[68:71], a[156:159]
    ds_write_b128 v23, a[248:251] offset:22528
    v_mfma_f32_16x16x32_bf16 v[32:35], a[32:35], a[0:3], v[32:35]
    ds_write_b128 v23, a[252:255] offset:23552
    v_mfma_f32_16x16x32_bf16 v[36:39], a[36:39], a[0:3], v[36:39]
    s_waitcnt lgkmcnt(0)
    s_barrier
    v_mfma_f32_16x16x32_bf16 v[40:43], a[40:43], a[0:3], v[40:43]
    ds_read_b128 v[160:163], v20 offset:0
    v_mfma_f32_16x16x32_bf16 v[44:47], a[44:47], a[0:3], v[44:47]
    ds_read_b128 v[192:195], v20 offset:8192
    v_mfma_f32_16x16x32_bf16 v[48:51], a[32:35], a[4:7], v[48:51]
    ds_read_b128 v[224:227], v20 offset:16384
    v_mfma_f32_16x16x32_bf16 v[52:55], a[36:39], a[4:7], v[52:55]
    ds_read_b128 v[164:167], v20 offset:1024
    v_mfma_f32_16x16x32_bf16 v[56:59], a[40:43], a[4:7], v[56:59]
    ds_read_b128 v[196:199], v20 offset:9216
    v_mfma_f32_16x16x32_bf16 v[60:63], a[44:47], a[4:7], v[60:63]
    ds_read_b128 v[228:231], v20 offset:17408
    v_mfma_f32_16x16x32_bf16 v[64:67], a[32:35], a[8:11], v[64:67]
    ds_read_b128 v[168:171], v20 offset:2048
    v_mfma_f32_16x16x32_bf16 v[68:71], a[36:39], a[8:11], v[68:71]
    ds_read_b128 v[200:203], v20 offset:10240
    v_mfma_f32_16x16x32_bf16 v[72:75], a[40:43], a[8:11], v[72:75]
    ds_read_b128 v[232:235], v20 offset:18432
    v_mfma_f32_16x16x32_bf16 v[76:79], a[44:47], a[8:11], v[76:79]
    ds_read_b128 v[172:175], v20 offset:3072
    v_mfma_f32_16x16x32_bf16 v[80:83], a[32:35], a[12:15], v[80:83]
    ds_read_b128 v[204:207], v20 offset:11264
    v_mfma_f32_16x16x32_bf16 v[84:87], a[36:39], a[12:15], v[84:87]
    ds_read_b128 v[236:239], v20 offset:19456
    v_mfma_f32_16x16x32_bf16 v[88:91], a[40:43], a[12:15], v[88:91]
    ds_read_b128 v[176:179], v20 offset:4096
    v_mfma_f32_16x16x32_bf16 v[92:95], a[44:47], a[12:15], v[92:95]
    ds_read_b128 v[208:211], v20 offset:12288
    v_mfma_f32_16x16x32_bf16 v[96:99], a[32:35], a[16:19], v[96:99]
    ds_read_b128 v[240:243], v20 offset:20480
    v_mfma_f32_16x16x32_bf16 v[100:103], a[36:39], a[16:19], v[100:103]
    ds_read_b128 v[180:183], v20 offset:5120
    v_mfma_f32_16x16x32_bf16 v[104:107], a[40:43], a[16:19], v[104:107]
    ds_read_b128 v[212:215], v20 offset:13312
    v_mfma_f32_16x16x32_bf16 v[108:111], a[44:47], a[16:19], v[108:111]
    ds_read_b128 v[244:247], v20 offset:21504
    v_mfma_f32_16x16x32_bf16 v[112:115], a[32:35], a[20:23], v[112:115]
    ds_read_b128 v[184:187], v20 offset:6144
    v_mfma_f32_16x16x32_bf16 v[116:119], a[36:39], a[20:23], v[116:119]
    ds_read_b128 v[216:219], v20 offset:14336
    v_mfma_f32_16x16x32_bf16 v[120:123], a[40:43], a[20:23], v[120:123]
    ds_read_b128 v[248:251], v20 offset:22528
    v_mfma_f32_16x16x32_bf16 v[124:127], a[44:47], a[20:23], v[124:127]
    ds_read_b128 v[188:191], v20 offset:7168
    v_mfma_f32_16x16x32_bf16 v[128:131], a[32:35], a[24:27], v[128:131]
    ds_read_b128 v[220:223], v20 offset:15360
    v_mfma_f32_16x16x32_bf16 v[132:135], a[36:39], a[24:27], v[132:135]
    ds_read_b128 v[252:255], v20 offset:23552
    v_mfma_f32_16x16x32_bf16 v[136:139], a[40:43], a[24:27], v[136:139]
    s_waitcnt lgkmcnt(15)
    v_add_f32 v160, v160, v192
    v_add_f32 v161, v161, v193
    v_mfma_f32_16x16x32_bf16 v[140:143], a[44:47], a[24:27], v[140:143]
    v_add_f32 v162, v162, v194
    v_add_f32 v163, v163, v195
    v_accvgpr_read_b32 v192, a128
    v_mfma_f32_16x16x32_bf16 v[144:147], a[32:35], a[28:31], v[144:147]
    v_accvgpr_read_b32 v193, a129
    v_accvgpr_read_b32 v194, a130
    v_accvgpr_read_b32 v195, a131
    v_mfma_f32_16x16x32_bf16 v[148:151], a[36:39], a[28:31], v[148:151]
    v_add_f32 v160, v160, v224
    v_add_f32 v161, v161, v225
    v_add_f32 v162, v162, v226
    v_mfma_f32_16x16x32_bf16 v[152:155], a[40:43], a[28:31], v[152:155]
    v_add_f32 v163, v163, v227
    v_add_f32 v160, v160, v192
    v_add_f32 v161, v161, v193
    v_mfma_f32_16x16x32_bf16 v[156:159], a[44:47], a[28:31], v[156:159]
    v_add_f32 v162, v162, v194
    v_add_f32 v163, v163, v195
    v_cvt_pk_bf16_f32 v224, v160, v161
    v_mfma_f32_16x16x32_bf16 v[64:67], a[96:99], a[72:75], v[64:67]
    v_cvt_pk_bf16_f32 v225, v162, v163
    s_waitcnt lgkmcnt(15)
    v_add_f32 v164, v164, v196
    v_mfma_f32_16x16x32_bf16 v[68:71], a[100:103], a[72:75], v[68:71]
    v_add_f32 v165, v165, v197
    v_add_f32 v166, v166, v198
    v_add_f32 v167, v167, v199
    v_mfma_f32_16x16x32_bf16 v[72:75], a[104:107], a[72:75], v[72:75]
    v_accvgpr_read_b32 v196, a132
    v_accvgpr_read_b32 v197, a133
    v_accvgpr_read_b32 v198, a134
    v_mfma_f32_16x16x32_bf16 v[76:79], a[108:111], a[72:75], v[76:79]
    v_accvgpr_read_b32 v199, a135
    v_add_f32 v164, v164, v228
    v_add_f32 v165, v165, v229
    v_mfma_f32_16x16x32_bf16 v[80:83], a[96:99], a[76:79], v[80:83]
    v_add_f32 v166, v166, v230
    v_add_f32 v167, v167, v231
    v_add_f32 v164, v164, v196
    v_mfma_f32_16x16x32_bf16 v[84:87], a[100:103], a[76:79], v[84:87]
    v_add_f32 v165, v165, v197
    v_add_f32 v166, v166, v198
    v_add_f32 v167, v167, v199
    v_mfma_f32_16x16x32_bf16 v[88:91], a[104:107], a[76:79], v[88:91]
    v_cvt_pk_bf16_f32 v226, v164, v165
    v_mov_b32 v227, v29
    buffer_store_dwordx4 v[224:227], v11, s[28:31], s56 offen offset:0 sc1
    v_mfma_f32_16x16x32_bf16 v[92:95], a[108:111], a[76:79], v[92:95]
    v_cvt_pk_bf16_f32 v228, v166, v167
    s_waitcnt lgkmcnt(15)
    v_add_f32 v168, v168, v200
    v_mfma_f32_16x16x32_bf16 v[96:99], a[96:99], a[80:83], v[96:99]
    v_add_f32 v169, v169, v201
    v_add_f32 v170, v170, v202
    v_add_f32 v171, v171, v203
    v_mfma_f32_16x16x32_bf16 v[100:103], a[100:103], a[80:83], v[100:103]
    v_accvgpr_read_b32 v200, a136
    v_accvgpr_read_b32 v201, a137
    v_accvgpr_read_b32 v202, a138
    v_mfma_f32_16x16x32_bf16 v[104:107], a[104:107], a[80:83], v[104:107]
    v_accvgpr_read_b32 v203, a139
    v_add_f32 v168, v168, v232
    v_add_f32 v169, v169, v233
    v_mfma_f32_16x16x32_bf16 v[108:111], a[108:111], a[80:83], v[108:111]
    v_add_f32 v170, v170, v234
    v_add_f32 v171, v171, v235
    v_add_f32 v168, v168, v200
    v_mfma_f32_16x16x32_bf16 v[112:115], a[96:99], a[84:87], v[112:115]
    v_add_f32 v169, v169, v201
    v_add_f32 v170, v170, v202
    v_add_f32 v171, v171, v203
    v_mfma_f32_16x16x32_bf16 v[116:119], a[100:103], a[84:87], v[116:119]
    v_cvt_pk_bf16_f32 v229, v168, v169
    v_cvt_pk_bf16_f32 v230, v170, v171
    v_mov_b32 v231, v29
    v_mfma_f32_16x16x32_bf16 v[120:123], a[104:107], a[84:87], v[120:123]
    buffer_store_dwordx4 v[228:231], v11, s[28:31], s56 offen offset:1024 sc1
    s_waitcnt lgkmcnt(12)
    v_add_f32 v172, v172, v204
    v_mfma_f32_16x16x32_bf16 v[124:127], a[108:111], a[84:87], v[124:127]
    v_add_f32 v173, v173, v205
    v_add_f32 v174, v174, v206
    v_add_f32 v175, v175, v207
    v_mfma_f32_16x16x32_bf16 v[128:131], a[96:99], a[88:91], v[128:131]
    v_accvgpr_read_b32 v204, a140
    v_accvgpr_read_b32 v205, a141
    v_accvgpr_read_b32 v206, a142
    v_mfma_f32_16x16x32_bf16 v[132:135], a[100:103], a[88:91], v[132:135]
    v_accvgpr_read_b32 v207, a143
    v_add_f32 v172, v172, v236
    v_add_f32 v173, v173, v237
    v_mfma_f32_16x16x32_bf16 v[136:139], a[104:107], a[88:91], v[136:139]
    v_add_f32 v174, v174, v238
    v_add_f32 v175, v175, v239
    v_add_f32 v172, v172, v204
    v_mfma_f32_16x16x32_bf16 v[140:143], a[108:111], a[88:91], v[140:143]
    v_add_f32 v173, v173, v205
    v_add_f32 v174, v174, v206
    v_add_f32 v175, v175, v207
    v_mfma_f32_16x16x32_bf16 v[144:147], a[96:99], a[92:95], v[144:147]
    v_cvt_pk_bf16_f32 v232, v172, v173
    v_cvt_pk_bf16_f32 v233, v174, v175
    s_waitcnt lgkmcnt(9)
    v_mfma_f32_16x16x32_bf16 v[148:151], a[100:103], a[92:95], v[148:151]
    v_add_f32 v176, v176, v208
    v_add_f32 v177, v177, v209
    v_add_f32 v178, v178, v210
    v_mfma_f32_16x16x32_bf16 v[152:155], a[104:107], a[92:95], v[152:155]
    v_add_f32 v179, v179, v211
    v_accvgpr_read_b32 v208, a144
    v_accvgpr_read_b32 v209, a145
    v_mfma_f32_16x16x32_bf16 v[156:159], a[108:111], a[92:95], v[156:159]
    v_accvgpr_read_b32 v210, a146
    v_accvgpr_read_b32 v211, a147
    v_add_f32 v176, v176, v240
    v_mfma_f32_16x16x32_bf16 v[32:35], a[96:99], a[64:67], v[32:35]
    v_add_f32 v177, v177, v241
    v_add_f32 v178, v178, v242
    v_add_f32 v179, v179, v243
    v_mfma_f32_16x16x32_bf16 v[36:39], a[100:103], a[64:67], v[36:39]
    v_add_f32 v176, v176, v208
    v_add_f32 v177, v177, v209
    v_add_f32 v178, v178, v210
    v_mfma_f32_16x16x32_bf16 v[40:43], a[104:107], a[64:67], v[40:43]
    v_add_f32 v179, v179, v211
    v_cvt_pk_bf16_f32 v234, v176, v177
    v_mov_b32 v235, v29
    v_mfma_f32_16x16x32_bf16 v[44:47], a[108:111], a[64:67], v[44:47]
    buffer_store_dwordx4 v[232:235], v11, s[28:31], s56 offen offset:2048 sc1
    v_cvt_pk_bf16_f32 v236, v178, v179
    s_waitcnt lgkmcnt(6)
    v_mfma_f32_16x16x32_bf16 v[48:51], a[96:99], a[68:71], v[48:51]
    v_add_f32 v180, v180, v212
    v_add_f32 v181, v181, v213
    v_add_f32 v182, v182, v214
    v_mfma_f32_16x16x32_bf16 v[52:55], a[100:103], a[68:71], v[52:55]
    v_add_f32 v183, v183, v215
    v_accvgpr_read_b32 v212, a148
    v_accvgpr_read_b32 v213, a149
    v_mfma_f32_16x16x32_bf16 v[56:59], a[104:107], a[68:71], v[56:59]
    v_accvgpr_read_b32 v214, a150
    v_accvgpr_read_b32 v215, a151
    v_add_f32 v180, v180, v244
    v_mfma_f32_16x16x32_bf16 v[60:63], a[108:111], a[68:71], v[60:63]
    v_add_f32 v181, v181, v245
    v_add_f32 v182, v182, v246
    v_add_f32 v183, v183, v247
    v_add_f32 v180, v180, v212
    v_add_f32 v181, v181, v213
    v_add_f32 v182, v182, v214
    v_add_f32 v183, v183, v215
    v_cvt_pk_bf16_f32 v237, v180, v181
    v_cvt_pk_bf16_f32 v238, v182, v183
    v_mov_b32 v239, v29
    buffer_store_dwordx4 v[236:239], v11, s[28:31], s56 offen offset:3072 sc1
    s_waitcnt lgkmcnt(3)
    v_add_f32 v184, v184, v216
    v_add_f32 v185, v185, v217
    v_add_f32 v186, v186, v218
    v_add_f32 v187, v187, v219
    v_accvgpr_read_b32 v216, a152
    v_accvgpr_read_b32 v217, a153
    v_accvgpr_read_b32 v218, a154
    v_accvgpr_read_b32 v219, a155
    v_add_f32 v184, v184, v248
    v_add_f32 v185, v185, v249
    v_add_f32 v186, v186, v250
    v_add_f32 v187, v187, v251
    v_add_f32 v184, v184, v216
    v_add_f32 v185, v185, v217
    v_add_f32 v186, v186, v218
    v_add_f32 v187, v187, v219
    v_cvt_pk_bf16_f32 v240, v184, v185
    v_cvt_pk_bf16_f32 v241, v186, v187
    s_waitcnt lgkmcnt(0)
    v_add_f32 v188, v188, v220
    v_add_f32 v189, v189, v221
    v_add_f32 v190, v190, v222
    v_add_f32 v191, v191, v223
    v_accvgpr_read_b32 v220, a156
    v_accvgpr_read_b32 v221, a157
    v_accvgpr_read_b32 v222, a158
    v_accvgpr_read_b32 v223, a159
    v_add_f32 v188, v188, v252
    v_add_f32 v189, v189, v253
    v_add_f32 v190, v190, v254
    v_add_f32 v191, v191, v255
    v_add_f32 v188, v188, v220
    v_add_f32 v189, v189, v221
    v_add_f32 v190, v190, v222
    v_add_f32 v191, v191, v223
    v_cvt_pk_bf16_f32 v242, v188, v189
    v_mov_b32 v243, v29
    buffer_store_dwordx4 v[240:243], v10, s[28:31], s56 offen offset:0 sc1
    v_cvt_pk_bf16_f32 v244, v190, v191
    v_mov_b32 v247, v29
    buffer_store_dwordx4 v[244:247], v10, s[28:31], s56 offen offset:1024 sc1
    s_barrier
    ds_write_b128 v21, v[64:67] offset:0
    ds_write_b128 v21, v[68:71] offset:1024
    ds_write_b128 v21, v[72:75] offset:2048
    ds_write_b128 v21, v[76:79] offset:3072
    ds_write_b128 v21, v[80:83] offset:4096
    ds_write_b128 v21, v[84:87] offset:5120
    ds_write_b128 v21, v[88:91] offset:6144
    ds_write_b128 v21, v[92:95] offset:7168
    ds_write_b128 v22, v[96:99] offset:8192
    ds_write_b128 v22, v[100:103] offset:9216
    ds_write_b128 v22, v[104:107] offset:10240
    ds_write_b128 v22, v[108:111] offset:11264
    ds_write_b128 v22, v[112:115] offset:12288
    ds_write_b128 v22, v[116:119] offset:13312
    ds_write_b128 v22, v[120:123] offset:14336
    ds_write_b128 v22, v[124:127] offset:15360
    ds_write_b128 v23, v[128:131] offset:16384
    ds_write_b128 v23, v[132:135] offset:17408
    ds_write_b128 v23, v[136:139] offset:18432
    ds_write_b128 v23, v[140:143] offset:19456
    ds_write_b128 v23, v[144:147] offset:20480
    ds_write_b128 v23, v[148:151] offset:21504
    ds_write_b128 v23, v[152:155] offset:22528
    ds_write_b128 v23, v[156:159] offset:23552
    s_waitcnt lgkmcnt(0)
    s_barrier
    ds_read_b128 v[64:67], v20 offset:0
    ds_read_b128 v[96:99], v20 offset:8192
    ds_read_b128 v[128:131], v20 offset:16384
    ds_read_b128 v[68:71], v20 offset:1024
    ds_read_b128 v[100:103], v20 offset:9216
    ds_read_b128 v[132:135], v20 offset:17408
    ds_read_b128 v[72:75], v20 offset:2048
    ds_read_b128 v[104:107], v20 offset:10240
    ds_read_b128 v[136:139], v20 offset:18432
    ds_read_b128 v[76:79], v20 offset:3072
    ds_read_b128 v[108:111], v20 offset:11264
    ds_read_b128 v[140:143], v20 offset:19456
    ds_read_b128 v[80:83], v20 offset:4096
    ds_read_b128 v[112:115], v20 offset:12288
    ds_read_b128 v[144:147], v20 offset:20480
    ds_read_b128 v[84:87], v20 offset:5120
    ds_read_b128 v[116:119], v20 offset:13312
    ds_read_b128 v[148:151], v20 offset:21504
    ds_read_b128 v[88:91], v20 offset:6144
    ds_read_b128 v[120:123], v20 offset:14336
    ds_read_b128 v[152:155], v20 offset:22528
    ds_read_b128 v[92:95], v20 offset:7168
    ds_read_b128 v[124:127], v20 offset:15360
    ds_read_b128 v[156:159], v20 offset:23552
    buffer_load_dwordx4 a[0:3], v11, s[28:31], s57 offen offset:0 sc1
    buffer_load_dwordx4 a[4:7], v11, s[28:31], s57 offen offset:1024 sc1
    buffer_load_dwordx4 a[8:11], v11, s[28:31], s57 offen offset:2048 sc1
    buffer_load_dwordx4 a[12:15], v11, s[28:31], s57 offen offset:3072 sc1
    buffer_load_dwordx4 a[16:19], v10, s[28:31], s57 offen offset:0 sc1
    buffer_load_dwordx4 a[20:23], v10, s[28:31], s57 offen offset:1024 sc1
    s_waitcnt lgkmcnt(15)
    v_add_f32 v64, v64, v96
    v_add_f32 v65, v65, v97
    v_add_f32 v66, v66, v98
    v_add_f32 v67, v67, v99
    v_add_f32 v32, v32, v128
    v_add_f32 v33, v33, v129
    v_add_f32 v34, v34, v130
    v_add_f32 v35, v35, v131
    v_add_f32 v32, v32, v64
    v_add_f32 v33, v33, v65
    v_add_f32 v34, v34, v66
    v_add_f32 v35, v35, v67
    s_waitcnt lgkmcnt(15)
    v_add_f32 v68, v68, v100
    v_add_f32 v69, v69, v101
    v_add_f32 v70, v70, v102
    v_add_f32 v71, v71, v103
    v_add_f32 v36, v36, v132
    v_add_f32 v37, v37, v133
    v_add_f32 v38, v38, v134
    v_add_f32 v39, v39, v135
    v_add_f32 v36, v36, v68
    v_add_f32 v37, v37, v69
    v_add_f32 v38, v38, v70
    v_add_f32 v39, v39, v71
    s_waitcnt lgkmcnt(15)
    v_add_f32 v72, v72, v104
    v_add_f32 v73, v73, v105
    v_add_f32 v74, v74, v106
    v_add_f32 v75, v75, v107
    v_add_f32 v40, v40, v136
    v_add_f32 v41, v41, v137
    v_add_f32 v42, v42, v138
    v_add_f32 v43, v43, v139
    v_add_f32 v40, v40, v72
    v_add_f32 v41, v41, v73
    v_add_f32 v42, v42, v74
    v_add_f32 v43, v43, v75
    s_waitcnt lgkmcnt(12)
    v_add_f32 v76, v76, v108
    v_add_f32 v77, v77, v109
    v_add_f32 v78, v78, v110
    v_add_f32 v79, v79, v111
    v_add_f32 v44, v44, v140
    v_add_f32 v45, v45, v141
    v_add_f32 v46, v46, v142
    v_add_f32 v47, v47, v143
    v_add_f32 v44, v44, v76
    v_add_f32 v45, v45, v77
    v_add_f32 v46, v46, v78
    v_add_f32 v47, v47, v79
    s_waitcnt lgkmcnt(9)
    v_add_f32 v80, v80, v112
    v_add_f32 v81, v81, v113
    v_add_f32 v82, v82, v114
    v_add_f32 v83, v83, v115
    v_add_f32 v48, v48, v144
    v_add_f32 v49, v49, v145
    v_add_f32 v50, v50, v146
    v_add_f32 v51, v51, v147
    v_add_f32 v48, v48, v80
    v_add_f32 v49, v49, v81
    v_add_f32 v50, v50, v82
    v_add_f32 v51, v51, v83
    s_waitcnt lgkmcnt(6)
    v_add_f32 v84, v84, v116
    v_add_f32 v85, v85, v117
    v_add_f32 v86, v86, v118
    v_add_f32 v87, v87, v119
    v_add_f32 v52, v52, v148
    v_add_f32 v53, v53, v149
    v_add_f32 v54, v54, v150
    v_add_f32 v55, v55, v151
    v_add_f32 v52, v52, v84
    v_add_f32 v53, v53, v85
    v_add_f32 v54, v54, v86
    v_add_f32 v55, v55, v87
    s_waitcnt lgkmcnt(3)
    v_add_f32 v88, v88, v120
    v_add_f32 v89, v89, v121
    v_add_f32 v90, v90, v122
    v_add_f32 v91, v91, v123
    v_add_f32 v56, v56, v152
    v_add_f32 v57, v57, v153
    v_add_f32 v58, v58, v154
    v_add_f32 v59, v59, v155
    v_add_f32 v56, v56, v88
    v_add_f32 v57, v57, v89
    v_add_f32 v58, v58, v90
    v_add_f32 v59, v59, v91
    s_waitcnt lgkmcnt(0)
    v_add_f32 v92, v92, v124
    v_add_f32 v93, v93, v125
    v_add_f32 v94, v94, v126
    v_add_f32 v95, v95, v127
    v_add_f32 v60, v60, v156
    v_add_f32 v61, v61, v157
    v_add_f32 v62, v62, v158
    v_add_f32 v63, v63, v159
    v_add_f32 v60, v60, v92
    v_add_f32 v61, v61, v93
    v_add_f32 v62, v62, v94
    v_add_f32 v63, v63, v95
    s_mov_b32 s53, 0
    s_waitcnt vmcnt(0)
Lb_chk:
    v_accvgpr_read_b32 v64, a3
    v_accvgpr_read_b32 v65, a7
    v_accvgpr_read_b32 v66, a11
    v_accvgpr_read_b32 v67, a15
    v_accvgpr_read_b32 v68, a19
    v_accvgpr_read_b32 v69, a23
    v_xor_b32 v64, v64, v29
    v_xor_b32 v65, v65, v29
    v_xor_b32 v66, v66, v29
    v_xor_b32 v67, v67, v29
    v_xor_b32 v68, v68, v29
    v_xor_b32 v69, v69, v29
    v_or3_b32 v64, v64, v65, v66
    v_or3_b32 v67, v67, v68, v69
    v_or_b32 v64, v64, v67
    v_cmp_ne_u32 vcc, 0, v64
    s_cbranch_vccnz Lb_spin
Lb_go:
    v_accvgpr_read_b32 v64, a0
    v_accvgpr_read_b32 v65, a1
    v_accvgpr_read_b32 v66, a2
    v_accvgpr_read_b32 v67, a4
    v_lshlrev_b32 v68, 16, v64
    v_and_b32 v69, 0xffff0000, v64
    v_lshlrev_b32 v70, 16, v65
    v_and_b32 v71, 0xffff0000, v65
    v_lshlrev_b32 v72, 16, v66
    v_and_b32 v73, 0xffff0000, v66
    v_lshlrev_b32 v74, 16, v67
    v_and_b32 v75, 0xffff0000, v67
    v_add_f32 v32, v32, v68
    v_add_f32 v33, v33, v69
    v_add_f32 v34, v34, v70
    v_add_f32 v35, v35, v71
    v_add_f32 v36, v36, v72
    v_add_f32 v37, v37, v73
    v_add_f32 v38, v38, v74
    v_add_f32 v39, v39, v75
    s_nop 0
    v_permlane16_swap_b32 v32, v36
    v_permlane16_swap_b32 v33, v37
    v_permlane16_swap_b32 v34, v38
    v_permlane16_swap_b32 v35, v39
    v_cvt_pk_bf16_f32 v32, v32, v33
    v_cvt_pk_bf16_f32 v33, v34, v35
    v_cvt_pk_bf16_f32 v34, v36, v37
    v_cvt_pk_bf16_f32 v35, v38, v39
    buffer_store_dwordx4 v[32:35], v3, s[40:43], s50 offen offset:0
    v_accvgpr_read_b32 v64, a5
    v_accvgpr_read_b32 v65, a6
    v_accvgpr_read_b32 v66, a8
    v_accvgpr_read_b32 v67, a9
    v_lshlrev_b32 v68, 16, v64
    v_and_b32 v69, 0xffff0000, v64
    v_lshlrev_b32 v70, 16, v65
    v_and_b32 v71, 0xffff0000, v65
    v_lshlrev_b32 v72, 16, v66
    v_and_b32 v73, 0xffff0000, v66
    v_lshlrev_b32 v74, 16, v67
    v_and_b32 v75, 0xffff0000, v67
    v_add_f32 v40, v40, v68
    v_add_f32 v41, v41, v69
    v_add_f32 v42, v42, v70
    v_add_f32 v43, v43, v71
    v_add_f32 v44, v44, v72
    v_add_f32 v45, v45, v73
    v_add_f32 v46, v46, v74
    v_add_f32 v47, v47, v75
    s_nop 0
    v_permlane16_swap_b32 v40, v44
    v_permlane16_swap_b32 v41, v45
    v_permlane16_swap_b32 v42, v46
    v_permlane16_swap_b32 v43, v47
    v_cvt_pk_bf16_f32 v40, v40, v41
    v_cvt_pk_bf16_f32 v41, v42, v43
    v_cvt_pk_bf16_f32 v42, v44, v45
    v_cvt_pk_bf16_f32 v43, v46, v47
    buffer_store_dwordx4 v[40:43], v3, s[40:43], s50 offen offset:64
    v_accvgpr_read_b32 v64, a10
    v_accvgpr_read_b32 v65, a12
    v_accvgpr_read_b32 v66, a13
    v_accvgpr_read_b32 v67, a14
    v_lshlrev_b32 v68, 16, v64
    v_and_b32 v69, 0xffff0000, v64
    v_lshlrev_b32 v70, 16, v65
    v_and_b32 v71, 0xffff0000, v65
    v_lshlrev_b32 v72, 16, v66
    v_and_b32 v73, 0xffff0000, v66
    v_lshlrev_b32 v74, 16, v67
    v_and_b32 v75, 0xffff0000, v67
    v_add_f32 v48, v48, v68
    v_add_f32 v49, v49, v69
    v_add_f32 v50, v50, v70
    v_add_f32 v51, v51, v71
    v_add_f32 v52, v52, v72
    v_add_f32 v53, v53, v73
    v_add_f32 v54, v54, v74
    v_add_f32 v55, v55, v75
    s_nop 0
    v_permlane16_swap_b32 v48, v52
    v_permlane16_swap_b32 v49, v53
    v_permlane16_swap_b32 v50, v54
    v_permlane16_swap_b32 v51, v55
    v_cvt_pk_bf16_f32 v48, v48, v49
    v_cvt_pk_bf16_f32 v49, v50, v51
    v_cvt_pk_bf16_f32 v50, v52, v53
    v_cvt_pk_bf16_f32 v51, v54, v55
    buffer_store_dwordx4 v[48:51], v3, s[40:43], s51 offen offset:0
    v_accvgpr_read_b32 v64, a16
    v_accvgpr_read_b32 v65, a17
    v_accvgpr_read_b32 v66, a18
    v_accvgpr_read_b32 v67, a20
    v_lshlrev_b32 v68, 16, v64
    v_and_b32 v69, 0xffff0000, v64
    v_lshlrev_b32 v70, 16, v65
    v_and_b32 v71, 0xffff0000, v65
    v_lshlrev_b32 v72, 16, v66
    v_and_b32 v73, 0xffff0000, v66
    v_lshlrev_b32 v74, 16, v67
    v_and_b32 v75, 0xffff0000, v67
    v_add_f32 v56, v56, v68
    v_add_f32 v57, v57, v69
    v_add_f32 v58, v58, v70
    v_add_f32 v59, v59, v71
    v_add_f32 v60, v60, v72
    v_add_f32 v61, v61, v73
    v_add_f32 v62, v62, v74
    v_add_f32 v63, v63, v75
    s_nop 0
    v_permlane16_swap_b32 v56, v60
    v_permlane16_swap_b32 v57, v61
    v_permlane16_swap_b32 v58, v62
    v_permlane16_swap_b32 v59, v63
    v_cvt_pk_bf16_f32 v56, v56, v57
    v_cvt_pk_bf16_f32 v57, v58, v59
    v_cvt_pk_bf16_f32 v58, v60, v61
    v_cvt_pk_bf16_f32 v59, v62, v63
    buffer_store_dwordx4 v[56:59], v3, s[40:43], s51 offen offset:64
    s_endpgm
Lb_spin:
    s_add_u32 s53, s53, 1
    s_cmp_gt_u32 s53, 0x40000
    s_cbranch_scc1 Lb_go
    s_sleep 2
    buffer_load_dwordx4 a[0:3], v11, s[28:31], s57 offen offset:0 sc1
    buffer_load_dwordx4 a[4:7], v11, s[28:31], s57 offen offset:1024 sc1
    buffer_load_dwordx4 a[8:11], v11, s[28:31], s57 offen offset:2048 sc1
    buffer_load_dwordx4 a[12:15], v11, s[28:31], s57 offen offset:3072 sc1
    buffer_load_dwordx4 a[16:19], v10, s[28:31], s57 offen offset:0 sc1
    buffer_load_dwordx4 a[20:23], v10, s[28:31], s57 offen offset:1024 sc1
    s_waitcnt vmcnt(0)
    s_branch Lb_chk
La_bodyB:
    s_waitcnt lgkmcnt(0)
    s_barrier
    v_mfma_f32_16x16x32_bf16 a[160:163], a[0:3], a[188:191], 0
    buffer_load_dword a254, v26, s[72:75], s76 offen
    s_add_u32 s76, s76, s77
    v_mfma_f32_16x16x32_bf16 a[164:167], a[4:7], a[188:191], 0
    ds_read_b128 a[88:91], v23 offset:0
    v_mfma_f32_16x16x32_bf16 a[168:171], a[8:11], a[188:191], 0
    v_accvgpr_read_b32 v230, a192
    v_lshlrev_b32 v230, 16, v230
    v_mfma_f32_16x16x32_bf16 a[172:175], a[12:15], a[188:191], 0
    ds_read_b128 a[92:95], v23 offset:2048
    s_nop 0
    v_readfirstlane_b32 s55, v230
    v_mfma_f32_16x16x32_bf16 a[176:179], a[16:19], a[188:191], 0
    v_mov_b32 v226, 0
    v_mov_b32 v228, 0
    v_mfma_f32_16x16x32_bf16 a[180:183], a[20:23], a[188:191], 0
    ds_read_b128 a[96:99], v23 offset:4096
    v_mfma_f32_16x16x32_bf16 a[184:187], a[24:27], a[188:191], 0
    v_mov_b32 v224, s55
    v_accvgpr_read_b32 v231, a192
    v_mfma_f32_16x16x32_bf16 v[32:35], a[0:3], a[28:31], v[32:35]
    ds_read_b128 a[100:103], v23 offset:6144
    v_lshlrev_b32 v230, 16, v231
    v_mfma_f32_16x16x32_bf16 v[36:39], a[0:3], a[32:35], v[36:39]
    v_and_b32 v231, 0xffff0000, v231
    v_sub_f32 v230, v230, v224
    v_mfma_f32_16x16x32_bf16 v[40:43], a[0:3], a[36:39], v[40:43]
    ds_read_b128 a[104:107], v23 offset:8192
    v_sub_f32 v231, v231, v224
    v_mfma_f32_16x16x32_bf16 v[44:47], a[0:3], a[40:43], v[44:47]
    v_add_f32 v226, v226, v230
    v_fmac_f32 v228, v230, v230
    v_mfma_f32_16x16x32_bf16 v[48:51], a[0:3], a[44:47], v[48:51]
    ds_read_b128 a[108:111], v23 offset:10240
    v_add_f32 v226, v226, v231
    v_mfma_f32_16x16x32_bf16 v[52:55], a[0:3], a[48:51], v[52:55]
    v_fmac_f32 v228, v231, v231
    v_accvgpr_read_b32 v233, a193
    v_mfma_f32_16x16x32_bf16 v[56:59], a[0:3], a[52:55], v[56:59]
    ds_read_b128 a[112:115], v23 offset:12288
    v_lshlrev_b32 v232, 16, v233
    v_mfma_f32_16x16x32_bf16 v[60:63], a[0:3], a[56:59], v[60:63]
    v_and_b32 v233, 0xffff0000, v233
    v_mfma_f32_16x16x32_bf16 v[64:67], a[4:7], a[28:31], v[64:67]
    ds_read_b128 a[116:119], v23 offset:14336
    v_sub_f32 v232, v232, v224
    v_mfma_f32_16x16x32_bf16 v[68:71], a[4:7], a[32:35], v[68:71]
    v_sub_f32 v233, v233, v224
    v_add_f32 v226, v226, v232
    v_mfma_f32_16x16x32_bf16 v[72:75], a[4:7], a[36:39], v[72:75]
    ds_read_b64_tr_b16 a[60:61], v20 offset:16384
    v_fmac_f32 v228, v232, v232
    v_mfma_f32_16x16x32_bf16 v[76:79], a[4:7], a[40:43], v[76:79]
    v_add_f32 v226, v226, v233
    v_fmac_f32 v228, v233, v233
    v_mfma_f32_16x16x32_bf16 v[80:83], a[4:7], a[44:47], v[80:83]
    ds_read_b64_tr_b16 a[62:63], v20 offset:18176
    v_accvgpr_read_b32 v231, a194
    v_mfma_f32_16x16x32_bf16 v[84:87], a[4:7], a[48:51], v[84:87]
    v_lshlrev_b32 v230, 16, v231
    v_and_b32 v231, 0xffff0000, v231
    v_mfma_f32_16x16x32_bf16 v[88:91], a[4:7], a[52:55], v[88:91]
    ds_read_b64_tr_b16 a[64:65], v20 offset:16416
    v_sub_f32 v230, v230, v224
    v_mfma_f32_16x16x32_bf16 v[92:95], a[4:7], a[56:59], v[92:95]
    ds_read_b64_tr_b16 a[66:67], v20 offset:18208
    v_mfma_f32_16x16x32_bf16 v[96:99], a[8:11], a[28:31], v[96:99]
    v_sub_f32 v231, v231, v224
    v_add_f32 v226, v226, v230
    v_mfma_f32_16x16x32_bf16 v[100:103], a[8:11], a[32:35], v[100:103]
    ds_read_b64_tr_b16 a[68:69], v20 offset:16448
    v_fmac_f32 v228, v230, v230
    v_mfma_f32_16x16x32_bf16 v[104:107], a[8:11], a[36:39], v[104:107]
    v_add_f32 v226, v226, v231
    v_fmac_f32 v228, v231, v231
    v_mfma_f32_16x16x32_bf16 v[108:111], a[8:11], a[40:43], v[108:111]
    ds_read_b64_tr_b16 a[70:71], v20 offset:18240
    v_accvgpr_read_b32 v233, a195
    v_mfma_f32_16x16x32_bf16 v[112:115], a[8:11], a[44:47], v[112:115]
    v_lshlrev_b32 v232, 16, v233
    v_and_b32 v233, 0xffff0000, v233
    v_mfma_f32_16x16x32_bf16 v[116:119], a[8:11], a[48:51], v[116:119]
    ds_read_b64_tr_b16 a[72:73], v20 offset:24576
    v_sub_f32 v232, v232, v224
    v_mfma_f32_16x16x32_bf16 v[120:123], a[8:11], a[52:55], v[120:123]
    v_sub_f32 v233, v233, v224
    v_add_f32 v226, v226, v232
    v_mfma_f32_16x16x32_bf16 v[124:127], a[8:11], a[56:59], v[124:127]
    ds_read_b64_tr_b16 a[74:75], v20 offset:26368
    v_fmac_f32 v228, v232, v232
    v_mfma_f32_16x16x32_bf16 v[128:131], a[12:15], a[28:31], v[128:131]
    v_add_f32 v226, v226, v233
    v_mfma_f32_16x16x32_bf16 v[132:135], a[12:15], a[32:35], v[132:135]
    ds_read_b64_tr_b16 a[76:77], v20 offset:24608
    v_fmac_f32 v228, v233, v233
    v_mfma_f32_16x16x32_bf16 v[136:139], a[12:15], a[36:39], v[136:139]
    v_accvgpr_read_b32 v231, a196
    v_lshlrev_b32 v230, 16, v231
    v_mfma_f32_16x16x32_bf16 v[140:143], a[12:15], a[40:43], v[140:143]
    ds_read_b64_tr_b16 a[78:79], v20 offset:26400
    v_and_b32 v231, 0xffff0000, v231
    v_mfma_f32_16x16x32_bf16 v[144:147], a[12:15], a[44:47], v[144:147]
    v_sub_f32 v230, v230, v224
    v_sub_f32 v231, v231, v224
    v_mfma_f32_16x16x32_bf16 v[148:151], a[12:15], a[48:51], v[148:151]
    ds_read_b64_tr_b16 a[80:81], v20 offset:24640
    v_add_f32 v226, v226, v230
    v_mfma_f32_16x16x32_bf16 v[152:155], a[12:15], a[52:55], v[152:155]
    v_fmac_f32 v228, v230, v230
    v_add_f32 v226, v226, v231
    v_mfma_f32_16x16x32_bf16 v[156:159], a[12:15], a[56:59], v[156:159]
    ds_read_b64_tr_b16 a[82:83], v20 offset:26432
    v_fmac_f32 v228, v231, v231
    v_mfma_f32_16x16x32_bf16 v[160:163], a[16:19], a[28:31], v[160:163]
    v_accvgpr_read_b32 v233, a197
    v_mfma_f32_16x16x32_bf16 v[164:167], a[16:19], a[32:35], v[164:167]
    ds_read_b64_tr_b16 a[84:85], v21 offset:16384
    v_lshlrev_b32 v232, 16, v233
    v_mfma_f32_16x16x32_bf16 v[168:171], a[16:19], a[36:39], v[168:171]
    v_and_b32 v233, 0xffff0000, v233
    v_sub_f32 v232, v232, v224
    v_mfma_f32_16x16x32_bf16 v[172:175], a[16:19], a[40:43], v[172:175]
    ds_read_b64_tr_b16 a[86:87], v21 offset:18176
    v_sub_f32 v233, v233, v224
    v_mfma_f32_16x16x32_bf16 v[176:179], a[16:19], a[44:47], v[176:179]
    v_add_f32 v226, v226, v232
    v_fmac_f32 v228, v232, v232
    v_mfma_f32_16x16x32_bf16 v[180:183], a[16:19], a[48:51], v[180:183]
    v_add_f32 v226, v226, v233
    v_fmac_f32 v228, v233, v233
    v_mfma_f32_16x16x32_bf16 v[184:187], a[16:19], a[52:55], v[184:187]
    v_accvgpr_read_b32 v231, a198
    v_lshlrev_b32 v230, 16, v231
    v_mfma_f32_16x16x32_bf16 v[188:191], a[16:19], a[56:59], v[188:191]
    v_and_b32 v231, 0xffff0000, v231
    v_sub_f32 v230, v230, v224
    v_mfma_f32_16x16x32_bf16 v[192:195], a[20:23], a[28:31], v[192:195]
    v_sub_f32 v231, v231, v224
    v_mfma_f32_16x16x32_bf16 v[196:199], a[20:23], a[32:35], v[196:199]
    v_add_f32 v226, v226, v230
    v_fmac_f32 v228, v230, v230
    v_mfma_f32_16x16x32_bf16 v[200:203], a[20:23], a[36:39], v[200:203]
    v_add_f32 v226, v226, v231
    v_fmac_f32 v228, v231, v231
    v_mfma_f32_16x16x32_bf16 v[204:207], a[20:23], a[40:43], v[204:207]
    v_accvgpr_read_b32 v233, a199
    v_lshlrev_b32 v232, 16, v233
    v_mfma_f32_16x16x32_bf16 v[208:211], a[20:23], a[44:47], v[208:211]
    v_and_b32 v233, 0xffff0000, v233
    v_sub_f32 v232, v232, v224
    v_mfma_f32_16x16x32_bf16 v[212:215], a[20:23], a[48:51], v[212:215]
    v_sub_f32 v233, v233, v224
    v_add_f32 v226, v226, v232
    v_mfma_f32_16x16x32_bf16 v[216:219], a[20:23], a[52:55], v[216:219]
    v_fmac_f32 v228, v232, v232
    v_mfma_f32_16x16x32_bf16 v[220:223], a[20:23], a[56:59], v[220:223]
    v_add_f32 v226, v226, v233
    v_fmac_f32 v228, v233, v233
    v_mfma_f32_16x16x32_bf16 a[128:131], a[24:27], a[28:31], a[128:131]
    v_accvgpr_read_b32 v230, a200
    v_lshlrev_b32 v230, 16, v230
    v_mfma_f32_16x16x32_bf16 a[132:135], a[24:27], a[32:35], a[132:135]
    s_nop 0
    v_readfirstlane_b32 s55, v230
    v_mfma_f32_16x16x32_bf16 a[136:139], a[24:27], a[36:39], a[136:139]
    v_mov_b32 v227, 0
    v_mov_b32 v229, 0
    v_mfma_f32_16x16x32_bf16 a[140:143], a[24:27], a[40:43], a[140:143]
    v_mov_b32 v225, s55
    v_accvgpr_read_b32 v231, a200
    v_mfma_f32_16x16x32_bf16 a[144:147], a[24:27], a[44:47], a[144:147]
    v_lshlrev_b32 v230, 16, v231
    v_mfma_f32_16x16x32_bf16 a[148:151], a[24:27], a[48:51], a[148:151]
    v_and_b32 v231, 0xffff0000, v231
    v_sub_f32 v230, v230, v225
    s_waitcnt vmcnt(9)
    v_mfma_f32_16x16x32_bf16 a[152:155], a[24:27], a[52:55], a[152:155]
    v_sub_f32 v231, v231, v225
    v_add_f32 v227, v227, v230
    v_mfma_f32_16x16x32_bf16 a[156:159], a[24:27], a[56:59], a[156:159]
    v_fmac_f32 v229, v230, v230
    v_add_f32 v227, v227, v231
    s_waitcnt lgkmcnt(0)
    s_barrier
    v_mfma_f32_16x16x32_bf16 a[160:163], a[60:63], a[188:191], a[160:163]
    s_add_u32 s60, s60, 32768
    s_cmp_eq_u32 s60, 98304
    s_cselect_b32 s60, 0, s60
    v_mfma_f32_16x16x32_bf16 a[164:167], a[64:67], a[188:191], a[164:167]
    v_add_u32 v22, s60, v24
    v_add_u32 v23, s60, v25
    v_mfma_f32_16x16x32_bf16 a[168:171], a[68:71], a[188:191], a[168:171]
    ds_read_b128 a[28:31], v22 offset:0
    v_fmac_f32 v229, v231, v231
    v_mfma_f32_16x16x32_bf16 a[172:175], a[72:75], a[188:191], a[172:175]
    ds_read_b128 a[32:35], v22 offset:2048
    v_accvgpr_read_b32 v233, a201
    v_mfma_f32_16x16x32_bf16 a[176:179], a[76:79], a[188:191], a[176:179]
    v_lshlrev_b32 v232, 16, v233
    v_mfma_f32_16x16x32_bf16 a[180:183], a[80:83], a[188:191], a[180:183]
    s_mov_b32 m0, s40
    s_nop 0
    buffer_load_dwordx4 v4, s[32:35], s36 offen lds
    v_mfma_f32_16x16x32_bf16 a[184:187], a[84:87], a[188:191], a[184:187]
    ds_read_b128 a[36:39], v22 offset:4096
    v_and_b32 v233, 0xffff0000, v233
    v_mfma_f32_16x16x32_bf16 v[32:35], a[60:63], a[88:91], v[32:35]
    ds_read_b128 a[40:43], v22 offset:6144
    v_sub_f32 v232, v232, v225
    v_mfma_f32_16x16x32_bf16 v[36:39], a[60:63], a[92:95], v[36:39]
    buffer_load_dwordx4 v5, s[32:35], s36 offen offset:1024 lds
    v_mfma_f32_16x16x32_bf16 v[40:43], a[60:63], a[96:99], v[40:43]
    v_sub_f32 v233, v233, v225
    v_add_f32 v227, v227, v232
    v_mfma_f32_16x16x32_bf16 v[44:47], a[60:63], a[100:103], v[44:47]
    ds_read_b128 a[44:47], v22 offset:8192
    v_fmac_f32 v229, v232, v232
    v_mfma_f32_16x16x32_bf16 v[48:51], a[60:63], a[104:107], v[48:51]
    ds_read_b128 a[48:51], v22 offset:10240
    v_add_f32 v227, v227, v233
    v_mfma_f32_16x16x32_bf16 v[52:55], a[60:63], a[108:111], v[52:55]
    buffer_load_dwordx4 v6, s[32:35], s36 offen offset:2048 lds
    v_mfma_f32_16x16x32_bf16 v[56:59], a[60:63], a[112:115], v[56:59]
    ds_read_b128 a[52:55], v22 offset:12288
    v_fmac_f32 v229, v233, v233
    v_mfma_f32_16x16x32_bf16 v[60:63], a[60:63], a[116:119], v[60:63]
    v_accvgpr_read_b32 v231, a202
    v_lshlrev_b32 v230, 16, v231
    v_mfma_f32_16x16x32_bf16 v[64:67], a[64:67], a[88:91], v[64:67]
    ds_read_b128 a[56:59], v22 offset:14336
    v_and_b32 v231, 0xffff0000, v231
    v_mfma_f32_16x16x32_bf16 v[68:71], a[64:67], a[92:95], v[68:71]
    buffer_load_dwordx4 v7, s[32:35], s36 offen offset:3072 lds
    v_mfma_f32_16x16x32_bf16 v[72:75], a[64:67], a[96:99], v[72:75]
    ds_read_b64_tr_b16 a[0:1], v20 offset:32768
    v_sub_f32 v230, v230, v225
    v_mfma_f32_16x16x32_bf16 v[76:79], a[64:67], a[100:103], v[76:79]
    ds_read_b64_tr_b16 a[2:3], v20 offset:34560
    v_sub_f32 v231, v231, v225
    v_mfma_f32_16x16x32_bf16 v[80:83], a[64:67], a[104:107], v[80:83]
    v_add_f32 v227, v227, v230
    v_mfma_f32_16x16x32_bf16 v[84:87], a[64:67], a[108:111], v[84:87]
    s_add_u32 m0, s40, 4096
    s_add_u32 s40, s40, 32768
    buffer_load_dwordx4 v8, s[32:35], s36 offen lds
    v_mfma_f32_16x16x32_bf16 v[88:91], a[64:67], a[112:115], v[88:91]
    ds_read_b64_tr_b16 a[4:5], v20 offset:32800
    v_fmac_f32 v229, v230, v230
    v_mfma_f32_16x16x32_bf16 v[92:95], a[64:67], a[116:119], v[92:95]
    ds_read_b64_tr_b16 a[6:7], v20 offset:34592
    v_add_f32 v227, v227, v231
    v_mfma_f32_16x16x32_bf16 v[96:99], a[68:71], a[88:91], v[96:99]
    s_cmp_eq_u32 s40, s42
    s_cselect_b32 s40, s41, s40
    buffer_load_dwordx4 v9, s[32:35], s36 offen offset:1024 lds
    v_mfma_f32_16x16x32_bf16 v[100:103], a[68:71], a[92:95], v[100:103]
    v_fmac_f32 v229, v231, v231
    v_accvgpr_read_b32 v233, a203
    v_mfma_f32_16x16x32_bf16 v[104:107], a[68:71], a[96:99], v[104:107]
    ds_read_b64_tr_b16 a[8:9], v20 offset:32832
    v_mfma_f32_16x16x32_bf16 v[108:111], a[68:71], a[100:103], v[108:111]
    ds_read_b64_tr_b16 a[10:11], v20 offset:34624
    v_lshlrev_b32 v232, 16, v233
    v_mfma_f32_16x16x32_bf16 v[112:115], a[68:71], a[104:107], v[112:115]
    buffer_load_dwordx4 v10, s[32:35], s36 offen offset:2048 lds
    v_and_b32 v233, 0xffff0000, v233
    v_mfma_f32_16x16x32_bf16 v[116:119], a[68:71], a[108:111], v[116:119]
    ds_read_b64_tr_b16 a[12:13], v20 offset:40960
    v_sub_f32 v232, v232, v225
    v_mfma_f32_16x16x32_bf16 v[120:123], a[68:71], a[112:115], v[120:123]
    v_sub_f32 v233, v233, v225
    v_mfma_f32_16x16x32_bf16 v[124:127], a[68:71], a[116:119], v[124:127]
    ds_read_b64_tr_b16 a[14:15], v20 offset:42752
    v_add_f32 v227, v227, v232
    v_mfma_f32_16x16x32_bf16 v[128:131], a[72:75], a[88:91], v[128:131]
    buffer_load_dwordx4 v11, s[32:35], s36 offen offset:3072 lds
    s_add_u32 s36, s36, s37
    s_cmp_eq_u32 s36, s39
    s_cselect_b32 s36, s38, s36
    v_mfma_f32_16x16x32_bf16 v[132:135], a[72:75], a[92:95], v[132:135]
    ds_read_b64_tr_b16 a[16:17], v20 offset:40992
    v_fmac_f32 v229, v232, v232
    v_mfma_f32_16x16x32_bf16 v[136:139], a[72:75], a[96:99], v[136:139]
    ds_read_b64_tr_b16 a[18:19], v20 offset:42784
    v_add_f32 v227, v227, v233
    v_mfma_f32_16x16x32_bf16 v[140:143], a[72:75], a[100:103], v[140:143]
    v_fmac_f32 v229, v233, v233
    v_mfma_f32_16x16x32_bf16 v[144:147], a[72:75], a[104:107], v[144:147]
    s_mov_b32 m0, s52
    s_nop 0
    buffer_load_dwordx4 v12, s[44:47], s48 offen lds
    v_mfma_f32_16x16x32_bf16 v[148:151], a[72:75], a[108:111], v[148:151]
    ds_read_b64_tr_b16 a[20:21], v20 offset:41024
    v_accvgpr_read_b32 v231, a204
    v_mfma_f32_16x16x32_bf16 v[152:155], a[72:75], a[112:115], v[152:155]
    ds_read_b64_tr_b16 a[22:23], v20 offset:42816
    v_lshlrev_b32 v230, 16, v231
    v_mfma_f32_16x16x32_bf16 v[156:159], a[72:75], a[116:119], v[156:159]
    buffer_load_dwordx4 v13, s[44:47], s48 offen offset:1024 lds
    v_and_b32 v231, 0xffff0000, v231
    v_mfma_f32_16x16x32_bf16 v[160:163], a[76:79], a[88:91], v[160:163]
    v_sub_f32 v230, v230, v225
    v_mfma_f32_16x16x32_bf16 v[164:167], a[76:79], a[92:95], v[164:167]
    ds_read_b64_tr_b16 a[24:25], v21 offset:32768
    v_sub_f32 v231, v231, v225
    v_mfma_f32_16x16x32_bf16 v[168:171], a[76:79], a[96:99], v[168:171]
    ds_read_b64_tr_b16 a[26:27], v21 offset:34560
    v_add_f32 v227, v227, v230
    v_mfma_f32_16x16x32_bf16 v[172:175], a[76:79], a[100:103], v[172:175]
    buffer_load_dwordx4 v14, s[44:47], s48 offen offset:2048 lds
    v_fmac_f32 v229, v230, v230
    v_mfma_f32_16x16x32_bf16 v[176:179], a[76:79], a[104:107], v[176:179]
    v_add_f32 v227, v227, v231
    v_mfma_f32_16x16x32_bf16 v[180:183], a[76:79], a[108:111], v[180:183]
    v_fmac_f32 v229, v231, v231
    v_accvgpr_read_b32 v233, a205
    v_mfma_f32_16x16x32_bf16 v[184:187], a[76:79], a[112:115], v[184:187]
    v_lshlrev_b32 v232, 16, v233
    v_mfma_f32_16x16x32_bf16 v[188:191], a[76:79], a[116:119], v[188:191]
    v_and_b32 v233, 0xffff0000, v233
    v_sub_f32 v232, v232, v225
    v_mfma_f32_16x16x32_bf16 v[192:195], a[80:83], a[88:91], v[192:195]
    v_sub_f32 v233, v233, v225
    v_mfma_f32_16x16x32_bf16 v[196:199], a[80:83], a[92:95], v[196:199]
    v_add_f32 v227, v227, v232
    v_fmac_f32 v229, v232, v232
    v_mfma_f32_16x16x32_bf16 v[200:203], a[80:83], a[96:99], v[200:203]
    v_add_f32 v227, v227, v233
    v_fmac_f32 v229, v233, v233
    v_mfma_f32_16x16x32_bf16 v[204:207], a[80:83], a[100:103], v[204:207]
    v_accvgpr_read_b32 v231, a206
    v_mfma_f32_16x16x32_bf16 v[208:211], a[80:83], a[104:107], v[208:211]
    v_lshlrev_b32 v230, 16, v231
    v_and_b32 v231, 0xffff0000, v231
    v_mfma_f32_16x16x32_bf16 v[212:215], a[80:83], a[108:111], v[212:215]
    v_sub_f32 v230, v230, v225
    v_mfma_f32_16x16x32_bf16 v[216:219], a[80:83], a[112:115], v[216:219]
    v_sub_f32 v231, v231, v225
    v_add_f32 v227, v227, v230
    v_mfma_f32_16x16x32_bf16 v[220:223], a[80:83], a[116:119], v[220:223]
    v_fmac_f32 v229, v230, v230
    v_mfma_f32_16x16x32_bf16 a[128:131], a[84:87], a[88:91], a[128:131]
    v_add_f32 v227, v227, v231
    v_fmac_f32 v229, v231, v231
    v_mfma_f32_16x16x32_bf16 a[132:135], a[84:87], a[92:95], a[132:135]
    v_accvgpr_read_b32 v233, a207
    v_lshlrev_b32 v232, 16, v233
    v_mfma_f32_16x16x32_bf16 a[136:139], a[84:87], a[96:99], a[136:139]
    v_and_b32 v233, 0xffff0000, v233
    v_mfma_f32_16x16x32_bf16 a[140:143], a[84:87], a[100:103], a[140:143]
    v_sub_f32 v232, v232, v225
    v_sub_f32 v233, v233, v225
    v_mfma_f32_16x16x32_bf16 a[144:147], a[84:87], a[104:107], a[144:147]
    v_add_f32 v227, v227, v232
    v_mfma_f32_16x16x32_bf16 a[148:151], a[84:87], a[108:111], a[148:151]
    v_fmac_f32 v229, v232, v232
    v_add_f32 v227, v227, v233
    s_waitcnt vmcnt(12)
    v_mfma_f32_16x16x32_bf16 a[152:155], a[84:87], a[112:115], a[152:155]
    v_fmac_f32 v229, v233, v233
    v_mfma_f32_16x16x32_bf16 a[156:159], a[84:87], a[116:119], a[156:159]
    s_nop 1
    s_waitcnt lgkmcnt(0)
    s_barrier
    v_mfma_f32_16x16x32_bf16 a[160:163], a[0:3], a[188:191], a[160:163]
    ds_read_b128 a[88:91], v23 offset:0
    v_add_f32_dpp v226, v226, v226 quad_perm:[1,0,3,2] row_mask:0xf bank_mask:0xf
    v_mfma_f32_16x16x32_bf16 a[164:167], a[4:7], a[188:191], a[164:167]
    ds_read_b128 a[92:95], v23 offset:2048
    v_add_f32_dpp v227, v227, v227 quad_perm:[1,0,3,2] row_mask:0xf bank_mask:0xf
    v_mfma_f32_16x16x32_bf16 a[168:171], a[8:11], a[188:191], a[168:171]
    buffer_load_dwordx4 v15, s[44:47], s48 offen offset:3072 lds
    v_mfma_f32_16x16x32_bf16 a[172:175], a[12:15], a[188:191], a[172:175]
    v_add_f32_dpp v228, v228, v228 quad_perm:[1,0,3,2] row_mask:0xf bank_mask:0xf
    v_add_f32_dpp v229, v229, v229 quad_perm:[1,0,3,2] row_mask:0xf bank_mask:0xf
    v_mfma_f32_16x16x32_bf16 a[176:179], a[16:19], a[188:191], a[176:179]
    ds_read_b128 a[96:99], v23 offset:4096
    v_add_f32_dpp v226, v226, v226 quad_perm:[2,3,0,1] row_mask:0xf bank_mask:0xf
    v_mfma_f32_16x16x32_bf16 a[180:183], a[20:23], a[188:191], a[180:183]
    ds_read_b128 a[100:103], v23 offset:6144
    v_add_f32_dpp v227, v227, v227 quad_perm:[2,3,0,1] row_mask:0xf bank_mask:0xf
    v_mfma_f32_16x16x32_bf16 a[184:187], a[24:27], a[188:191], a[184:187]
    s_add_u32 m0, s52, 4096
    s_add_u32 s52, s52, 32768
    buffer_load_dwordx4 v16, s[44:47], s48 offen lds
    v_mfma_f32_16x16x32_bf16 v[32:35], a[0:3], a[28:31], v[32:35]
    v_add_f32_dpp v228, v228, v228 quad_perm:[2,3,0,1] row_mask:0xf bank_mask:0xf
    v_mfma_f32_16x16x32_bf16 v[36:39], a[0:3], a[32:35], v[36:39]
    ds_read_b128 a[104:107], v23 offset:8192
    v_add_f32_dpp v229, v229, v229 quad_perm:[2,3,0,1] row_mask:0xf bank_mask:0xf
    v_mfma_f32_16x16x32_bf16 v[40:43], a[0:3], a[36:39], v[40:43]
    ds_read_b128 a[108:111], v23 offset:10240
    v_add_f32_dpp v226, v226, v226 row_half_mirror row_mask:0xf bank_mask:0xf
    v_mfma_f32_16x16x32_bf16 v[44:47], a[0:3], a[40:43], v[44:47]
    v_add_f32_dpp v227, v227, v227 row_half_mirror row_mask:0xf bank_mask:0xf
    v_mfma_f32_16x16x32_bf16 v[48:51], a[0:3], a[44:47], v[48:51]
    s_cmp_eq_u32 s52, s54
    s_cselect_b32 s52, s53, s52
    buffer_load_dwordx4 v17, s[44:47], s48 offen offset:1024 lds
    v_mfma_f32_16x16x32_bf16 v[52:55], a[0:3], a[48:51], v[52:55]
    ds_read_b128 a[112:115], v23 offset:12288
    v_add_f32_dpp v228, v228, v228 row_half_mirror row_mask:0xf bank_mask:0xf
    v_mfma_f32_16x16x32_bf16 v[56:59], a[0:3], a[52:55], v[56:59]
    ds_read_b128 a[116:119], v23 offset:14336
    v_add_f32_dpp v229, v229, v229 row_half_mirror row_mask:0xf bank_mask:0xf
    v_mfma_f32_16x16x32_bf16 v[60:63], a[0:3], a[56:59], v[60:63]
    v_add_f32_dpp v226, v226, v226 row_mirror row_mask:0xf bank_mask:0xf
    v_add_f32_dpp v227, v227, v227 row_mirror row_mask:0xf bank_mask:0xf
    v_mfma_f32_16x16x32_bf16 v[64:67], a[4:7], a[28:31], v[64:67]
    buffer_load_dwordx4 v18, s[44:47], s48 offen offset:2048 lds
    v_mfma_f32_16x16x32_bf16 v[68:71], a[4:7], a[32:35], v[68:71]
    ds_read_b64_tr_b16 a[60:61], v20 offset:49152
    v_add_f32_dpp v228, v228, v228 row_mirror row_mask:0xf bank_mask:0xf
    v_mfma_f32_16x16x32_bf16 v[72:75], a[4:7], a[36:39], v[72:75]
    ds_read_b64_tr_b16 a[62:63], v20 offset:50944
    v_add_f32_dpp v229, v229, v229 row_mirror row_mask:0xf bank_mask:0xf
    v_mfma_f32_16x16x32_bf16 v[76:79], a[4:7], a[40:43], v[76:79]
    v_mov_b32 v230, v226
    v_mov_b32 v231, v227
    v_mfma_f32_16x16x32_bf16 v[80:83], a[4:7], a[44:47], v[80:83]
    buffer_load_dwordx4 v19, s[44:47], s48 offen offset:3072 lds
    s_add_u32 s48, s48, s49
    s_cmp_eq_u32 s48, s51
    s_cselect_b32 s48, s50, s48
    v_mfma_f32_16x16x32_bf16 v[84:87], a[4:7], a[48:51], v[84:87]
    ds_read_b64_tr_b16 a[64:65], v20 offset:49184
    v_mfma_f32_16x16x32_bf16 v[88:91], a[4:7], a[52:55], v[88:91]
    v_mov_b32 v232, v228
    v_mov_b32 v233, v229
    v_mfma_f32_16x16x32_bf16 v[92:95], a[4:7], a[56:59], v[92:95]
    ds_read_b64_tr_b16 a[66:67], v20 offset:50976
    s_nop 0
    v_mfma_f32_16x16x32_bf16 v[96:99], a[8:11], a[28:31], v[96:99]
    s_mov_b32 m0, s40
    s_nop 0
    buffer_load_dwordx4 v4, s[32:35], s36 offen lds
    v_mfma_f32_16x16x32_bf16 v[100:103], a[8:11], a[32:35], v[100:103]
    ds_read_b64_tr_b16 a[68:69], v20 offset:49216
    v_permlane16_swap_b32 v226, v230
    v_mfma_f32_16x16x32_bf16 v[104:107], a[8:11], a[36:39], v[104:107]
    v_permlane16_swap_b32 v227, v231
    v_mfma_f32_16x16x32_bf16 v[108:111], a[8:11], a[40:43], v[108:111]
    ds_read_b64_tr_b16 a[70:71], v20 offset:51008
    v_permlane16_swap_b32 v228, v232
    v_mfma_f32_16x16x32_bf16 v[112:115], a[8:11], a[44:47], v[112:115]
    buffer_load_dwordx4 v5, s[32:35], s36 offen offset:1024 lds
    v_permlane16_swap_b32 v229, v233
    v_mfma_f32_16x16x32_bf16 v[116:119], a[8:11], a[48:51], v[116:119]
    ds_read_b64_tr_b16 a[72:73], v20 offset:57344
    v_add_f32 v226, v226, v230
    v_mfma_f32_16x16x32_bf16 v[120:123], a[8:11], a[52:55], v[120:123]
    v_add_f32 v227, v227, v231
    v_mfma_f32_16x16x32_bf16 v[124:127], a[8:11], a[56:59], v[124:127]
    ds_read_b64_tr_b16 a[74:75], v20 offset:59136
    v_add_f32 v228, v228, v232
    v_mfma_f32_16x16x32_bf16 v[128:131], a[12:15], a[28:31], v[128:131]
    buffer_load_dwordx4 v6, s[32:35], s36 offen offset:2048 lds
    v_add_f32 v229, v229, v233
    v_mfma_f32_16x16x32_bf16 v[132:135], a[12:15], a[32:35], v[132:135]
    v_mov_b32 v230, v226
    v_mfma_f32_16x16x32_bf16 v[136:139], a[12:15], a[36:39], v[136:139]
    ds_read_b64_tr_b16 a[76:77], v20 offset:57376
    v_mov_b32 v231, v227
    v_mfma_f32_16x16x32_bf16 v[140:143], a[12:15], a[40:43], v[140:143]
    ds_read_b64_tr_b16 a[78:79], v20 offset:59168
    v_mov_b32 v232, v228
    v_mfma_f32_16x16x32_bf16 v[144:147], a[12:15], a[44:47], v[144:147]
    buffer_load_dwordx4 v7, s[32:35], s36 offen offset:3072 lds
    v_mov_b32 v233, v229
    v_mfma_f32_16x16x32_bf16 v[148:151], a[12:15], a[48:51], v[148:151]
    s_nop 0
    v_mfma_f32_16x16x32_bf16 v[152:155], a[12:15], a[52:55], v[152:155]
    ds_read_b64_tr_b16 a[80:81], v20 offset:57408
    v_permlane32_swap_b32 v226, v230
    v_mfma_f32_16x16x32_bf16 v[156:159], a[12:15], a[56:59], v[156:159]
    ds_read_b64_tr_b16 a[82:83], v20 offset:59200
    v_permlane32_swap_b32 v227, v231
    v_mfma_f32_16x16x32_bf16 v[160:163], a[16:19], a[28:31], v[160:163]
    s_add_u32 m0, s40, 4096
    s_add_u32 s40, s40, 32768
    buffer_load_dwordx4 v8, s[32:35], s36 offen lds
    v_mfma_f32_16x16x32_bf16 v[164:167], a[16:19], a[32:35], v[164:167]
    v_permlane32_swap_b32 v228, v232
    v_mfma_f32_16x16x32_bf16 v[168:171], a[16:19], a[36:39], v[168:171]
    ds_read_b64_tr_b16 a[84:85], v21 offset:49152
    v_permlane32_swap_b32 v229, v233
    v_mfma_f32_16x16x32_bf16 v[172:175], a[16:19], a[40:43], v[172:175]
    ds_read_b64_tr_b16 a[86:87], v21 offset:50944
    v_add_f32 v226, v226, v230
    v_mfma_f32_16x16x32_bf16 v[176:179], a[16:19], a[44:47], v[176:179]
    v_add_f32 v227, v227, v231
    v_add_f32 v228, v228, v232
    v_mfma_f32_16x16x32_bf16 v[180:183], a[16:19], a[48:51], v[180:183]
    v_add_f32 v229, v229, v233
    v_mfma_f32_16x16x32_bf16 v[184:187], a[16:19], a[52:55], v[184:187]
    v_mfma_f32_16x16x32_bf16 v[188:191], a[16:19], a[56:59], v[188:191]
    v_cmp_lt_u32 vcc, 31, v1
    v_and_b32 v234, 31, v1
    s_nop 0
    v_mfma_f32_16x16x32_bf16 v[192:195], a[20:23], a[28:31], v[192:195]
    v_cndmask_b32 v226, v226, v227, vcc
    v_cndmask_b32 v228, v228, v229, vcc
    v_mfma_f32_16x16x32_bf16 v[196:199], a[20:23], a[32:35], v[196:199]
    v_cndmask_b32 v224, v224, v225, vcc
    v_mul_f32 v226, 0x3a800000, v226
    v_mfma_f32_16x16x32_bf16 v[200:203], a[20:23], a[36:39], v[200:203]
    v_mul_f32 v228, 0x3a800000, v228
    v_mfma_f32_16x16x32_bf16 v[204:207], a[20:23], a[40:43], v[204:207]
    v_add_f32 v236, v224, v226
    v_fma_f32 v238, -v226, v226, v228
    v_mfma_f32_16x16x32_bf16 v[208:211], a[20:23], a[44:47], v[208:211]
    v_cvt_pk_bf16_f32 v236, -v236, -v236
    v_mfma_f32_16x16x32_bf16 v[212:215], a[20:23], a[48:51], v[212:215]
    v_max_f32 v238, 0, v238
    v_mov_b32 v237, v236
    v_mfma_f32_16x16x32_bf16 v[216:219], a[20:23], a[52:55], v[216:219]
    v_cvt_pk_bf16_f32 v238, 0, v238
    v_cmp_ne_u32 vcc, 0, v234
    v_mfma_f32_16x16x32_bf16 v[220:223], a[20:23], a[56:59], v[220:223]
    v_add_f32 v238, 0x3727c5ac, v238
    v_mfma_f32_16x16x32_bf16 a[128:131], a[24:27], a[28:31], a[128:131]
    v_lshrrev_b32 v234, 1, v1
    v_cvt_pk_bf16_f32 v238, 0, v238
    v_mfma_f32_16x16x32_bf16 a[132:135], a[24:27], a[32:35], a[132:135]
    v_cndmask_b32 v234, v234, v31, vcc
    v_mfma_f32_16x16x32_bf16 a[136:139], a[24:27], a[36:39], a[136:139]
    v_mfma_f32_16x16x32_bf16 a[140:143], a[24:27], a[40:43], a[140:143]
    v_sqrt_f32 v238, v238
    s_nop 0
    v_cvt_pk_bf16_f32 v238, 0, v238
    v_mfma_f32_16x16x32_bf16 a[144:147], a[24:27], a[44:47], a[144:147]
    v_mfma_f32_16x16x32_bf16 a[148:151], a[24:27], a[48:51], a[148:151]
    v_rcp_f32 v239, v238
    s_nop 0
    s_waitcnt vmcnt(13)
    v_mfma_f32_16x16x32_bf16 a[152:155], a[24:27], a[52:55], a[152:155]
    v_mfma_f32_16x16x32_bf16 a[156:159], a[24:27], a[56:59], a[156:159]
    v_mul_f32 v239, 0xbfb8aa3b, v239
    s_lshl_b32 s55, s62, 5
    buffer_store_dwordx4 v[236:239], v234, s[56:59], s55 offen sc1
    s_waitcnt lgkmcnt(0)
    s_barrier
    v_mfma_f32_16x16x32_bf16 a[160:163], a[60:63], a[188:191], a[160:163]
    s_add_u32 s60, s60, 32768
    s_cmp_eq_u32 s60, 98304
    s_cselect_b32 s60, 0, s60
    v_mfma_f32_16x16x32_bf16 a[164:167], a[64:67], a[188:191], a[164:167]
    v_add_u32 v22, s60, v24
    v_add_u32 v23, s60, v25
    v_mfma_f32_16x16x32_bf16 a[168:171], a[68:71], a[188:191], a[168:171]
    ds_read_b128 a[28:31], v22 offset:0
    v_mfma_f32_16x16x32_bf16 a[172:175], a[72:75], a[188:191], a[172:175]
    ds_read_b128 a[32:35], v22 offset:2048
    v_mfma_f32_16x16x32_bf16 a[176:179], a[76:79], a[188:191], a[176:179]
    s_cmp_eq_u32 s40, s42
    s_cselect_b32 s40, s41, s40
    buffer_load_dwordx4 v9, s[32:35], s36 offen offset:1024 lds
    v_mfma_f32_16x16x32_bf16 a[180:183], a[80:83], a[188:191], a[180:183]
    ds_read_b128 a[36:39], v22 offset:4096
    v_mfma_f32_16x16x32_bf16 a[184:187], a[84:87], a[188:191], a[184:187]
    ds_read_b128 a[40:43], v22 offset:6144
    v_mfma_f32_16x16x32_bf16 v[32:35], a[60:63], a[88:91], v[32:35]
    v_mfma_f32_16x16x32_bf16 v[36:39], a[60:63], a[92:95], v[36:39]
    buffer_load_dwordx4 v10, s[32:35], s36 offen offset:2048 lds
    v_mfma_f32_16x16x32_bf16 v[40:43], a[60:63], a[96:99], v[40:43]
    ds_read_b128 a[44:47], v22 offset:8192
    v_mfma_f32_16x16x32_bf16 v[44:47], a[60:63], a[100:103], v[44:47]
    ds_read_b128 a[48:51], v22 offset:10240
    v_and_b32 v240, 3, v1
    v_mfma_f32_16x16x32_bf16 v[48:51], a[60:63], a[104:107], v[48:51]
    buffer_load_dwordx4 v11, s[32:35], s36 offen offset:3072 lds
    s_add_u32 s36, s36, s37
    s_cmp_eq_u32 s36, s39
    s_cselect_b32 s36, s38, s36
    v_mfma_f32_16x16x32_bf16 v[52:55], a[60:63], a[108:111], v[52:55]
    ds_read_b128 a[52:55], v22 offset:12288
    v_bfe_u32 v241, v1, 2, 2
    v_mfma_f32_16x16x32_bf16 v[56:59], a[60:63], a[112:115], v[56:59]
    ds_read_b128 a[56:59], v22 offset:14336
    v_cmp_eq_u32 s[82:83], 1, v240
    v_mfma_f32_16x16x32_bf16 v[60:63], a[60:63], a[116:119], v[60:63]
    v_cmp_eq_u32 s[84:85], 2, v240
    v_cmp_eq_u32 s[86:87], 3, v240
    v_mfma_f32_16x16x32_bf16 v[64:67], a[64:67], a[88:91], v[64:67]
    s_mov_b32 m0, s52
    s_nop 0
    buffer_load_dwordx4 v12, s[44:47], s48 offen lds
    v_mfma_f32_16x16x32_bf16 v[68:71], a[64:67], a[92:95], v[68:71]
    ds_read_b64_tr_b16 a[0:1], v20 offset:0
    v_cmp_eq_u32 s[88:89], 1, v241
    v_mfma_f32_16x16x32_bf16 v[72:75], a[64:67], a[96:99], v[72:75]
    ds_read_b64_tr_b16 a[2:3], v20 offset:1792
    v_cmp_eq_u32 s[90:91], 2, v241
    v_mfma_f32_16x16x32_bf16 v[76:79], a[64:67], a[100:103], v[76:79]
    buffer_load_dwordx4 v13, s[44:47], s48 offen offset:1024 lds
    v_cmp_eq_u32 s[96:97], 3, v241
    v_mfma_f32_16x16x32_bf16 v[80:83], a[64:67], a[104:107], v[80:83]
    ds_read_b64_tr_b16 a[4:5], v20 offset:32
    v_accvgpr_read_b32 v242, a160
    v_mfma_f32_16x16x32_bf16 v[84:87], a[64:67], a[108:111], v[84:87]
    ds_read_b64_tr_b16 a[6:7], v20 offset:1824
    v_accvgpr_read_b32 v243, a161
    v_mfma_f32_16x16x32_bf16 v[88:91], a[64:67], a[112:115], v[88:91]
    v_accvgpr_read_b32 v244, a162
    v_accvgpr_read_b32 v245, a163
    v_mfma_f32_16x16x32_bf16 v[92:95], a[64:67], a[116:119], v[92:95]
    buffer_load_dwordx4 v14, s[44:47], s48 offen offset:2048 lds
    v_cndmask_b32 v242, v242, v243, s[82:83]
    v_mfma_f32_16x16x32_bf16 v[96:99], a[68:71], a[88:91], v[96:99]
    ds_read_b64_tr_b16 a[8:9], v20 offset:64
    v_cndmask_b32 v242, v242, v244, s[84:85]
    v_mfma_f32_16x16x32_bf16 v[100:103], a[68:71], a[92:95], v[100:103]
    ds_read_b64_tr_b16 a[10:11], v20 offset:1856
    v_cndmask_b32 v240, v242, v245, s[86:87]
    v_mfma_f32_16x16x32_bf16 v[104:107], a[68:71], a[96:99], v[104:107]
    buffer_load_dwordx4 v15, s[44:47], s48 offen offset:3072 lds
    v_accvgpr_read_b32 v246, a164
    v_mfma_f32_16x16x32_bf16 v[108:111], a[68:71], a[100:103], v[108:111]
    ds_read_b64_tr_b16 a[12:13], v20 offset:8192
    v_accvgpr_read_b32 v247, a165
    v_mfma_f32_16x16x32_bf16 v[112:115], a[68:71], a[104:107], v[112:115]
    ds_read_b64_tr_b16 a[14:15], v20 offset:9984
    v_accvgpr_read_b32 v248, a166
    v_mfma_f32_16x16x32_bf16 v[116:119], a[68:71], a[108:111], v[116:119]
    s_add_u32 m0, s52, 4096
    s_add_u32 s52, s52, 32768
    buffer_load_dwordx4 v16, s[44:47], s48 offen lds
    v_mfma_f32_16x16x32_bf16 v[120:123], a[68:71], a[112:115], v[120:123]
    v_accvgpr_read_b32 v249, a167
    v_cndmask_b32 v246, v246, v247, s[82:83]
    v_mfma_f32_16x16x32_bf16 v[124:127], a[68:71], a[116:119], v[124:127]
    ds_read_b64_tr_b16 a[16:17], v20 offset:8224
    v_cndmask_b32 v246, v246, v248, s[84:85]
    v_mfma_f32_16x16x32_bf16 v[128:131], a[72:75], a[88:91], v[128:131]
    ds_read_b64_tr_b16 a[18:19], v20 offset:10016
    v_cndmask_b32 v246, v246, v249, s[86:87]
    v_mfma_f32_16x16x32_bf16 v[132:135], a[72:75], a[92:95], v[132:135]
    s_cmp_eq_u32 s52, s54
    s_cselect_b32 s52, s53, s52
    buffer_load_dwordx4 v17, s[44:47], s48 offen offset:1024 lds
    v_mfma_f32_16x16x32_bf16 v[136:139], a[72:75], a[96:99], v[136:139]
    ds_read_b64_tr_b16 a[20:21], v20 offset:8256
    v_cndmask_b32 v240, v240, v246, s[88:89]
    v_mfma_f32_16x16x32_bf16 v[140:143], a[72:75], a[100:103], v[140:143]
    ds_read_b64_tr_b16 a[22:23], v20 offset:10048
    v_accvgpr_read_b32 v242, a168
    v_mfma_f32_16x16x32_bf16 v[144:147], a[72:75], a[104:107], v[144:147]
    buffer_load_dwordx4 v18, s[44:47], s48 offen offset:2048 lds
    v_accvgpr_read_b32 v243, a169
    v_mfma_f32_16x16x32_bf16 v[148:151], a[72:75], a[108:111], v[148:151]
    v_accvgpr_read_b32 v244, a170
    v_accvgpr_read_b32 v245, a171
    v_cndmask_b32 v242, v242, v243, s[82:83]
    v_mfma_f32_16x16x32_bf16 v[152:155], a[72:75], a[112:115], v[152:155]
    ds_read_b64_tr_b16 a[24:25], v21 offset:0
    v_cndmask_b32 v242, v242, v244, s[84:85]
    v_mfma_f32_16x16x32_bf16 v[156:159], a[72:75], a[116:119], v[156:159]
    ds_read_b64_tr_b16 a[26:27], v21 offset:1792
    v_cndmask_b32 v242, v242, v245, s[86:87]
    v_mfma_f32_16x16x32_bf16 v[160:163], a[76:79], a[88:91], v[160:163]
    buffer_load_dwordx4 v19, s[44:47], s48 offen offset:3072 lds
    s_add_u32 s48, s48, s49
    s_cmp_eq_u32 s48, s51
    s_cselect_b32 s48, s50, s48
    v_mfma_f32_16x16x32_bf16 v[164:167], a[76:79], a[92:95], v[164:167]
    s_cmp_eq_u32 s61, 2
    s_cselect_b64 vcc, -1, 0
    s_cselect_b64 s[72:73], s[6:7], s[72:73]
    s_cselect_b32 s74, 4194304, s74
    v_mfma_f32_16x16x32_bf16 v[168:171], a[76:79], a[96:99], v[168:171]
    v_cndmask_b32 v26, v26, v255, vcc
    s_cmp_ge_u32 s61, 2
    s_cselect_b32 s76, 0, s76
    v_mfma_f32_16x16x32_bf16 v[172:175], a[76:79], a[100:103], v[172:175]
    s_cmp_eq_u32 s61, 3
    s_cselect_b64 s[72:73], s[8:9], s[72:73]
    v_mfma_f32_16x16x32_bf16 v[176:179], a[76:79], a[104:107], v[176:179]
    v_cndmask_b32 v240, v240, v242, s[90:91]
    v_accvgpr_read_b32 v246, a172
    v_mfma_f32_16x16x32_bf16 v[180:183], a[76:79], a[108:111], v[180:183]
    v_accvgpr_read_b32 v247, a173
    v_accvgpr_read_b32 v248, a174
    v_mfma_f32_16x16x32_bf16 v[184:187], a[76:79], a[112:115], v[184:187]
    v_accvgpr_read_b32 v249, a175
    v_cndmask_b32 v246, v246, v247, s[82:83]
    v_mfma_f32_16x16x32_bf16 v[188:191], a[76:79], a[116:119], v[188:191]
    v_cndmask_b32 v246, v246, v248, s[84:85]
    v_cndmask_b32 v246, v246, v249, s[86:87]
    v_mfma_f32_16x16x32_bf16 v[192:195], a[80:83], a[88:91], v[192:195]
    v_cndmask_b32 v240, v240, v246, s[96:97]
    v_cvt_pk_bf16_f32 v250, 0, v240
    v_mfma_f32_16x16x32_bf16 v[196:199], a[80:83], a[92:95], v[196:199]
    v_sub_f32 v240, v240, v250
    v_cvt_pk_bf16_f32 v240, v250, v240
    v_mfma_f32_16x16x32_bf16 v[200:203], a[80:83], a[96:99], v[200:203]
    buffer_store_dword v240, v28, s[56:59], s79 offen offset:0 sc1
    v_accvgpr_read_b32 v242, a176
    v_mfma_f32_16x16x32_bf16 v[204:207], a[80:83], a[100:103], v[204:207]
    v_accvgpr_read_b32 v243, a177
    v_accvgpr_read_b32 v244, a178
    v_mfma_f32_16x16x32_bf16 v[208:211], a[80:83], a[104:107], v[208:211]
    v_accvgpr_read_b32 v245, a179
    v_cndmask_b32 v242, v242, v243, s[82:83]
    v_mfma_f32_16x16x32_bf16 v[212:215], a[80:83], a[108:111], v[212:215]
    v_cndmask_b32 v242, v242, v244, s[84:85]
    v_cndmask_b32 v241, v242, v245, s[86:87]
    v_mfma_f32_16x16x32_bf16 v[216:219], a[80:83], a[112:115], v[216:219]
    v_accvgpr_read_b32 v246, a180
    v_accvgpr_read_b32 v247, a181
    v_mfma_f32_16x16x32_bf16 v[220:223], a[80:83], a[116:119], v[220:223]
    v_accvgpr_read_b32 v248, a182
    v_accvgpr_read_b32 v249, a183
    v_mfma_f32_16x16x32_bf16 a[128:131], a[84:87], a[88:91], a[128:131]
    v_cndmask_b32 v246, v246, v247, s[82:83]
    v_cndmask_b32 v246, v246, v248, s[84:85]
    v_mfma_f32_16x16x32_bf16 a[132:135], a[84:87], a[92:95], a[132:135]
    v_cndmask_b32 v246, v246, v249, s[86:87]
    v_cndmask_b32 v241, v241, v246, s[88:89]
    v_mfma_f32_16x16x32_bf16 a[136:139], a[84:87], a[96:99], a[136:139]
    v_accvgpr_read_b32 v242, a184
    v_accvgpr_read_b32 v243, a185
    v_mfma_f32_16x16x32_bf16 a[140:143], a[84:87], a[100:103], a[140:143]
    v_accvgpr_read_b32 v244, a186
    v_accvgpr_read_b32 v245, a187
    v_mfma_f32_16x16x32_bf16 a[144:147], a[84:87], a[104:107], a[144:147]
    v_cndmask_b32 v242, v242, v243, s[82:83]
    v_cndmask_b32 v242, v242, v244, s[84:85]
    v_mfma_f32_16x16x32_bf16 a[148:151], a[84:87], a[108:111], a[148:151]
    v_cndmask_b32 v242, v242, v245, s[86:87]
    v_cndmask_b32 v241, v241, v242, s[90:91]
    s_waitcnt vmcnt(16)
    v_mfma_f32_16x16x32_bf16 a[152:155], a[84:87], a[112:115], a[152:155]
    v_cvt_pk_bf16_f32 v250, 0, v241
    v_sub_f32 v241, v241, v250
    v_mfma_f32_16x16x32_bf16 a[156:159], a[84:87], a[116:119], a[156:159]
    v_cvt_pk_bf16_f32 v241, v250, v241
    buffer_store_dword v241, v28, s[56:59], s79 offen offset:2048 sc1
    s_branch La_next
La_spin:
    s_add_u32 s90, s90, 1
    s_cmp_gt_u32 s90, 0x40000
    s_cbranch_scc1 La_go
    s_sleep 12
    buffer_load_dword v254, v28, s[68:71], 0 offen sc1
    s_waitcnt vmcnt(0)
    s_branch La_chk
La_spin2:
    s_add_u32 s90, s90, 1
    s_cmp_gt_u32 s90, 0x40000
    s_cbranch_scc1 La_go2
    s_sleep 12
    buffer_load_dword v3, v30, s[68:71], 0 offen sc1
    s_waitcnt vmcnt(0)
    s_branch La_chk2
La_tspin:
    s_add_u32 s90, s90, 1
    s_cmp_gt_u32 s90, 0x40000
    s_cbranch_scc1 La_tgo
    s_sleep 12
    buffer_load_dword v29, v30, s[68:71], 0 offen sc1
    s_waitcnt vmcnt(0)
    s_branch La_tchk
Lf_spin:
    buffer_load_dwordx4 v[24:27], v11, s[68:71], s47 offen sc1
Lf_sp2:
    s_add_u32 s90, s90, 1
    s_cmp_gt_u32 s90, 0x40000
    s_cbranch_scc1 Lf_out
    s_sleep 6
    buffer_load_dwordx4 v[20:23], v11, s[68:71], s47 offen sc1
    s_waitcnt vmcnt(1)
    v_xor_b32 v24, v24, v29
    v_xor_b32 v25, v25, v29
    v_xor_b32 v26, v26, v29
    v_xor_b32 v27, v27, v29
    v_or3_b32 v24, v24, v25, v26
    v_or_b32 v24, v24, v27
    v_cmp_ne_u32 vcc, 0, v24
    s_cbranch_vccz Lf_out
    s_sleep 6
    buffer_load_dwordx4 v[24:27], v11, s[68:71], s47 offen sc1
    s_waitcnt vmcnt(1)
    v_xor_b32 v20, v20, v29
    v_xor_b32 v21, v21, v29
    v_xor_b32 v22, v22, v29
    v_xor_b32 v23, v23, v29
    v_or3_b32 v20, v20, v21, v22
    v_or_b32 v20, v20, v23
    v_cmp_ne_u32 vcc, 0, v20
    s_cbranch_vccz Lf_out
    s_branch Lf_sp2
Lf_out:
    s_branch Lf_go
Lz_spin:
    s_add_u32 s90, s90, 1
    s_cmp_gt_u32 s90, 0x40000
    s_cbranch_scc1 Lz_go
    s_sleep 1
    buffer_load_dword v24, v25, s[64:67], s58 offen sc1
    s_waitcnt vmcnt(0)
    s_branch Lz_chk
La_end:
    s_endpgm

.section .rodata,"a"
.p2align 6
.amdhsa_kernel parallel_sum__ssm_conv_h3__glu_gated_glu__prompt_kernel
  .amdhsa_next_free_vgpr 512
  .amdhsa_next_free_sgpr 102
  .amdhsa_accum_offset 256
  .amdhsa_group_segment_fixed_size 0
  .amdhsa_kernarg_size 104
  .amdhsa_user_sgpr_count 2
  .amdhsa_user_sgpr_kernarg_segment_ptr 1
  .amdhsa_system_sgpr_workgroup_id_x 1
  .amdhsa_float_denorm_mode_32 3
  .amdhsa_float_denorm_mode_16_64 3
.end_amdhsa_kernel
```
